```python
import torch

def _softmax(x, axis=-1):
    return torch.softmax(x, dim=axis)
def _gelu(x):
    return torch.nn.functional.gelu(x, approximate="tanh")
def _silu(x):
    return torch.nn.functional.silu(x)
def _sigmoid(x):
    return torch.sigmoid(x)
def _layernorm(x, axis=-1, eps=1e-5):
    m = x.mean(dim=axis, keepdim=True)
    v = x.var(dim=axis, keepdim=True, unbiased=False)
    return (x - m) / torch.sqrt(v + eps)
def _scatter_add(tgt, idx, src, axis=0):
    return tgt.clone().index_add_(axis, idx, src)
def _segment_sum(src, seg, n):
    out = torch.zeros((n,) + src.shape[1:], dtype=src.dtype)
    return out.index_add_(0, seg, src)
def _pad(x, pw):
    flat = tuple(v for pair in reversed(pw) for v in pair)
    return torch.nn.functional.pad(x, flat)

kernel_name = 'sequential_preLN__grouped_kv_mqa__mixer_token_mlp__prompt'

def setup_inputs():

    _w = (lambda a: (lambda t: t.to(torch.bfloat16) if t.is_floating_point() else t)(torch.as_tensor(a)))
    def _A_setup():
        B, S, D, H = 1, 2048, 448, 16
        Dh = D // H
        return {
            "x": _w((lambda *s: torch.randn(*s, dtype=torch.bfloat16) * 0.05)(B, S, D)),
            "wq": _w((lambda *s: torch.randn(*s, dtype=torch.bfloat16) * 0.05)(D, H * Dh)),
            "wk": _w((lambda *s: torch.randn(*s, dtype=torch.bfloat16) * 0.05)(D, Dh)),
            "wv": _w((lambda *s: torch.randn(*s, dtype=torch.bfloat16) * 0.05)(D, Dh)),
            "wo": _w((lambda *s: torch.randn(*s, dtype=torch.bfloat16) * 0.05)(H * Dh, D)),
        }
    _A_in = _A_setup()

    def _B_setup():
        B, S, D, F = 1, 2048, 448, 1792
        return {
            "x": _w((lambda *s: torch.randn(*s, dtype=torch.bfloat16) * 0.05)(B, S, D)),
            "w1": _w((lambda *s: torch.randn(*s, dtype=torch.bfloat16) * 0.8)(S, F) * (S ** -0.5)),
            "b1": _w((lambda *s: torch.randn(*s, dtype=torch.bfloat16) * 12.8)(F) * 0.02),
            "w2": _w((lambda *s: torch.randn(*s, dtype=torch.bfloat16) * 0.2)(F, S) * (F ** -0.5)),
            "b2": _w((lambda *s: torch.randn(*s, dtype=torch.bfloat16) * 3.2)(S) * 0.02),
        }
    _B_in = _B_setup()

    return {
        "A_x": _A_in["x"],
        "A_wq": _A_in["wq"],
        "A_wk": _A_in["wk"],
        "A_wv": _A_in["wv"],
        "A_wo": _A_in["wo"],
        "B_x": _B_in["x"],
        "B_w1": _B_in["w1"],
        "B_b1": _B_in["b1"],
        "B_w2": _B_in["w2"],
        "B_b2": _B_in["b2"],
    }

def reference(A_x, A_wq, A_wk, A_wv, A_wo, B_x, B_w1, B_b1, B_w2, B_b2):
    def _A_ref(x, wq, wk, wv, wo):
        B, S, D = x.shape
        H = 16
        Dh = D // H
        q = (lambda x, *d: x.permute(*d))((x @ wq).reshape(B, S, H, Dh), 0, 2, 1, 3)
        k = x @ wk
        v = x @ wv
        scores = torch.einsum("bhqd,bkd->bhqk", q, k) * (Dh ** -0.5)
        p = _softmax(scores, axis=-1)
        o = torch.einsum("bhqk,bkd->bhqd", p, v)
        return (lambda x, *d: x.permute(*d))(o, 0, 2, 1, 3).reshape(B, S, H * Dh) @ wo

    def _B_ref(x, w1, b1, w2, b2):
        B, S, D = x.shape
        h = _layernorm(x, axis=-1)
        u = torch.einsum("bsd,sf->bdf", h, w1) + b1
        u = _gelu(u)
        y = torch.einsum("bdf,fs->bds", u, w2) + b2
        return (lambda x, *d: x.permute(*d))(y, 0, 2, 1)

    x = A_x
    h = x + _A_ref(_layernorm(x, axis=-1), A_wq, A_wk, A_wv, A_wo)
    h2 = h + _B_ref(_layernorm(h, axis=-1), B_w1, B_b1, B_w2, B_b2)
    return h2
```

```asm
; @launch kernel=k1_qkv_kernel grid=(256,1,1) block=(512,1,1) lds=160512
; @launch kernel=k2_attn_kernel grid=(256,1,1) block=(512,1,1) lds=163840
; @launch kernel=k3_gemm_kernel grid=(224,1,1) block=(512,1,1) lds=131072
; @launch kernel=k4_gemm_kernel grid=(224,1,1) block=(512,1,1) lds=114688
.amdgcn_target "amdgcn-amd-amdhsa--gfx950"
.text
.globl k1_qkv_kernel
.p2align 8
.type k1_qkv_kernel,@function
k1_qkv_kernel:
    s_cmp_ge_u32 s2, 256
    s_cbranch_scc1 K1_DONE
    s_load_dwordx4 s[4:7], s[0:1], 0
    s_load_dwordx4 s[8:11], s[0:1], 16
    s_load_dwordx2 s[12:13], s[0:1], 96
    s_lshr_b32 s14, s2, 2
    s_and_b32 s15, s2, 3
    v_lshrrev_b32 v1, 6, v0
    v_and_b32 v2, 63, v0
    s_nop 0
    v_readfirstlane_b32 s32, v1
    s_waitcnt lgkmcnt(0)
    s_mov_b32 s16, s4
    s_and_b32 s17, s5, 0xffff
    s_mov_b32 s18, 0x1c0000
    s_mov_b32 s19, 0x00020000
    s_mov_b32 s20, s6
    s_and_b32 s21, s7, 0xffff
    s_mov_b32 s22, 0x62000
    s_mov_b32 s23, 0x00020000
    s_cmp_eq_u32 s15, 0
    s_cselect_b32 s24, s8, s10
    s_cselect_b32 s25, s9, s11
    s_and_b32 s25, s25, 0xffff
    s_mov_b32 s26, 25088
    s_mov_b32 s27, 0x00020000
    s_mov_b32 s28, s12
    s_and_b32 s29, s13, 0xffff
    s_mov_b32 s30, 0x10000000
    s_mov_b32 s31, 0x00020000
    s_cmp_ge_u32 s32, 4
    s_cbranch_scc1 K1_SKIPX
    v_lshrrev_b32 v3, 3, v0
    v_and_b32 v4, 7, v0
    s_lshl_b32 s33, s14, 5
    v_add_u32 v5, s33, v3
    s_movk_i32 s34, 896
    v_mul_lo_u32 v5, v5, s34
    v_lshl_add_u32 v5, v4, 4, v5
    buffer_load_dwordx4 v[32:35], v5, s[16:19], 0 offen offset:0
    buffer_load_dwordx4 v[36:39], v5, s[16:19], 0 offen offset:128
    buffer_load_dwordx4 v[40:43], v5, s[16:19], 0 offen offset:256
    buffer_load_dwordx4 v[44:47], v5, s[16:19], 0 offen offset:384
    buffer_load_dwordx4 v[48:51], v5, s[16:19], 0 offen offset:512
    buffer_load_dwordx4 v[52:55], v5, s[16:19], 0 offen offset:640
    buffer_load_dwordx4 v[56:59], v5, s[16:19], 0 offen offset:768
K1_SKIPX:
    s_cmp_lt_u32 s32, 4
    s_cbranch_scc1 K1_SKIPKV
    s_sub_u32 s39, s32, 4
    s_lshl_b32 s35, s39, 6
    v_add_u32 v6, s35, v2
    s_mul_i32 s36, s15, 224
    s_mov_b32 s37, 37450
    s_lshl_b32 s38, s39, 10
    s_add_u32 s38, s38, 29184
    v_mul_u32_u24 v7, s37, v6
    v_lshrrev_b32 v7, 19, v7
    v_mul_u32_u24 v7, 672, v7
    v_lshl_add_u32 v7, v6, 4, v7
    s_mov_b32 m0, s38
    s_add_u32 s38, s38, 4096
    buffer_load_dwordx4 v7, s[20:23], s36 offen lds
    v_add_u32 v6, 256, v6
    v_mul_u32_u24 v7, s37, v6
    v_lshrrev_b32 v7, 19, v7
    v_mul_u32_u24 v7, 672, v7
    v_lshl_add_u32 v7, v6, 4, v7
    s_mov_b32 m0, s38
    s_add_u32 s38, s38, 4096
    buffer_load_dwordx4 v7, s[20:23], s36 offen lds
    v_add_u32 v6, 256, v6
    v_mul_u32_u24 v7, s37, v6
    v_lshrrev_b32 v7, 19, v7
    v_mul_u32_u24 v7, 672, v7
    v_lshl_add_u32 v7, v6, 4, v7
    s_mov_b32 m0, s38
    s_add_u32 s38, s38, 4096
    buffer_load_dwordx4 v7, s[20:23], s36 offen lds
    v_add_u32 v6, 256, v6
    v_mul_u32_u24 v7, s37, v6
    v_lshrrev_b32 v7, 19, v7
    v_mul_u32_u24 v7, 672, v7
    v_lshl_add_u32 v7, v6, 4, v7
    s_mov_b32 m0, s38
    s_add_u32 s38, s38, 4096
    buffer_load_dwordx4 v7, s[20:23], s36 offen lds
    v_add_u32 v6, 256, v6
    v_mul_u32_u24 v7, s37, v6
    v_lshrrev_b32 v7, 19, v7
    v_mul_u32_u24 v7, 672, v7
    v_lshl_add_u32 v7, v6, 4, v7
    s_mov_b32 m0, s38
    s_add_u32 s38, s38, 4096
    buffer_load_dwordx4 v7, s[20:23], s36 offen lds
    v_add_u32 v6, 256, v6
    v_mul_u32_u24 v7, s37, v6
    v_lshrrev_b32 v7, 19, v7
    v_mul_u32_u24 v7, 672, v7
    v_lshl_add_u32 v7, v6, 4, v7
    s_mov_b32 m0, s38
    s_add_u32 s38, s38, 4096
    buffer_load_dwordx4 v7, s[20:23], s36 offen lds
    v_add_u32 v6, 256, v6
    v_mul_u32_u24 v7, s37, v6
    v_lshrrev_b32 v7, 19, v7
    v_mul_u32_u24 v7, 672, v7
    v_lshl_add_u32 v7, v6, 4, v7
    s_mov_b32 m0, s38
    s_add_u32 s38, s38, 4096
    buffer_load_dwordx4 v7, s[20:23], s36 offen lds
    v_add_u32 v6, 256, v6
    v_mul_u32_u24 v7, s37, v6
    v_lshrrev_b32 v7, 19, v7
    v_mul_u32_u24 v7, 672, v7
    v_lshl_add_u32 v7, v6, 4, v7
    s_mov_b32 m0, s38
    s_add_u32 s38, s38, 4096
    buffer_load_dwordx4 v7, s[20:23], s36 offen lds
    v_add_u32 v6, 256, v6
    v_mul_u32_u24 v7, s37, v6
    v_lshrrev_b32 v7, 19, v7
    v_mul_u32_u24 v7, 672, v7
    v_lshl_add_u32 v7, v6, 4, v7
    s_mov_b32 m0, s38
    s_add_u32 s38, s38, 4096
    buffer_load_dwordx4 v7, s[20:23], s36 offen lds
    v_add_u32 v6, 256, v6
    v_mul_u32_u24 v7, s37, v6
    v_lshrrev_b32 v7, 19, v7
    v_mul_u32_u24 v7, 672, v7
    v_lshl_add_u32 v7, v6, 4, v7
    s_mov_b32 m0, s38
    s_add_u32 s38, s38, 4096
    buffer_load_dwordx4 v7, s[20:23], s36 offen lds
    v_add_u32 v6, 256, v6
    v_mul_u32_u24 v7, s37, v6
    v_lshrrev_b32 v7, 19, v7
    v_mul_u32_u24 v7, 672, v7
    v_lshl_add_u32 v7, v6, 4, v7
    s_mov_b32 m0, s38
    s_add_u32 s38, s38, 4096
    buffer_load_dwordx4 v7, s[20:23], s36 offen lds
    v_add_u32 v6, 256, v6
    v_mul_u32_u24 v7, s37, v6
    v_lshrrev_b32 v7, 19, v7
    v_mul_u32_u24 v7, 672, v7
    v_lshl_add_u32 v7, v6, 4, v7
    s_mov_b32 m0, s38
    s_add_u32 s38, s38, 4096
    buffer_load_dwordx4 v7, s[20:23], s36 offen lds
    v_add_u32 v6, 256, v6
    v_mul_u32_u24 v7, s37, v6
    v_lshrrev_b32 v7, 19, v7
    v_mul_u32_u24 v7, 672, v7
    v_lshl_add_u32 v7, v6, 4, v7
    s_mov_b32 m0, s38
    s_add_u32 s38, s38, 4096
    buffer_load_dwordx4 v7, s[20:23], s36 offen lds
    v_add_u32 v6, 256, v6
    v_mul_u32_u24 v7, s37, v6
    v_lshrrev_b32 v7, 19, v7
    v_mul_u32_u24 v7, 672, v7
    v_lshl_add_u32 v7, v6, 4, v7
    s_mov_b32 m0, s38
    s_add_u32 s38, s38, 4096
    buffer_load_dwordx4 v7, s[20:23], s36 offen lds
    v_add_u32 v6, 256, v6
    v_mul_u32_u24 v7, s37, v6
    v_lshrrev_b32 v7, 19, v7
    v_mul_u32_u24 v7, 672, v7
    v_lshl_add_u32 v7, v6, 4, v7
    s_mov_b32 m0, s38
    s_add_u32 s38, s38, 4096
    buffer_load_dwordx4 v7, s[20:23], s36 offen lds
    v_add_u32 v6, 256, v6
    v_mul_u32_u24 v7, s37, v6
    v_lshrrev_b32 v7, 19, v7
    v_mul_u32_u24 v7, 672, v7
    v_lshl_add_u32 v7, v6, 4, v7
    s_mov_b32 m0, s38
    s_add_u32 s38, s38, 4096
    buffer_load_dwordx4 v7, s[20:23], s36 offen lds
    v_add_u32 v6, 256, v6
    v_mul_u32_u24 v7, s37, v6
    v_lshrrev_b32 v7, 19, v7
    v_mul_u32_u24 v7, 672, v7
    v_lshl_add_u32 v7, v6, 4, v7
    s_mov_b32 m0, s38
    s_add_u32 s38, s38, 4096
    buffer_load_dwordx4 v7, s[20:23], s36 offen lds
    v_add_u32 v6, 256, v6
    v_mul_u32_u24 v7, s37, v6
    v_lshrrev_b32 v7, 19, v7
    v_mul_u32_u24 v7, 672, v7
    v_lshl_add_u32 v7, v6, 4, v7
    s_mov_b32 m0, s38
    s_add_u32 s38, s38, 4096
    buffer_load_dwordx4 v7, s[20:23], s36 offen lds
    v_add_u32 v6, 256, v6
    v_mul_u32_u24 v7, s37, v6
    v_lshrrev_b32 v7, 19, v7
    v_mul_u32_u24 v7, 672, v7
    v_lshl_add_u32 v7, v6, 4, v7
    s_mov_b32 m0, s38
    s_add_u32 s38, s38, 4096
    buffer_load_dwordx4 v7, s[20:23], s36 offen lds
    v_add_u32 v6, 256, v6
    v_mul_u32_u24 v7, s37, v6
    v_lshrrev_b32 v7, 19, v7
    v_mul_u32_u24 v7, 672, v7
    v_lshl_add_u32 v7, v6, 4, v7
    s_mov_b32 m0, s38
    s_add_u32 s38, s38, 4096
    buffer_load_dwordx4 v7, s[20:23], s36 offen lds
    v_add_u32 v6, 256, v6
    v_mul_u32_u24 v7, s37, v6
    v_lshrrev_b32 v7, 19, v7
    v_mul_u32_u24 v7, 672, v7
    v_lshl_add_u32 v7, v6, 4, v7
    s_mov_b32 m0, s38
    s_add_u32 s38, s38, 4096
    buffer_load_dwordx4 v7, s[20:23], s36 offen lds
    v_add_u32 v6, 256, v6
    v_mul_u32_u24 v7, s37, v6
    v_lshrrev_b32 v7, 19, v7
    v_mul_u32_u24 v7, 672, v7
    v_lshl_add_u32 v7, v6, 4, v7
    s_mov_b32 m0, s38
    s_add_u32 s38, s38, 4096
    buffer_load_dwordx4 v7, s[20:23], s36 offen lds
    v_add_u32 v6, 256, v6
    v_mul_u32_u24 v7, s37, v6
    v_lshrrev_b32 v7, 19, v7
    v_mul_u32_u24 v7, 672, v7
    v_lshl_add_u32 v7, v6, 4, v7
    s_mov_b32 m0, s38
    s_add_u32 s38, s38, 4096
    buffer_load_dwordx4 v7, s[20:23], s36 offen lds
    v_add_u32 v6, 256, v6
    v_mul_u32_u24 v7, s37, v6
    v_lshrrev_b32 v7, 19, v7
    v_mul_u32_u24 v7, 672, v7
    v_lshl_add_u32 v7, v6, 4, v7
    s_mov_b32 m0, s38
    s_add_u32 s38, s38, 4096
    buffer_load_dwordx4 v7, s[20:23], s36 offen lds
    v_add_u32 v6, 256, v6
    v_mul_u32_u24 v7, s37, v6
    v_lshrrev_b32 v7, 19, v7
    v_mul_u32_u24 v7, 672, v7
    v_lshl_add_u32 v7, v6, 4, v7
    s_mov_b32 m0, s38
    s_add_u32 s38, s38, 4096
    buffer_load_dwordx4 v7, s[20:23], s36 offen lds
    s_cmp_ge_u32 s15, 2
    s_cbranch_scc1 K1_SKIPKV
    v_add_u32 v7, s35, v2
    v_lshlrev_b32 v7, 4, v7
    s_lshl_b32 s38, s39, 10
    s_add_u32 s38, s38, 131584
    s_mov_b32 m0, s38
    s_add_u32 s38, s38, 4096
    buffer_load_dwordx4 v7, s[24:27], 0 offen lds
    v_add_u32 v7, 4096, v7
    s_mov_b32 m0, s38
    s_add_u32 s38, s38, 4096
    buffer_load_dwordx4 v7, s[24:27], 0 offen lds
    v_add_u32 v7, 4096, v7
    s_mov_b32 m0, s38
    s_add_u32 s38, s38, 4096
    buffer_load_dwordx4 v7, s[24:27], 0 offen lds
    v_add_u32 v7, 4096, v7
    s_mov_b32 m0, s38
    s_add_u32 s38, s38, 4096
    buffer_load_dwordx4 v7, s[24:27], 0 offen lds
    v_add_u32 v7, 4096, v7
    s_mov_b32 m0, s38
    s_add_u32 s38, s38, 4096
    buffer_load_dwordx4 v7, s[24:27], 0 offen lds
    v_add_u32 v7, 4096, v7
    s_mov_b32 m0, s38
    s_add_u32 s38, s38, 4096
    buffer_load_dwordx4 v7, s[24:27], 0 offen lds
    v_add_u32 v7, 4096, v7
    s_mov_b32 m0, s38
    s_add_u32 s38, s38, 4096
    buffer_load_dwordx4 v7, s[24:27], 0 offen lds
K1_SKIPKV:
    s_cmp_ge_u32 s32, 4
    s_cbranch_scc1 K1_SKIPLN
    s_waitcnt vmcnt(0)
    v_lshlrev_b32 v64, 16, v32
    v_and_b32 v65, 0xffff0000, v32
    v_lshlrev_b32 v66, 16, v33
    v_and_b32 v67, 0xffff0000, v33
    v_lshlrev_b32 v68, 16, v34
    v_and_b32 v69, 0xffff0000, v34
    v_lshlrev_b32 v70, 16, v35
    v_and_b32 v71, 0xffff0000, v35
    v_lshlrev_b32 v72, 16, v36
    v_and_b32 v73, 0xffff0000, v36
    v_lshlrev_b32 v74, 16, v37
    v_and_b32 v75, 0xffff0000, v37
    v_lshlrev_b32 v76, 16, v38
    v_and_b32 v77, 0xffff0000, v38
    v_lshlrev_b32 v78, 16, v39
    v_and_b32 v79, 0xffff0000, v39
    v_lshlrev_b32 v80, 16, v40
    v_and_b32 v81, 0xffff0000, v40
    v_lshlrev_b32 v82, 16, v41
    v_and_b32 v83, 0xffff0000, v41
    v_lshlrev_b32 v84, 16, v42
    v_and_b32 v85, 0xffff0000, v42
    v_lshlrev_b32 v86, 16, v43
    v_and_b32 v87, 0xffff0000, v43
    v_lshlrev_b32 v88, 16, v44
    v_and_b32 v89, 0xffff0000, v44
    v_lshlrev_b32 v90, 16, v45
    v_and_b32 v91, 0xffff0000, v45
    v_lshlrev_b32 v92, 16, v46
    v_and_b32 v93, 0xffff0000, v46
    v_lshlrev_b32 v94, 16, v47
    v_and_b32 v95, 0xffff0000, v47
    v_lshlrev_b32 v96, 16, v48
    v_and_b32 v97, 0xffff0000, v48
    v_lshlrev_b32 v98, 16, v49
    v_and_b32 v99, 0xffff0000, v49
    v_lshlrev_b32 v100, 16, v50
    v_and_b32 v101, 0xffff0000, v50
    v_lshlrev_b32 v102, 16, v51
    v_and_b32 v103, 0xffff0000, v51
    v_lshlrev_b32 v104, 16, v52
    v_and_b32 v105, 0xffff0000, v52
    v_lshlrev_b32 v106, 16, v53
    v_and_b32 v107, 0xffff0000, v53
    v_lshlrev_b32 v108, 16, v54
    v_and_b32 v109, 0xffff0000, v54
    v_lshlrev_b32 v110, 16, v55
    v_and_b32 v111, 0xffff0000, v55
    v_lshlrev_b32 v112, 16, v56
    v_and_b32 v113, 0xffff0000, v56
    v_lshlrev_b32 v114, 16, v57
    v_and_b32 v115, 0xffff0000, v57
    v_lshlrev_b32 v116, 16, v58
    v_and_b32 v117, 0xffff0000, v58
    v_lshlrev_b32 v118, 16, v59
    v_and_b32 v119, 0xffff0000, v59
    v_add_f32 v8, v64, v65
    v_add_f32 v9, v66, v67
    v_add_f32 v8, v8, v68
    v_add_f32 v8, v8, v69
    v_add_f32 v9, v9, v70
    v_add_f32 v9, v9, v71
    v_add_f32 v8, v8, v72
    v_add_f32 v8, v8, v73
    v_add_f32 v9, v9, v74
    v_add_f32 v9, v9, v75
    v_add_f32 v8, v8, v76
    v_add_f32 v8, v8, v77
    v_add_f32 v9, v9, v78
    v_add_f32 v9, v9, v79
    v_add_f32 v8, v8, v80
    v_add_f32 v8, v8, v81
    v_add_f32 v9, v9, v82
    v_add_f32 v9, v9, v83
    v_add_f32 v8, v8, v84
    v_add_f32 v8, v8, v85
    v_add_f32 v9, v9, v86
    v_add_f32 v9, v9, v87
    v_add_f32 v8, v8, v88
    v_add_f32 v8, v8, v89
    v_add_f32 v9, v9, v90
    v_add_f32 v9, v9, v91
    v_add_f32 v8, v8, v92
    v_add_f32 v8, v8, v93
    v_add_f32 v9, v9, v94
    v_add_f32 v9, v9, v95
    v_add_f32 v8, v8, v96
    v_add_f32 v8, v8, v97
    v_add_f32 v9, v9, v98
    v_add_f32 v9, v9, v99
    v_add_f32 v8, v8, v100
    v_add_f32 v8, v8, v101
    v_add_f32 v9, v9, v102
    v_add_f32 v9, v9, v103
    v_add_f32 v8, v8, v104
    v_add_f32 v8, v8, v105
    v_add_f32 v9, v9, v106
    v_add_f32 v9, v9, v107
    v_add_f32 v8, v8, v108
    v_add_f32 v8, v8, v109
    v_add_f32 v9, v9, v110
    v_add_f32 v9, v9, v111
    v_add_f32 v8, v8, v112
    v_add_f32 v8, v8, v113
    v_add_f32 v9, v9, v114
    v_add_f32 v9, v9, v115
    v_add_f32 v8, v8, v116
    v_add_f32 v8, v8, v117
    v_add_f32 v9, v9, v118
    v_add_f32 v9, v9, v119
    v_add_f32 v8, v8, v9
    s_nop 1
    v_add_f32 v8, v8, v8 quad_perm:[1,0,3,2] row_mask:0xf bank_mask:0xf
    s_nop 1
    v_add_f32 v8, v8, v8 quad_perm:[2,3,0,1] row_mask:0xf bank_mask:0xf
    s_nop 1
    v_add_f32 v8, v8, v8 row_half_mirror row_mask:0xf bank_mask:0xf
    v_mul_f32 v8, 0x3b124925, v8
    v_sub_f32 v64, v64, v8
    v_sub_f32 v65, v65, v8
    v_sub_f32 v66, v66, v8
    v_sub_f32 v67, v67, v8
    v_sub_f32 v68, v68, v8
    v_sub_f32 v69, v69, v8
    v_sub_f32 v70, v70, v8
    v_sub_f32 v71, v71, v8
    v_sub_f32 v72, v72, v8
    v_sub_f32 v73, v73, v8
    v_sub_f32 v74, v74, v8
    v_sub_f32 v75, v75, v8
    v_sub_f32 v76, v76, v8
    v_sub_f32 v77, v77, v8
    v_sub_f32 v78, v78, v8
    v_sub_f32 v79, v79, v8
    v_sub_f32 v80, v80, v8
    v_sub_f32 v81, v81, v8
    v_sub_f32 v82, v82, v8
    v_sub_f32 v83, v83, v8
    v_sub_f32 v84, v84, v8
    v_sub_f32 v85, v85, v8
    v_sub_f32 v86, v86, v8
    v_sub_f32 v87, v87, v8
    v_sub_f32 v88, v88, v8
    v_sub_f32 v89, v89, v8
    v_sub_f32 v90, v90, v8
    v_sub_f32 v91, v91, v8
    v_sub_f32 v92, v92, v8
    v_sub_f32 v93, v93, v8
    v_sub_f32 v94, v94, v8
    v_sub_f32 v95, v95, v8
    v_sub_f32 v96, v96, v8
    v_sub_f32 v97, v97, v8
    v_sub_f32 v98, v98, v8
    v_sub_f32 v99, v99, v8
    v_sub_f32 v100, v100, v8
    v_sub_f32 v101, v101, v8
    v_sub_f32 v102, v102, v8
    v_sub_f32 v103, v103, v8
    v_sub_f32 v104, v104, v8
    v_sub_f32 v105, v105, v8
    v_sub_f32 v106, v106, v8
    v_sub_f32 v107, v107, v8
    v_sub_f32 v108, v108, v8
    v_sub_f32 v109, v109, v8
    v_sub_f32 v110, v110, v8
    v_sub_f32 v111, v111, v8
    v_sub_f32 v112, v112, v8
    v_sub_f32 v113, v113, v8
    v_sub_f32 v114, v114, v8
    v_sub_f32 v115, v115, v8
    v_sub_f32 v116, v116, v8
    v_sub_f32 v117, v117, v8
    v_sub_f32 v118, v118, v8
    v_sub_f32 v119, v119, v8
    v_mul_f32 v9, v64, v64
    v_mul_f32 v10, v65, v65
    v_fmac_f32 v9, v66, v66
    v_fmac_f32 v10, v67, v67
    v_fmac_f32 v9, v68, v68
    v_fmac_f32 v10, v69, v69
    v_fmac_f32 v9, v70, v70
    v_fmac_f32 v10, v71, v71
    v_fmac_f32 v9, v72, v72
    v_fmac_f32 v10, v73, v73
    v_fmac_f32 v9, v74, v74
    v_fmac_f32 v10, v75, v75
    v_fmac_f32 v9, v76, v76
    v_fmac_f32 v10, v77, v77
    v_fmac_f32 v9, v78, v78
    v_fmac_f32 v10, v79, v79
    v_fmac_f32 v9, v80, v80
    v_fmac_f32 v10, v81, v81
    v_fmac_f32 v9, v82, v82
    v_fmac_f32 v10, v83, v83
    v_fmac_f32 v9, v84, v84
    v_fmac_f32 v10, v85, v85
    v_fmac_f32 v9, v86, v86
    v_fmac_f32 v10, v87, v87
    v_fmac_f32 v9, v88, v88
    v_fmac_f32 v10, v89, v89
    v_fmac_f32 v9, v90, v90
    v_fmac_f32 v10, v91, v91
    v_fmac_f32 v9, v92, v92
    v_fmac_f32 v10, v93, v93
    v_fmac_f32 v9, v94, v94
    v_fmac_f32 v10, v95, v95
    v_fmac_f32 v9, v96, v96
    v_fmac_f32 v10, v97, v97
    v_fmac_f32 v9, v98, v98
    v_fmac_f32 v10, v99, v99
    v_fmac_f32 v9, v100, v100
    v_fmac_f32 v10, v101, v101
    v_fmac_f32 v9, v102, v102
    v_fmac_f32 v10, v103, v103
    v_fmac_f32 v9, v104, v104
    v_fmac_f32 v10, v105, v105
    v_fmac_f32 v9, v106, v106
    v_fmac_f32 v10, v107, v107
    v_fmac_f32 v9, v108, v108
    v_fmac_f32 v10, v109, v109
    v_fmac_f32 v9, v110, v110
    v_fmac_f32 v10, v111, v111
    v_fmac_f32 v9, v112, v112
    v_fmac_f32 v10, v113, v113
    v_fmac_f32 v9, v114, v114
    v_fmac_f32 v10, v115, v115
    v_fmac_f32 v9, v116, v116
    v_fmac_f32 v10, v117, v117
    v_fmac_f32 v9, v118, v118
    v_fmac_f32 v10, v119, v119
    v_add_f32 v9, v9, v10
    s_nop 1
    v_add_f32 v9, v9, v9 quad_perm:[1,0,3,2] row_mask:0xf bank_mask:0xf
    s_nop 1
    v_add_f32 v9, v9, v9 quad_perm:[2,3,0,1] row_mask:0xf bank_mask:0xf
    s_nop 1
    v_add_f32 v9, v9, v9 row_half_mirror row_mask:0xf bank_mask:0xf
    v_mov_b32 v10, 0x3727c5ac
    v_fmac_f32 v10, 0x3b124925, v9
    v_rsq_f32 v10, v10
    s_nop 0
    v_mul_f32 v64, v64, v10
    v_mul_f32 v65, v65, v10
    v_mul_f32 v66, v66, v10
    v_mul_f32 v67, v67, v10
    v_mul_f32 v68, v68, v10
    v_mul_f32 v69, v69, v10
    v_mul_f32 v70, v70, v10
    v_mul_f32 v71, v71, v10
    v_mul_f32 v72, v72, v10
    v_mul_f32 v73, v73, v10
    v_mul_f32 v74, v74, v10
    v_mul_f32 v75, v75, v10
    v_mul_f32 v76, v76, v10
    v_mul_f32 v77, v77, v10
    v_mul_f32 v78, v78, v10
    v_mul_f32 v79, v79, v10
    v_mul_f32 v80, v80, v10
    v_mul_f32 v81, v81, v10
    v_mul_f32 v82, v82, v10
    v_mul_f32 v83, v83, v10
    v_mul_f32 v84, v84, v10
    v_mul_f32 v85, v85, v10
    v_mul_f32 v86, v86, v10
    v_mul_f32 v87, v87, v10
    v_mul_f32 v88, v88, v10
    v_mul_f32 v89, v89, v10
    v_mul_f32 v90, v90, v10
    v_mul_f32 v91, v91, v10
    v_mul_f32 v92, v92, v10
    v_mul_f32 v93, v93, v10
    v_mul_f32 v94, v94, v10
    v_mul_f32 v95, v95, v10
    v_mul_f32 v96, v96, v10
    v_mul_f32 v97, v97, v10
    v_mul_f32 v98, v98, v10
    v_mul_f32 v99, v99, v10
    v_mul_f32 v100, v100, v10
    v_mul_f32 v101, v101, v10
    v_mul_f32 v102, v102, v10
    v_mul_f32 v103, v103, v10
    v_mul_f32 v104, v104, v10
    v_mul_f32 v105, v105, v10
    v_mul_f32 v106, v106, v10
    v_mul_f32 v107, v107, v10
    v_mul_f32 v108, v108, v10
    v_mul_f32 v109, v109, v10
    v_mul_f32 v110, v110, v10
    v_mul_f32 v111, v111, v10
    v_mul_f32 v112, v112, v10
    v_mul_f32 v113, v113, v10
    v_mul_f32 v114, v114, v10
    v_mul_f32 v115, v115, v10
    v_mul_f32 v116, v116, v10
    v_mul_f32 v117, v117, v10
    v_mul_f32 v118, v118, v10
    v_mul_f32 v119, v119, v10
    v_cvt_pk_bf16_f32 v32, v64, v65
    v_cvt_pk_bf16_f32 v33, v66, v67
    v_cvt_pk_bf16_f32 v34, v68, v69
    v_cvt_pk_bf16_f32 v35, v70, v71
    v_cvt_pk_bf16_f32 v36, v72, v73
    v_cvt_pk_bf16_f32 v37, v74, v75
    v_cvt_pk_bf16_f32 v38, v76, v77
    v_cvt_pk_bf16_f32 v39, v78, v79
    v_cvt_pk_bf16_f32 v40, v80, v81
    v_cvt_pk_bf16_f32 v41, v82, v83
    v_cvt_pk_bf16_f32 v42, v84, v85
    v_cvt_pk_bf16_f32 v43, v86, v87
    v_cvt_pk_bf16_f32 v44, v88, v89
    v_cvt_pk_bf16_f32 v45, v90, v91
    v_cvt_pk_bf16_f32 v46, v92, v93
    v_cvt_pk_bf16_f32 v47, v94, v95
    v_cvt_pk_bf16_f32 v48, v96, v97
    v_cvt_pk_bf16_f32 v49, v98, v99
    v_cvt_pk_bf16_f32 v50, v100, v101
    v_cvt_pk_bf16_f32 v51, v102, v103
    v_cvt_pk_bf16_f32 v52, v104, v105
    v_cvt_pk_bf16_f32 v53, v106, v107
    v_cvt_pk_bf16_f32 v54, v108, v109
    v_cvt_pk_bf16_f32 v55, v110, v111
    v_cvt_pk_bf16_f32 v56, v112, v113
    v_cvt_pk_bf16_f32 v57, v114, v115
    v_cvt_pk_bf16_f32 v58, v116, v117
    v_cvt_pk_bf16_f32 v59, v118, v119
    v_mul_u32_u24 v11, 912, v3
    v_lshl_add_u32 v11, v4, 4, v11
    ds_write_b128 v11, v[32:35] offset:0
    ds_write_b128 v11, v[36:39] offset:128
    ds_write_b128 v11, v[40:43] offset:256
    ds_write_b128 v11, v[44:47] offset:384
    ds_write_b128 v11, v[48:51] offset:512
    ds_write_b128 v11, v[52:55] offset:640
    ds_write_b128 v11, v[56:59] offset:768
K1_SKIPLN:
    s_waitcnt vmcnt(0) lgkmcnt(0)
    s_barrier
    v_and_b32 v12, 31, v2
    v_mul_u32_u24 v12, 912, v12
    v_lshrrev_b32 v13, 5, v2
    v_lshl_add_u32 v12, v13, 4, v12
    v_bfe_u32 v14, v2, 2, 2
    v_lshl_add_u32 v14, v13, 3, v14
    v_bfe_u32 v15, v2, 4, 1
    v_and_b32 v16, 3, v2
    v_lshlrev_b32 v16, 3, v16
    v_lshl_add_u32 v15, v15, 5, v16
    s_cmp_ge_u32 s32, 5
    s_cbranch_scc1 K1_DONE
    s_cmp_ge_u32 s32, 4
    s_cbranch_scc1 K1_KV
    v_mul_u32_u24 v18, 224, v14
    v_add_u32 v18, v18, v15
    s_mul_i32 s33, s32, 56
    s_add_u32 s33, s33, 29184
    v_add_u32 v18, s33, v18
    v_add_u32 v17, 50176, v18
    ds_read_b64_tr_b16 v[80:81], v18 offset:0
    ds_read_b64_tr_b16 v[82:83], v18 offset:896
    ds_read_b128 v[84:87], v12 offset:0
    ds_read_b64_tr_b16 v[88:89], v18 offset:3584
    ds_read_b64_tr_b16 v[90:91], v18 offset:4480
    ds_read_b128 v[92:95], v12 offset:32
    ds_read_b64_tr_b16 v[96:97], v18 offset:7168
    ds_read_b64_tr_b16 v[98:99], v18 offset:8064
    ds_read_b128 v[100:103], v12 offset:64
    ds_read_b64_tr_b16 v[104:105], v18 offset:10752
    ds_read_b64_tr_b16 v[106:107], v18 offset:11648
    ds_read_b128 v[108:111], v12 offset:96
    ds_read_b64_tr_b16 v[112:113], v18 offset:14336
    ds_read_b64_tr_b16 v[114:115], v18 offset:15232
    ds_read_b128 v[116:119], v12 offset:128
    s_waitcnt lgkmcnt(12)
    v_mfma_f32_32x32x16_bf16 v[64:79], v[80:83], v[84:87], 0
    ds_read_b64_tr_b16 v[80:81], v18 offset:17920
    ds_read_b64_tr_b16 v[82:83], v18 offset:18816
    ds_read_b128 v[84:87], v12 offset:160
    s_waitcnt lgkmcnt(12)
    v_mfma_f32_32x32x16_bf16 v[64:79], v[88:91], v[92:95], v[64:79]
    ds_read_b64_tr_b16 v[88:89], v18 offset:21504
    ds_read_b64_tr_b16 v[90:91], v18 offset:22400
    ds_read_b128 v[92:95], v12 offset:192
    s_waitcnt lgkmcnt(12)
    v_mfma_f32_32x32x16_bf16 v[64:79], v[96:99], v[100:103], v[64:79]
    ds_read_b64_tr_b16 v[96:97], v18 offset:25088
    ds_read_b64_tr_b16 v[98:99], v18 offset:25984
    ds_read_b128 v[100:103], v12 offset:224
    s_waitcnt lgkmcnt(12)
    v_mfma_f32_32x32x16_bf16 v[64:79], v[104:107], v[108:111], v[64:79]
    ds_read_b64_tr_b16 v[104:105], v18 offset:28672
    ds_read_b64_tr_b16 v[106:107], v18 offset:29568
    ds_read_b128 v[108:111], v12 offset:256
    s_waitcnt lgkmcnt(12)
    v_mfma_f32_32x32x16_bf16 v[64:79], v[112:115], v[116:119], v[64:79]
    ds_read_b64_tr_b16 v[112:113], v18 offset:32256
    ds_read_b64_tr_b16 v[114:115], v18 offset:33152
    ds_read_b128 v[116:119], v12 offset:288
    s_waitcnt lgkmcnt(12)
    v_mfma_f32_32x32x16_bf16 v[64:79], v[80:83], v[84:87], v[64:79]
    ds_read_b64_tr_b16 v[80:81], v18 offset:35840
    ds_read_b64_tr_b16 v[82:83], v18 offset:36736
    ds_read_b128 v[84:87], v12 offset:320
    s_waitcnt lgkmcnt(12)
    v_mfma_f32_32x32x16_bf16 v[64:79], v[88:91], v[92:95], v[64:79]
    ds_read_b64_tr_b16 v[88:89], v18 offset:39424
    ds_read_b64_tr_b16 v[90:91], v18 offset:40320
    ds_read_b128 v[92:95], v12 offset:352
    s_waitcnt lgkmcnt(12)
    v_mfma_f32_32x32x16_bf16 v[64:79], v[96:99], v[100:103], v[64:79]
    ds_read_b64_tr_b16 v[96:97], v18 offset:43008
    ds_read_b64_tr_b16 v[98:99], v18 offset:43904
    ds_read_b128 v[100:103], v12 offset:384
    s_waitcnt lgkmcnt(12)
    v_mfma_f32_32x32x16_bf16 v[64:79], v[104:107], v[108:111], v[64:79]
    ds_read_b64_tr_b16 v[104:105], v18 offset:46592
    ds_read_b64_tr_b16 v[106:107], v18 offset:47488
    ds_read_b128 v[108:111], v12 offset:416
    s_waitcnt lgkmcnt(12)
    v_mfma_f32_32x32x16_bf16 v[64:79], v[112:115], v[116:119], v[64:79]
    ds_read_b64_tr_b16 v[112:113], v17 offset:0
    ds_read_b64_tr_b16 v[114:115], v17 offset:896
    ds_read_b128 v[116:119], v12 offset:448
    s_waitcnt lgkmcnt(12)
    v_mfma_f32_32x32x16_bf16 v[64:79], v[80:83], v[84:87], v[64:79]
    ds_read_b64_tr_b16 v[80:81], v17 offset:3584
    ds_read_b64_tr_b16 v[82:83], v17 offset:4480
    ds_read_b128 v[84:87], v12 offset:480
    s_waitcnt lgkmcnt(12)
    v_mfma_f32_32x32x16_bf16 v[64:79], v[88:91], v[92:95], v[64:79]
    ds_read_b64_tr_b16 v[88:89], v17 offset:7168
    ds_read_b64_tr_b16 v[90:91], v17 offset:8064
    ds_read_b128 v[92:95], v12 offset:512
    s_waitcnt lgkmcnt(12)
    v_mfma_f32_32x32x16_bf16 v[64:79], v[96:99], v[100:103], v[64:79]
    ds_read_b64_tr_b16 v[96:97], v17 offset:10752
    ds_read_b64_tr_b16 v[98:99], v17 offset:11648
    ds_read_b128 v[100:103], v12 offset:544
    s_waitcnt lgkmcnt(12)
    v_mfma_f32_32x32x16_bf16 v[64:79], v[104:107], v[108:111], v[64:79]
    ds_read_b64_tr_b16 v[104:105], v17 offset:14336
    ds_read_b64_tr_b16 v[106:107], v17 offset:15232
    ds_read_b128 v[108:111], v12 offset:576
    s_waitcnt lgkmcnt(12)
    v_mfma_f32_32x32x16_bf16 v[64:79], v[112:115], v[116:119], v[64:79]
    ds_read_b64_tr_b16 v[112:113], v17 offset:17920
    ds_read_b64_tr_b16 v[114:115], v17 offset:18816
    ds_read_b128 v[116:119], v12 offset:608
    s_waitcnt lgkmcnt(12)
    v_mfma_f32_32x32x16_bf16 v[64:79], v[80:83], v[84:87], v[64:79]
    ds_read_b64_tr_b16 v[80:81], v17 offset:21504
    ds_read_b64_tr_b16 v[82:83], v17 offset:22400
    ds_read_b128 v[84:87], v12 offset:640
    s_waitcnt lgkmcnt(12)
    v_mfma_f32_32x32x16_bf16 v[64:79], v[88:91], v[92:95], v[64:79]
    ds_read_b64_tr_b16 v[88:89], v17 offset:25088
    ds_read_b64_tr_b16 v[90:91], v17 offset:25984
    ds_read_b128 v[92:95], v12 offset:672
    s_waitcnt lgkmcnt(12)
    v_mfma_f32_32x32x16_bf16 v[64:79], v[96:99], v[100:103], v[64:79]
    ds_read_b64_tr_b16 v[96:97], v17 offset:28672
    ds_read_b64_tr_b16 v[98:99], v17 offset:29568
    ds_read_b128 v[100:103], v12 offset:704
    s_waitcnt lgkmcnt(12)
    v_mfma_f32_32x32x16_bf16 v[64:79], v[104:107], v[108:111], v[64:79]
    ds_read_b64_tr_b16 v[104:105], v17 offset:32256
    ds_read_b64_tr_b16 v[106:107], v17 offset:33152
    ds_read_b128 v[108:111], v12 offset:736
    s_waitcnt lgkmcnt(12)
    v_mfma_f32_32x32x16_bf16 v[64:79], v[112:115], v[116:119], v[64:79]
    ds_read_b64_tr_b16 v[112:113], v17 offset:35840
    ds_read_b64_tr_b16 v[114:115], v17 offset:36736
    ds_read_b128 v[116:119], v12 offset:768
    s_waitcnt lgkmcnt(12)
    v_mfma_f32_32x32x16_bf16 v[64:79], v[80:83], v[84:87], v[64:79]
    ds_read_b64_tr_b16 v[80:81], v17 offset:39424
    ds_read_b64_tr_b16 v[82:83], v17 offset:40320
    ds_read_b128 v[84:87], v12 offset:800
    s_waitcnt lgkmcnt(12)
    v_mfma_f32_32x32x16_bf16 v[64:79], v[88:91], v[92:95], v[64:79]
    ds_read_b64_tr_b16 v[88:89], v17 offset:43008
    ds_read_b64_tr_b16 v[90:91], v17 offset:43904
    ds_read_b128 v[92:95], v12 offset:832
    s_waitcnt lgkmcnt(12)
    v_mfma_f32_32x32x16_bf16 v[64:79], v[96:99], v[100:103], v[64:79]
    ds_read_b64_tr_b16 v[96:97], v17 offset:46592
    ds_read_b64_tr_b16 v[98:99], v17 offset:47488
    ds_read_b128 v[100:103], v12 offset:864
    s_waitcnt lgkmcnt(12)
    v_mfma_f32_32x32x16_bf16 v[64:79], v[104:107], v[108:111], v[64:79]
    s_waitcnt lgkmcnt(9)
    v_mfma_f32_32x32x16_bf16 v[64:79], v[112:115], v[116:119], v[64:79]
    s_waitcnt lgkmcnt(6)
    v_mfma_f32_32x32x16_bf16 v[64:79], v[80:83], v[84:87], v[64:79]
    s_waitcnt lgkmcnt(3)
    v_mfma_f32_32x32x16_bf16 v[64:79], v[88:91], v[92:95], v[64:79]
    s_waitcnt lgkmcnt(0)
    v_mfma_f32_32x32x16_bf16 v[64:79], v[96:99], v[100:103], v[64:79]
    s_nop 15
    s_mov_b32 s40, 0
    s_mov_b32 s41, -1
    v_mul_f32 v64, 0x3e8b97f6, v64
    v_mul_f32 v65, 0x3e8b97f6, v65
    v_mul_f32 v66, 0x3e8b97f6, v66
    v_mul_f32 v67, 0x3e8b97f6, v67
    v_mul_f32 v68, 0x3e8b97f6, v68
    v_mul_f32 v69, 0x3e8b97f6, v69
    v_mul_f32 v70, 0x3e8b97f6, v70
    v_mul_f32 v71, 0x3e8b97f6, v71
    v_mul_f32 v72, 0x3e8b97f6, v72
    v_mul_f32 v73, 0x3e8b97f6, v73
    v_mul_f32 v74, 0x3e8b97f6, v74
    v_mul_f32 v75, 0x3e8b97f6, v75
    v_mul_f32 v76, 0x3e8b97f6, v76
    v_mul_f32 v77, 0x3e8b97f6, v77
    v_mul_f32 v78, 0x3e8b97f6, v78
    v_mul_f32 v79, 0x3e8b97f6, v79
    v_cndmask_b32 v76, v76, 0, s[40:41]
    v_cndmask_b32 v77, v77, 0, s[40:41]
    v_cndmask_b32 v78, v78, 0, s[40:41]
    v_cndmask_b32 v79, v79, 0, s[40:41]
    v_cvt_pk_bf16_f32 v32, v64, v65
    v_cvt_pk_bf16_f32 v33, v66, v67
    v_cvt_pk_bf16_f32 v34, v68, v69
    v_cvt_pk_bf16_f32 v35, v70, v71
    v_cvt_pk_bf16_f32 v36, v72, v73
    v_cvt_pk_bf16_f32 v37, v74, v75
    v_cvt_pk_bf16_f32 v38, v76, v77
    v_cvt_pk_bf16_f32 v39, v78, v79
    v_and_b32 v20, 31, v2
    v_lshlrev_b32 v20, 10, v20
    v_lshl_add_u32 v20, v13, 3, v20
    s_lshl_b32 s33, s14, 15
    s_lshl_b32 s34, s15, 8
    s_add_u32 s33, s33, s34
    s_lshl_b32 s34, s32, 6
    s_add_u32 s33, s33, s34
    s_add_u32 s33, s33, 0
    buffer_store_dwordx2 v[32:33], v20, s[28:31], s33 offen offset:0
    buffer_store_dwordx2 v[34:35], v20, s[28:31], s33 offen offset:16
    buffer_store_dwordx2 v[36:37], v20, s[28:31], s33 offen offset:32
    buffer_store_dwordx2 v[38:39], v20, s[28:31], s33 offen offset:48
    s_branch K1_DONE
K1_KV:
    s_cmp_ge_u32 s15, 2
    s_cbranch_scc1 K1_WOF
    v_mul_u32_u24 v18, 56, v14
    v_add_u32 v18, v18, v15
    v_add_u32 v18, 131584, v18
    s_cmp_eq_u32 s15, 1
    s_cbranch_scc1 K1_V
    v_add_u32 v17, 12544, v18
    ds_read_b64_tr_b16 v[80:81], v18 offset:0
    ds_read_b64_tr_b16 v[82:83], v18 offset:224
    ds_read_b128 v[84:87], v12 offset:0
    ds_read_b64_tr_b16 v[88:89], v18 offset:896
    ds_read_b64_tr_b16 v[90:91], v18 offset:1120
    ds_read_b128 v[92:95], v12 offset:32
    ds_read_b64_tr_b16 v[96:97], v18 offset:1792
    ds_read_b64_tr_b16 v[98:99], v18 offset:2016
    ds_read_b128 v[100:103], v12 offset:64
    ds_read_b64_tr_b16 v[104:105], v18 offset:2688
    ds_read_b64_tr_b16 v[106:107], v18 offset:2912
    ds_read_b128 v[108:111], v12 offset:96
    ds_read_b64_tr_b16 v[112:113], v18 offset:3584
    ds_read_b64_tr_b16 v[114:115], v18 offset:3808
    ds_read_b128 v[116:119], v12 offset:128
    s_waitcnt lgkmcnt(12)
    v_mfma_f32_32x32x16_bf16 v[64:79], v[80:83], v[84:87], 0
    ds_read_b64_tr_b16 v[80:81], v18 offset:4480
    ds_read_b64_tr_b16 v[82:83], v18 offset:4704
    ds_read_b128 v[84:87], v12 offset:160
    s_waitcnt lgkmcnt(12)
    v_mfma_f32_32x32x16_bf16 v[64:79], v[88:91], v[92:95], v[64:79]
    ds_read_b64_tr_b16 v[88:89], v18 offset:5376
    ds_read_b64_tr_b16 v[90:91], v18 offset:5600
    ds_read_b128 v[92:95], v12 offset:192
    s_waitcnt lgkmcnt(12)
    v_mfma_f32_32x32x16_bf16 v[64:79], v[96:99], v[100:103], v[64:79]
    ds_read_b64_tr_b16 v[96:97], v18 offset:6272
    ds_read_b64_tr_b16 v[98:99], v18 offset:6496
    ds_read_b128 v[100:103], v12 offset:224
    s_waitcnt lgkmcnt(12)
    v_mfma_f32_32x32x16_bf16 v[64:79], v[104:107], v[108:111], v[64:79]
    ds_read_b64_tr_b16 v[104:105], v18 offset:7168
    ds_read_b64_tr_b16 v[106:107], v18 offset:7392
    ds_read_b128 v[108:111], v12 offset:256
    s_waitcnt lgkmcnt(12)
    v_mfma_f32_32x32x16_bf16 v[64:79], v[112:115], v[116:119], v[64:79]
    ds_read_b64_tr_b16 v[112:113], v18 offset:8064
    ds_read_b64_tr_b16 v[114:115], v18 offset:8288
    ds_read_b128 v[116:119], v12 offset:288
    s_waitcnt lgkmcnt(12)
    v_mfma_f32_32x32x16_bf16 v[64:79], v[80:83], v[84:87], v[64:79]
    ds_read_b64_tr_b16 v[80:81], v18 offset:8960
    ds_read_b64_tr_b16 v[82:83], v18 offset:9184
    ds_read_b128 v[84:87], v12 offset:320
    s_waitcnt lgkmcnt(12)
    v_mfma_f32_32x32x16_bf16 v[64:79], v[88:91], v[92:95], v[64:79]
    ds_read_b64_tr_b16 v[88:89], v18 offset:9856
    ds_read_b64_tr_b16 v[90:91], v18 offset:10080
    ds_read_b128 v[92:95], v12 offset:352
    s_waitcnt lgkmcnt(12)
    v_mfma_f32_32x32x16_bf16 v[64:79], v[96:99], v[100:103], v[64:79]
    ds_read_b64_tr_b16 v[96:97], v18 offset:10752
    ds_read_b64_tr_b16 v[98:99], v18 offset:10976
    ds_read_b128 v[100:103], v12 offset:384
    s_waitcnt lgkmcnt(12)
    v_mfma_f32_32x32x16_bf16 v[64:79], v[104:107], v[108:111], v[64:79]
    ds_read_b64_tr_b16 v[104:105], v18 offset:11648
    ds_read_b64_tr_b16 v[106:107], v18 offset:11872
    ds_read_b128 v[108:111], v12 offset:416
    s_waitcnt lgkmcnt(12)
    v_mfma_f32_32x32x16_bf16 v[64:79], v[112:115], v[116:119], v[64:79]
    ds_read_b64_tr_b16 v[112:113], v17 offset:0
    ds_read_b64_tr_b16 v[114:115], v17 offset:224
    ds_read_b128 v[116:119], v12 offset:448
    s_waitcnt lgkmcnt(12)
    v_mfma_f32_32x32x16_bf16 v[64:79], v[80:83], v[84:87], v[64:79]
    ds_read_b64_tr_b16 v[80:81], v17 offset:896
    ds_read_b64_tr_b16 v[82:83], v17 offset:1120
    ds_read_b128 v[84:87], v12 offset:480
    s_waitcnt lgkmcnt(12)
    v_mfma_f32_32x32x16_bf16 v[64:79], v[88:91], v[92:95], v[64:79]
    ds_read_b64_tr_b16 v[88:89], v17 offset:1792
    ds_read_b64_tr_b16 v[90:91], v17 offset:2016
    ds_read_b128 v[92:95], v12 offset:512
    s_waitcnt lgkmcnt(12)
    v_mfma_f32_32x32x16_bf16 v[64:79], v[96:99], v[100:103], v[64:79]
    ds_read_b64_tr_b16 v[96:97], v17 offset:2688
    ds_read_b64_tr_b16 v[98:99], v17 offset:2912
    ds_read_b128 v[100:103], v12 offset:544
    s_waitcnt lgkmcnt(12)
    v_mfma_f32_32x32x16_bf16 v[64:79], v[104:107], v[108:111], v[64:79]
    ds_read_b64_tr_b16 v[104:105], v17 offset:3584
    ds_read_b64_tr_b16 v[106:107], v17 offset:3808
    ds_read_b128 v[108:111], v12 offset:576
    s_waitcnt lgkmcnt(12)
    v_mfma_f32_32x32x16_bf16 v[64:79], v[112:115], v[116:119], v[64:79]
    ds_read_b64_tr_b16 v[112:113], v17 offset:4480
    ds_read_b64_tr_b16 v[114:115], v17 offset:4704
    ds_read_b128 v[116:119], v12 offset:608
    s_waitcnt lgkmcnt(12)
    v_mfma_f32_32x32x16_bf16 v[64:79], v[80:83], v[84:87], v[64:79]
    ds_read_b64_tr_b16 v[80:81], v17 offset:5376
    ds_read_b64_tr_b16 v[82:83], v17 offset:5600
    ds_read_b128 v[84:87], v12 offset:640
    s_waitcnt lgkmcnt(12)
    v_mfma_f32_32x32x16_bf16 v[64:79], v[88:91], v[92:95], v[64:79]
    ds_read_b64_tr_b16 v[88:89], v17 offset:6272
    ds_read_b64_tr_b16 v[90:91], v17 offset:6496
    ds_read_b128 v[92:95], v12 offset:672
    s_waitcnt lgkmcnt(12)
    v_mfma_f32_32x32x16_bf16 v[64:79], v[96:99], v[100:103], v[64:79]
    ds_read_b64_tr_b16 v[96:97], v17 offset:7168
    ds_read_b64_tr_b16 v[98:99], v17 offset:7392
    ds_read_b128 v[100:103], v12 offset:704
    s_waitcnt lgkmcnt(12)
    v_mfma_f32_32x32x16_bf16 v[64:79], v[104:107], v[108:111], v[64:79]
    ds_read_b64_tr_b16 v[104:105], v17 offset:8064
    ds_read_b64_tr_b16 v[106:107], v17 offset:8288
    ds_read_b128 v[108:111], v12 offset:736
    s_waitcnt lgkmcnt(12)
    v_mfma_f32_32x32x16_bf16 v[64:79], v[112:115], v[116:119], v[64:79]
    ds_read_b64_tr_b16 v[112:113], v17 offset:8960
    ds_read_b64_tr_b16 v[114:115], v17 offset:9184
    ds_read_b128 v[116:119], v12 offset:768
    s_waitcnt lgkmcnt(12)
    v_mfma_f32_32x32x16_bf16 v[64:79], v[80:83], v[84:87], v[64:79]
    ds_read_b64_tr_b16 v[80:81], v17 offset:9856
    ds_read_b64_tr_b16 v[82:83], v17 offset:10080
    ds_read_b128 v[84:87], v12 offset:800
    s_waitcnt lgkmcnt(12)
    v_mfma_f32_32x32x16_bf16 v[64:79], v[88:91], v[92:95], v[64:79]
    ds_read_b64_tr_b16 v[88:89], v17 offset:10752
    ds_read_b64_tr_b16 v[90:91], v17 offset:10976
    ds_read_b128 v[92:95], v12 offset:832
    s_waitcnt lgkmcnt(12)
    v_mfma_f32_32x32x16_bf16 v[64:79], v[96:99], v[100:103], v[64:79]
    ds_read_b64_tr_b16 v[96:97], v17 offset:11648
    ds_read_b64_tr_b16 v[98:99], v17 offset:11872
    ds_read_b128 v[100:103], v12 offset:864
    s_waitcnt lgkmcnt(12)
    v_mfma_f32_32x32x16_bf16 v[64:79], v[104:107], v[108:111], v[64:79]
    s_waitcnt lgkmcnt(9)
    v_mfma_f32_32x32x16_bf16 v[64:79], v[112:115], v[116:119], v[64:79]
    s_waitcnt lgkmcnt(6)
    v_mfma_f32_32x32x16_bf16 v[64:79], v[80:83], v[84:87], v[64:79]
    s_waitcnt lgkmcnt(3)
    v_mfma_f32_32x32x16_bf16 v[64:79], v[88:91], v[92:95], v[64:79]
    s_waitcnt lgkmcnt(0)
    v_mfma_f32_32x32x16_bf16 v[64:79], v[96:99], v[100:103], v[64:79]
    s_nop 15
    v_cvt_pk_bf16_f32 v32, v64, v65
    v_cvt_pk_bf16_f32 v33, v66, v67
    v_cvt_pk_bf16_f32 v34, v68, v69
    v_cvt_pk_bf16_f32 v35, v70, v71
    v_cvt_pk_bf16_f32 v36, v72, v73
    v_cvt_pk_bf16_f32 v37, v74, v75
    v_cvt_pk_bf16_f32 v38, v76, v77
    v_cvt_pk_bf16_f32 v39, v78, v79
    s_mov_b32 s40, 0
    s_mov_b32 s41, -1
    v_cndmask_b32 v76, v76, 0, s[40:41]
    v_cndmask_b32 v77, v77, 0, s[40:41]
    v_cndmask_b32 v78, v78, 0, s[40:41]
    v_cndmask_b32 v79, v79, 0, s[40:41]
    v_mul_f32 v44, v64, v64
    v_fmac_f32 v44, v65, v65
    v_fmac_f32 v44, v66, v66
    v_fmac_f32 v44, v67, v67
    v_fmac_f32 v44, v68, v68
    v_fmac_f32 v44, v69, v69
    v_fmac_f32 v44, v70, v70
    v_fmac_f32 v44, v71, v71
    v_fmac_f32 v44, v72, v72
    v_fmac_f32 v44, v73, v73
    v_fmac_f32 v44, v74, v74
    v_fmac_f32 v44, v75, v75
    v_fmac_f32 v44, v76, v76
    v_fmac_f32 v44, v77, v77
    v_fmac_f32 v44, v78, v78
    v_fmac_f32 v44, v79, v79
    v_xor_b32 v45, 32, v2
    v_lshlrev_b32 v45, 2, v45
    ds_bpermute_b32 v46, v45, v44
    s_waitcnt lgkmcnt(0)
    v_add_f32 v44, v44, v46
    s_nop 1
    v_mov_b32 v46, v44
    s_nop 1
    v_mov_b32 v46, v44 row_shr:1 row_mask:0xf bank_mask:0xf
    s_nop 1
    v_max_f32 v44, v44, v46
    s_nop 1
    v_mov_b32 v46, v44
    s_nop 1
    v_mov_b32 v46, v44 row_shr:2 row_mask:0xf bank_mask:0xf
    s_nop 1
    v_max_f32 v44, v44, v46
    s_nop 1
    v_mov_b32 v46, v44
    s_nop 1
    v_mov_b32 v46, v44 row_shr:4 row_mask:0xf bank_mask:0xf
    s_nop 1
    v_max_f32 v44, v44, v46
    s_nop 1
    v_mov_b32 v46, v44
    s_nop 1
    v_mov_b32 v46, v44 row_shr:8 row_mask:0xf bank_mask:0xf
    s_nop 1
    v_max_f32 v44, v44, v46
    s_nop 1
    v_readlane_b32 s44, v44, 15
    v_readlane_b32 s45, v44, 31
    s_nop 3
    v_mov_b32 v46, s44
    v_max_f32 v46, s45, v46
    v_mov_b32 v45, 0
    s_lshl_b32 s44, s14, 2
    s_add_u32 s44, s44, 10485760
    v_cmp_eq_u32 vcc, 0, v2
    s_and_saveexec_b64 s[46:47], vcc
    buffer_store_dword v46, v45, s[28:31], s44 offen
    s_mov_b64 exec, s[46:47]
    v_mov_b32 v21, 0x3f803f80
    v_cndmask_b32 v38, v38, v21, s[40:41]
    v_cndmask_b32 v39, v39, 0, s[40:41]
    v_and_b32 v20, 31, v2
    v_lshlrev_b32 v20, 4, v20
    v_lshl_add_u32 v20, v13, 3, v20
    s_lshl_b32 s33, s14, 11
    s_add_u32 s33, s33, 2097152
    buffer_store_dwordx2 v[32:33], v20, s[28:31], s33 offen offset:0
    buffer_store_dwordx2 v[34:35], v20, s[28:31], s33 offen offset:512
    buffer_store_dwordx2 v[36:37], v20, s[28:31], s33 offen offset:1024
    buffer_store_dwordx2 v[38:39], v20, s[28:31], s33 offen offset:1536
    s_branch K1_DONE
K1_V:
    v_add_u32 v17, 12544, v18
    ds_read_b64_tr_b16 v[80:81], v18 offset:0
    ds_read_b64_tr_b16 v[82:83], v18 offset:224
    ds_read_b128 v[84:87], v12 offset:0
    ds_read_b64_tr_b16 v[88:89], v18 offset:896
    ds_read_b64_tr_b16 v[90:91], v18 offset:1120
    ds_read_b128 v[92:95], v12 offset:32
    ds_read_b64_tr_b16 v[96:97], v18 offset:1792
    ds_read_b64_tr_b16 v[98:99], v18 offset:2016
    ds_read_b128 v[100:103], v12 offset:64
    ds_read_b64_tr_b16 v[104:105], v18 offset:2688
    ds_read_b64_tr_b16 v[106:107], v18 offset:2912
    ds_read_b128 v[108:111], v12 offset:96
    ds_read_b64_tr_b16 v[112:113], v18 offset:3584
    ds_read_b64_tr_b16 v[114:115], v18 offset:3808
    ds_read_b128 v[116:119], v12 offset:128
    s_waitcnt lgkmcnt(12)
    v_mfma_f32_32x32x16_bf16 v[64:79], v[84:87], v[80:83], 0
    ds_read_b64_tr_b16 v[80:81], v18 offset:4480
    ds_read_b64_tr_b16 v[82:83], v18 offset:4704
    ds_read_b128 v[84:87], v12 offset:160
    s_waitcnt lgkmcnt(12)
    v_mfma_f32_32x32x16_bf16 v[64:79], v[92:95], v[88:91], v[64:79]
    ds_read_b64_tr_b16 v[88:89], v18 offset:5376
    ds_read_b64_tr_b16 v[90:91], v18 offset:5600
    ds_read_b128 v[92:95], v12 offset:192
    s_waitcnt lgkmcnt(12)
    v_mfma_f32_32x32x16_bf16 v[64:79], v[100:103], v[96:99], v[64:79]
    ds_read_b64_tr_b16 v[96:97], v18 offset:6272
    ds_read_b64_tr_b16 v[98:99], v18 offset:6496
    ds_read_b128 v[100:103], v12 offset:224
    s_waitcnt lgkmcnt(12)
    v_mfma_f32_32x32x16_bf16 v[64:79], v[108:111], v[104:107], v[64:79]
    ds_read_b64_tr_b16 v[104:105], v18 offset:7168
    ds_read_b64_tr_b16 v[106:107], v18 offset:7392
    ds_read_b128 v[108:111], v12 offset:256
    s_waitcnt lgkmcnt(12)
    v_mfma_f32_32x32x16_bf16 v[64:79], v[116:119], v[112:115], v[64:79]
    ds_read_b64_tr_b16 v[112:113], v18 offset:8064
    ds_read_b64_tr_b16 v[114:115], v18 offset:8288
    ds_read_b128 v[116:119], v12 offset:288
    s_waitcnt lgkmcnt(12)
    v_mfma_f32_32x32x16_bf16 v[64:79], v[84:87], v[80:83], v[64:79]
    ds_read_b64_tr_b16 v[80:81], v18 offset:8960
    ds_read_b64_tr_b16 v[82:83], v18 offset:9184
    ds_read_b128 v[84:87], v12 offset:320
    s_waitcnt lgkmcnt(12)
    v_mfma_f32_32x32x16_bf16 v[64:79], v[92:95], v[88:91], v[64:79]
    ds_read_b64_tr_b16 v[88:89], v18 offset:9856
    ds_read_b64_tr_b16 v[90:91], v18 offset:10080
    ds_read_b128 v[92:95], v12 offset:352
    s_waitcnt lgkmcnt(12)
    v_mfma_f32_32x32x16_bf16 v[64:79], v[100:103], v[96:99], v[64:79]
    ds_read_b64_tr_b16 v[96:97], v18 offset:10752
    ds_read_b64_tr_b16 v[98:99], v18 offset:10976
    ds_read_b128 v[100:103], v12 offset:384
    s_waitcnt lgkmcnt(12)
    v_mfma_f32_32x32x16_bf16 v[64:79], v[108:111], v[104:107], v[64:79]
    ds_read_b64_tr_b16 v[104:105], v18 offset:11648
    ds_read_b64_tr_b16 v[106:107], v18 offset:11872
    ds_read_b128 v[108:111], v12 offset:416
    s_waitcnt lgkmcnt(12)
    v_mfma_f32_32x32x16_bf16 v[64:79], v[116:119], v[112:115], v[64:79]
    ds_read_b64_tr_b16 v[112:113], v17 offset:0
    ds_read_b64_tr_b16 v[114:115], v17 offset:224
    ds_read_b128 v[116:119], v12 offset:448
    s_waitcnt lgkmcnt(12)
    v_mfma_f32_32x32x16_bf16 v[64:79], v[84:87], v[80:83], v[64:79]
    ds_read_b64_tr_b16 v[80:81], v17 offset:896
    ds_read_b64_tr_b16 v[82:83], v17 offset:1120
    ds_read_b128 v[84:87], v12 offset:480
    s_waitcnt lgkmcnt(12)
    v_mfma_f32_32x32x16_bf16 v[64:79], v[92:95], v[88:91], v[64:79]
    ds_read_b64_tr_b16 v[88:89], v17 offset:1792
    ds_read_b64_tr_b16 v[90:91], v17 offset:2016
    ds_read_b128 v[92:95], v12 offset:512
    s_waitcnt lgkmcnt(12)
    v_mfma_f32_32x32x16_bf16 v[64:79], v[100:103], v[96:99], v[64:79]
    ds_read_b64_tr_b16 v[96:97], v17 offset:2688
    ds_read_b64_tr_b16 v[98:99], v17 offset:2912
    ds_read_b128 v[100:103], v12 offset:544
    s_waitcnt lgkmcnt(12)
    v_mfma_f32_32x32x16_bf16 v[64:79], v[108:111], v[104:107], v[64:79]
    ds_read_b64_tr_b16 v[104:105], v17 offset:3584
    ds_read_b64_tr_b16 v[106:107], v17 offset:3808
    ds_read_b128 v[108:111], v12 offset:576
    s_waitcnt lgkmcnt(12)
    v_mfma_f32_32x32x16_bf16 v[64:79], v[116:119], v[112:115], v[64:79]
    ds_read_b64_tr_b16 v[112:113], v17 offset:4480
    ds_read_b64_tr_b16 v[114:115], v17 offset:4704
    ds_read_b128 v[116:119], v12 offset:608
    s_waitcnt lgkmcnt(12)
    v_mfma_f32_32x32x16_bf16 v[64:79], v[84:87], v[80:83], v[64:79]
    ds_read_b64_tr_b16 v[80:81], v17 offset:5376
    ds_read_b64_tr_b16 v[82:83], v17 offset:5600
    ds_read_b128 v[84:87], v12 offset:640
    s_waitcnt lgkmcnt(12)
    v_mfma_f32_32x32x16_bf16 v[64:79], v[92:95], v[88:91], v[64:79]
    ds_read_b64_tr_b16 v[88:89], v17 offset:6272
    ds_read_b64_tr_b16 v[90:91], v17 offset:6496
    ds_read_b128 v[92:95], v12 offset:672
    s_waitcnt lgkmcnt(12)
    v_mfma_f32_32x32x16_bf16 v[64:79], v[100:103], v[96:99], v[64:79]
    ds_read_b64_tr_b16 v[96:97], v17 offset:7168
    ds_read_b64_tr_b16 v[98:99], v17 offset:7392
    ds_read_b128 v[100:103], v12 offset:704
    s_waitcnt lgkmcnt(12)
    v_mfma_f32_32x32x16_bf16 v[64:79], v[108:111], v[104:107], v[64:79]
    ds_read_b64_tr_b16 v[104:105], v17 offset:8064
    ds_read_b64_tr_b16 v[106:107], v17 offset:8288
    ds_read_b128 v[108:111], v12 offset:736
    s_waitcnt lgkmcnt(12)
    v_mfma_f32_32x32x16_bf16 v[64:79], v[116:119], v[112:115], v[64:79]
    ds_read_b64_tr_b16 v[112:113], v17 offset:8960
    ds_read_b64_tr_b16 v[114:115], v17 offset:9184
    ds_read_b128 v[116:119], v12 offset:768
    s_waitcnt lgkmcnt(12)
    v_mfma_f32_32x32x16_bf16 v[64:79], v[84:87], v[80:83], v[64:79]
    ds_read_b64_tr_b16 v[80:81], v17 offset:9856
    ds_read_b64_tr_b16 v[82:83], v17 offset:10080
    ds_read_b128 v[84:87], v12 offset:800
    s_waitcnt lgkmcnt(12)
    v_mfma_f32_32x32x16_bf16 v[64:79], v[92:95], v[88:91], v[64:79]
    ds_read_b64_tr_b16 v[88:89], v17 offset:10752
    ds_read_b64_tr_b16 v[90:91], v17 offset:10976
    ds_read_b128 v[92:95], v12 offset:832
    s_waitcnt lgkmcnt(12)
    v_mfma_f32_32x32x16_bf16 v[64:79], v[100:103], v[96:99], v[64:79]
    ds_read_b64_tr_b16 v[96:97], v17 offset:11648
    ds_read_b64_tr_b16 v[98:99], v17 offset:11872
    ds_read_b128 v[100:103], v12 offset:864
    s_waitcnt lgkmcnt(12)
    v_mfma_f32_32x32x16_bf16 v[64:79], v[108:111], v[104:107], v[64:79]
    s_waitcnt lgkmcnt(9)
    v_mfma_f32_32x32x16_bf16 v[64:79], v[116:119], v[112:115], v[64:79]
    s_waitcnt lgkmcnt(6)
    v_mfma_f32_32x32x16_bf16 v[64:79], v[84:87], v[80:83], v[64:79]
    s_waitcnt lgkmcnt(3)
    v_mfma_f32_32x32x16_bf16 v[64:79], v[92:95], v[88:91], v[64:79]
    s_waitcnt lgkmcnt(0)
    v_mfma_f32_32x32x16_bf16 v[64:79], v[100:103], v[96:99], v[64:79]
    s_nop 15
    v_and_b32 v20, 31, v2
    v_cmp_eq_u32 s[40:41], 28, v20
    v_cmp_lt_u32 s[42:43], 28, v20
    s_nop 1
    v_cndmask_b32 v64, v64, 1.0, s[40:41]
    v_cndmask_b32 v64, v64, 0, s[42:43]
    v_cndmask_b32 v65, v65, 1.0, s[40:41]
    v_cndmask_b32 v65, v65, 0, s[42:43]
    v_cndmask_b32 v66, v66, 1.0, s[40:41]
    v_cndmask_b32 v66, v66, 0, s[42:43]
    v_cndmask_b32 v67, v67, 1.0, s[40:41]
    v_cndmask_b32 v67, v67, 0, s[42:43]
    v_cndmask_b32 v68, v68, 1.0, s[40:41]
    v_cndmask_b32 v68, v68, 0, s[42:43]
    v_cndmask_b32 v69, v69, 1.0, s[40:41]
    v_cndmask_b32 v69, v69, 0, s[42:43]
    v_cndmask_b32 v70, v70, 1.0, s[40:41]
    v_cndmask_b32 v70, v70, 0, s[42:43]
    v_cndmask_b32 v71, v71, 1.0, s[40:41]
    v_cndmask_b32 v71, v71, 0, s[42:43]
    v_cndmask_b32 v72, v72, 1.0, s[40:41]
    v_cndmask_b32 v72, v72, 0, s[42:43]
    v_cndmask_b32 v73, v73, 1.0, s[40:41]
    v_cndmask_b32 v73, v73, 0, s[42:43]
    v_cndmask_b32 v74, v74, 1.0, s[40:41]
    v_cndmask_b32 v74, v74, 0, s[42:43]
    v_cndmask_b32 v75, v75, 1.0, s[40:41]
    v_cndmask_b32 v75, v75, 0, s[42:43]
    v_cndmask_b32 v76, v76, 1.0, s[40:41]
    v_cndmask_b32 v76, v76, 0, s[42:43]
    v_cndmask_b32 v77, v77, 1.0, s[40:41]
    v_cndmask_b32 v77, v77, 0, s[42:43]
    v_cndmask_b32 v78, v78, 1.0, s[40:41]
    v_cndmask_b32 v78, v78, 0, s[42:43]
    v_cndmask_b32 v79, v79, 1.0, s[40:41]
    v_cndmask_b32 v79, v79, 0, s[42:43]
    v_cvt_pk_bf16_f32 v32, v64, v65
    v_cvt_pk_bf16_f32 v33, v66, v67
    v_cvt_pk_bf16_f32 v34, v68, v69
    v_cvt_pk_bf16_f32 v35, v70, v71
    v_cvt_pk_bf16_f32 v36, v72, v73
    v_cvt_pk_bf16_f32 v37, v74, v75
    v_cvt_pk_bf16_f32 v38, v76, v77
    v_cvt_pk_bf16_f32 v39, v78, v79
    v_lshlrev_b32 v20, 4, v2
    s_lshl_b32 s33, s14, 11
    s_add_u32 s33, s33, 2228224
    buffer_store_dwordx4 v[32:35], v20, s[28:31], s33 offen
    buffer_store_dwordx4 v[36:39], v20, s[28:31], s33 offen offset:1024
    s_branch K1_DONE
K1_WOF:
    s_load_dwordx2 s[4:5], s[0:1], 32
    s_waitcnt lgkmcnt(0)
    s_mov_b32 s16, s4
    s_and_b32 s17, s5, 0xffff
    s_mov_b32 s18, 0x62000
    s_mov_b32 s19, 0x00020000
    v_lshrrev_b32 v20, 4, v2
    v_mul_u32_u24 v20, 7168, v20
    v_and_b32 v21, 15, v2
    v_lshl_add_u32 v20, v21, 1, v20
    v_lshlrev_b32 v21, 4, v2
    v_add_u32 v22, 3584, v20
    s_lshl_b32 s33, s14, 1
    s_add_u32 s33, s33, s15
    s_sub_u32 s33, s33, 2
    s_cmp_ge_u32 s33, 392
    s_cbranch_scc1 K1_DONE
    s_mul_i32 s34, s33, 2341
    s_lshr_b32 s34, s34, 16
    s_mul_i32 s35, s34, 28
    s_sub_u32 s35, s33, s35
    s_mul_i32 s36, s34, 28672
    s_lshl_b32 s35, s35, 5
    s_add_u32 s36, s36, s35
    buffer_load_ushort v32, v20, s[16:19], s36 offen offset:0
    buffer_load_ushort v33, v20, s[16:19], s36 offen offset:896
    buffer_load_ushort v34, v20, s[16:19], s36 offen offset:1792
    buffer_load_ushort v35, v20, s[16:19], s36 offen offset:2688
    buffer_load_ushort v36, v20, s[16:19], s36 offen offset:3584
    buffer_load_ushort v37, v22, s[16:19], s36 offen offset:896
    buffer_load_ushort v38, v22, s[16:19], s36 offen offset:1792
    buffer_load_ushort v39, v22, s[16:19], s36 offen offset:2688
    s_waitcnt vmcnt(0)
    v_lshl_or_b32 v40, v33, 16, v32
    v_lshl_or_b32 v41, v35, 16, v34
    v_lshl_or_b32 v42, v37, 16, v36
    v_lshl_or_b32 v43, v39, 16, v38
    s_lshl_b32 s36, s33, 10
    s_add_u32 s36, s36, 9437184
    buffer_store_dwordx4 v[40:43], v21, s[28:31], s36 offen
    s_add_u32 s33, s33, 128
    s_cmp_ge_u32 s33, 392
    s_cbranch_scc1 K1_DONE
    s_mul_i32 s34, s33, 2341
    s_lshr_b32 s34, s34, 16
    s_mul_i32 s35, s34, 28
    s_sub_u32 s35, s33, s35
    s_mul_i32 s36, s34, 28672
    s_lshl_b32 s35, s35, 5
    s_add_u32 s36, s36, s35
    buffer_load_ushort v32, v20, s[16:19], s36 offen offset:0
    buffer_load_ushort v33, v20, s[16:19], s36 offen offset:896
    buffer_load_ushort v34, v20, s[16:19], s36 offen offset:1792
    buffer_load_ushort v35, v20, s[16:19], s36 offen offset:2688
    buffer_load_ushort v36, v20, s[16:19], s36 offen offset:3584
    buffer_load_ushort v37, v22, s[16:19], s36 offen offset:896
    buffer_load_ushort v38, v22, s[16:19], s36 offen offset:1792
    buffer_load_ushort v39, v22, s[16:19], s36 offen offset:2688
    s_waitcnt vmcnt(0)
    v_lshl_or_b32 v40, v33, 16, v32
    v_lshl_or_b32 v41, v35, 16, v34
    v_lshl_or_b32 v42, v37, 16, v36
    v_lshl_or_b32 v43, v39, 16, v38
    s_lshl_b32 s36, s33, 10
    s_add_u32 s36, s36, 9437184
    buffer_store_dwordx4 v[40:43], v21, s[28:31], s36 offen
    s_add_u32 s33, s33, 128
    s_cmp_ge_u32 s33, 392
    s_cbranch_scc1 K1_DONE
    s_mul_i32 s34, s33, 2341
    s_lshr_b32 s34, s34, 16
    s_mul_i32 s35, s34, 28
    s_sub_u32 s35, s33, s35
    s_mul_i32 s36, s34, 28672
    s_lshl_b32 s35, s35, 5
    s_add_u32 s36, s36, s35
    buffer_load_ushort v32, v20, s[16:19], s36 offen offset:0
    buffer_load_ushort v33, v20, s[16:19], s36 offen offset:896
    buffer_load_ushort v34, v20, s[16:19], s36 offen offset:1792
    buffer_load_ushort v35, v20, s[16:19], s36 offen offset:2688
    buffer_load_ushort v36, v20, s[16:19], s36 offen offset:3584
    buffer_load_ushort v37, v22, s[16:19], s36 offen offset:896
    buffer_load_ushort v38, v22, s[16:19], s36 offen offset:1792
    buffer_load_ushort v39, v22, s[16:19], s36 offen offset:2688
    s_waitcnt vmcnt(0)
    v_lshl_or_b32 v40, v33, 16, v32
    v_lshl_or_b32 v41, v35, 16, v34
    v_lshl_or_b32 v42, v37, 16, v36
    v_lshl_or_b32 v43, v39, 16, v38
    s_lshl_b32 s36, s33, 10
    s_add_u32 s36, s36, 9437184
    buffer_store_dwordx4 v[40:43], v21, s[28:31], s36 offen
    s_add_u32 s33, s33, 128
    s_cmp_ge_u32 s33, 392
    s_cbranch_scc1 K1_DONE
    s_mul_i32 s34, s33, 2341
    s_lshr_b32 s34, s34, 16
    s_mul_i32 s35, s34, 28
    s_sub_u32 s35, s33, s35
    s_mul_i32 s36, s34, 28672
    s_lshl_b32 s35, s35, 5
    s_add_u32 s36, s36, s35
    buffer_load_ushort v32, v20, s[16:19], s36 offen offset:0
    buffer_load_ushort v33, v20, s[16:19], s36 offen offset:896
    buffer_load_ushort v34, v20, s[16:19], s36 offen offset:1792
    buffer_load_ushort v35, v20, s[16:19], s36 offen offset:2688
    buffer_load_ushort v36, v20, s[16:19], s36 offen offset:3584
    buffer_load_ushort v37, v22, s[16:19], s36 offen offset:896
    buffer_load_ushort v38, v22, s[16:19], s36 offen offset:1792
    buffer_load_ushort v39, v22, s[16:19], s36 offen offset:2688
    s_waitcnt vmcnt(0)
    v_lshl_or_b32 v40, v33, 16, v32
    v_lshl_or_b32 v41, v35, 16, v34
    v_lshl_or_b32 v42, v37, 16, v36
    v_lshl_or_b32 v43, v39, 16, v38
    s_lshl_b32 s36, s33, 10
    s_add_u32 s36, s36, 9437184
    buffer_store_dwordx4 v[40:43], v21, s[28:31], s36 offen
    s_add_u32 s33, s33, 128
K1_DONE:
    s_endpgm
.section .rodata,"a"
.p2align 6
.amdhsa_kernel k1_qkv_kernel
  .amdhsa_next_free_vgpr 128
  .amdhsa_next_free_sgpr 102
  .amdhsa_accum_offset 128
  .amdhsa_group_segment_fixed_size 0
  .amdhsa_kernarg_size 104
  .amdhsa_user_sgpr_count 2
  .amdhsa_user_sgpr_kernarg_segment_ptr 1
  .amdhsa_system_sgpr_workgroup_id_x 1
.end_amdhsa_kernel
.text
.globl k2_attn_kernel
.p2align 8
.type k2_attn_kernel,@function
k2_attn_kernel:
    s_cmp_ge_u32 s2, 256
    s_cbranch_scc1 K2_DONE
    s_load_dwordx2 s[4:5], s[0:1], 0
    s_load_dwordx2 s[12:13], s[0:1], 96
    s_load_dwordx2 s[6:7], s[0:1], 48
    s_load_dwordx2 s[8:9], s[0:1], 64
    v_lshrrev_b32 v1, 6, v0
    v_and_b32 v2, 63, v0
    s_nop 0
    v_readfirstlane_b32 s32, v1
    s_waitcnt lgkmcnt(0)
    s_and_b32 s33, s32, 3
    s_lshr_b32 s34, s32, 2
    s_mov_b32 s16, s4
    s_and_b32 s17, s5, 0xffff
    s_mov_b32 s18, 0x1c0000
    s_mov_b32 s19, 0x00020000
    s_mov_b32 s28, s12
    s_and_b32 s29, s13, 0xffff
    s_mov_b32 s30, 0x10000000
    s_mov_b32 s31, 0x00020000
    v_lshlrev_b32 v6, 4, v2
    s_lshl_b32 s38, s34, 16
    s_lshl_b32 s39, s33, 10
    s_add_u32 s38, s38, s39
    s_lshl_b32 s40, s34, 15
    s_add_u32 s39, s39, s40
    s_add_u32 s40, s39, 0
    s_add_u32 s41, s38, 2097152
    s_mov_b32 m0, s40
    s_nop 0
    buffer_load_dwordx4 v6, s[28:31], s41 offen lds
    s_add_u32 s40, s39, 4096
    s_add_u32 s41, s38, 2228224
    s_mov_b32 m0, s40
    s_nop 0
    buffer_load_dwordx4 v6, s[28:31], s41 offen lds
    s_add_u32 s40, s39, 8192
    s_add_u32 s41, s38, 2101248
    s_mov_b32 m0, s40
    s_nop 0
    buffer_load_dwordx4 v6, s[28:31], s41 offen lds
    s_add_u32 s40, s39, 12288
    s_add_u32 s41, s38, 2232320
    s_mov_b32 m0, s40
    s_nop 0
    buffer_load_dwordx4 v6, s[28:31], s41 offen lds
    v_and_b32 v3, 7, v2
    v_lshlrev_b32 v3, 10, v3
    v_bfe_u32 v4, v2, 3, 2
    v_lshl_add_u32 v3, v4, 6, v3
    v_lshrrev_b32 v5, 5, v2
    v_lshl_add_u32 v3, v5, 4, v3
    s_lshl_b32 s35, s2, 13
    s_lshl_b32 s36, s33, 8
    s_add_u32 s35, s35, s36
    buffer_load_dwordx4 v[16:19], v3, s[28:31], s35 offen
    buffer_load_dwordx4 v[20:23], v3, s[28:31], s35 offen offset:32
    v_lshlrev_b32 v8, 2, v2
    s_mov_b32 s40, 10485760
    buffer_load_dword v226, v8, s[28:31], s40 offen
    s_lshl_b32 s40, s34, 15
    v_add_u32 v7, s40, v6
    s_lshl_b32 s44, s32, 12
    s_add_u32 s44, s44, 9437184
    s_lshl_b32 s45, s32, 12
    s_add_u32 s45, s45, 65536
    s_mov_b32 s20, s6
    s_and_b32 s21, s7, 0xffff
    s_mov_b32 s22, 0x700000
    s_mov_b32 s23, 0x00020000
    s_mov_b32 s24, s8
    s_and_b32 s25, s9, 0xffff
    s_mov_b32 s26, 0x700000
    s_mov_b32 s27, 0x00020000
    s_and_b32 s50, s2, 7
    s_lshr_b32 s51, s2, 3
    v_lshrrev_b32 v8, 3, v2
    v_and_b32 v9, 7, v2
    s_movk_i32 s40, 3584
    v_mul_lo_u32 v10, v8, s40
    v_lshl_add_u32 v10, v9, 4, v10
    v_lshlrev_b32 v11, 12, v8
    v_lshl_add_u32 v11, v9, 4, v11
    s_lshl_b32 s50, s50, 7
    s_mul_i32 s52, s51, 229376
    s_add_u32 s52, s52, s50
    s_mul_i32 s53, s51, 229376
    s_add_u32 s53, s53, s50
    s_mov_b32 s42, 0
    s_mov_b32 s43, -1
    s_mov_b32 s46, 0xff800000
    v_mov_b32 v216, 0
    s_waitcnt vmcnt(0)
    s_barrier
    ds_read_b128 v[80:83], v7 offset:0
    ds_read_b128 v[84:87], v7 offset:1024
    ds_read_b128 v[88:91], v7 offset:2048
    ds_read_b128 v[92:95], v7 offset:3072
    s_waitcnt lgkmcnt(2)
    v_mfma_f32_32x32x16_bf16 v[24:39], v[80:83], v[16:19], 0
    v_mfma_f32_32x32x16_bf16 v[24:39], v[84:87], v[20:23], v[24:39]
    v_mov_b32 v224, 0
    v_lshlrev_b32 v217, 16, v16
    v_and_b32 v218, 0xffff0000, v16
    v_fmac_f32 v224, v217, v217
    v_fmac_f32 v224, v218, v218
    v_lshlrev_b32 v217, 16, v17
    v_and_b32 v218, 0xffff0000, v17
    v_fmac_f32 v224, v217, v217
    v_fmac_f32 v224, v218, v218
    v_lshlrev_b32 v217, 16, v18
    v_and_b32 v218, 0xffff0000, v18
    v_fmac_f32 v224, v217, v217
    v_fmac_f32 v224, v218, v218
    v_lshlrev_b32 v217, 16, v19
    v_and_b32 v218, 0xffff0000, v19
    v_fmac_f32 v224, v217, v217
    v_fmac_f32 v224, v218, v218
    v_lshlrev_b32 v217, 16, v20
    v_and_b32 v218, 0xffff0000, v20
    v_fmac_f32 v224, v217, v217
    v_fmac_f32 v224, v218, v218
    v_lshlrev_b32 v217, 16, v21
    v_and_b32 v218, 0xffff0000, v21
    v_fmac_f32 v224, v217, v217
    v_fmac_f32 v224, v218, v218
    v_lshlrev_b32 v217, 16, v22
    v_and_b32 v218, 0xffff0000, v22
    v_fmac_f32 v224, v217, v217
    v_fmac_f32 v224, v218, v218
    v_lshlrev_b32 v217, 16, v23
    v_and_b32 v218, 0xffff0000, v23
    v_fmac_f32 v224, v217, v217
    v_fmac_f32 v224, v218, v218
    v_xor_b32 v218, 32, v2
    v_lshlrev_b32 v218, 2, v218
    ds_bpermute_b32 v219, v218, v224
    v_mov_b32 v225, v226
    s_nop 1
    v_mov_b32 v220, v225
    s_nop 1
    v_mov_b32 v220, v225 row_shr:1 row_mask:0xf bank_mask:0xf
    s_nop 1
    v_max_f32 v225, v225, v220
    s_nop 1
    v_mov_b32 v220, v225
    s_nop 1
    v_mov_b32 v220, v225 row_shr:2 row_mask:0xf bank_mask:0xf
    s_nop 1
    v_max_f32 v225, v225, v220
    s_nop 1
    v_mov_b32 v220, v225
    s_nop 1
    v_mov_b32 v220, v225 row_shr:4 row_mask:0xf bank_mask:0xf
    s_nop 1
    v_max_f32 v225, v225, v220
    s_nop 1
    v_mov_b32 v220, v225
    s_nop 1
    v_mov_b32 v220, v225 row_shr:8 row_mask:0xf bank_mask:0xf
    s_nop 1
    v_max_f32 v225, v225, v220
    s_nop 1
    v_readlane_b32 s54, v225, 15
    v_readlane_b32 s55, v225, 31
    v_readlane_b32 s56, v225, 47
    v_readlane_b32 s57, v225, 63
    s_waitcnt lgkmcnt(0)
    v_add_f32 v224, v224, v219
    v_mov_b32 v225, s54
    v_max_f32 v225, s55, v225
    v_max_f32 v225, s56, v225
    v_max_f32 v225, s57, v225
    v_mul_f32 v224, v224, v225
    v_mov_b32 v225, 0x45100000
    v_cmp_nlt_f32 vcc, v224, v225
    s_cbranch_vccnz K2_SAFE
    s_add_u32 s40, s39, 16384
    s_add_u32 s41, s38, 2105344
    s_mov_b32 m0, s40
    s_nop 0
    buffer_load_dwordx4 v6, s[28:31], s41 offen lds
    s_add_u32 s40, s39, 20480
    s_add_u32 s41, s38, 2236416
    s_mov_b32 m0, s40
    s_nop 0
    buffer_load_dwordx4 v6, s[28:31], s41 offen lds
    s_waitcnt lgkmcnt(0)
    v_mfma_f32_32x32x16_bf16 v[40:55], v[88:91], v[16:19], 0
    s_nop 15
    v_max3_f32 v217, v24, v25, v26
    v_max3_f32 v218, v27, v28, v29
    v_max3_f32 v217, v217, v30, v31
    v_max3_f32 v218, v218, v32, v33
    v_max3_f32 v217, v217, v34, v35
    v_max3_f32 v218, v218, v36, v37
    v_max3_f32 v217, v217, v38, v39
    v_max_f32 v217, v217, v218
    v_cmp_lt_f32 vcc, s46, v217
    s_cbranch_vccnz K2F_RARE0
K2F_BACK0:
    v_exp_f32 v24, v24
    v_exp_f32 v25, v25
    v_exp_f32 v26, v26
    v_exp_f32 v27, v27
    v_mfma_f32_32x32x16_bf16 v[40:55], v[92:95], v[20:23], v[40:55]
    s_cmp_ge_u32 s32, 7
    s_cbranch_scc1 K2_Q7_0
    s_add_u32 s40, s44, 0
    buffer_load_dwordx4 v[104:107], v6, s[28:31], s40 offen
    s_branch K2_QJ_0
K2_Q7_0:
    s_add_u32 s40, s52, 0
    buffer_load_dwordx4 v[104:107], v10, s[20:23], s40 offen
K2_QJ_0:
    v_exp_f32 v28, v28
    v_exp_f32 v29, v29
    v_exp_f32 v30, v30
    v_exp_f32 v31, v31
    s_cmp_ge_u32 s32, 7
    s_cbranch_scc1 K2_Q7_1
    s_add_u32 s40, s44, 1024
    buffer_load_dwordx4 v[108:111], v6, s[28:31], s40 offen
    s_branch K2_QJ_1
K2_Q7_1:
    s_add_u32 s40, s52, 28672
    buffer_load_dwordx4 v[108:111], v10, s[20:23], s40 offen
K2_QJ_1:
    v_exp_f32 v32, v32
    v_exp_f32 v33, v33
    v_exp_f32 v34, v34
    v_exp_f32 v35, v35
    ds_read_b128 v[80:83], v7 offset:8192
    ds_read_b128 v[84:87], v7 offset:9216
    s_cmp_ge_u32 s32, 7
    s_cbranch_scc1 K2_Q7_2
    s_add_u32 s40, s44, 2048
    buffer_load_dwordx4 v[112:115], v6, s[28:31], s40 offen
    s_branch K2_QJ_2
K2_Q7_2:
    s_add_u32 s40, s52, 57344
    buffer_load_dwordx4 v[112:115], v10, s[20:23], s40 offen
K2_QJ_2:
    v_exp_f32 v36, v36
    v_exp_f32 v37, v37
    v_exp_f32 v38, v38
    v_exp_f32 v39, v39
    v_cvt_pk_bf16_f32 v56, v24, v25
    v_cvt_pk_bf16_f32 v57, v26, v27
    v_cvt_pk_bf16_f32 v58, v28, v29
    v_cvt_pk_bf16_f32 v59, v30, v31
    v_cvt_pk_bf16_f32 v60, v32, v33
    v_cvt_pk_bf16_f32 v61, v34, v35
    v_cvt_pk_bf16_f32 v62, v36, v37
    v_cvt_pk_bf16_f32 v63, v38, v39
    ds_read_b128 v[96:99], v7 offset:4096
    ds_read_b128 v[100:103], v7 offset:5120
    s_waitcnt lgkmcnt(2)
    v_mfma_f32_32x32x16_bf16 v[24:39], v[80:83], v[16:19], 0
    v_exp_f32 v40, v40
    v_exp_f32 v41, v41
    v_exp_f32 v42, v42
    v_exp_f32 v43, v43
    v_mfma_f32_32x32x16_bf16 v[24:39], v[84:87], v[20:23], v[24:39]
    s_cmp_ge_u32 s32, 7
    s_cbranch_scc1 K2_Q7_3
    s_add_u32 s40, s44, 3072
    buffer_load_dwordx4 v[116:119], v6, s[28:31], s40 offen
    s_branch K2_QJ_3
K2_Q7_3:
    s_add_u32 s40, s52, 86016
    buffer_load_dwordx4 v[116:119], v10, s[20:23], s40 offen
K2_QJ_3:
    v_exp_f32 v44, v44
    v_exp_f32 v45, v45
    v_exp_f32 v46, v46
    v_exp_f32 v47, v47
    s_waitcnt lgkmcnt(0)
    v_mfma_f32_32x32x16_bf16 v[64:79], v[96:99], v[56:59], 0
    s_cmp_ge_u32 s32, 7
    s_cbranch_scc1 K2_Q7_4
    s_branch K2_QJ_4
K2_Q7_4:
    s_add_u32 s40, s52, 114688
    buffer_load_dwordx4 v[120:123], v10, s[20:23], s40 offen
K2_QJ_4:
    v_exp_f32 v48, v48
    v_exp_f32 v49, v49
    v_exp_f32 v50, v50
    v_exp_f32 v51, v51
    v_mfma_f32_32x32x16_bf16 v[64:79], v[100:103], v[60:63], v[64:79]
    ds_read_b128 v[88:91], v7 offset:10240
    ds_read_b128 v[92:95], v7 offset:11264
    v_exp_f32 v52, v52
    v_exp_f32 v53, v53
    v_exp_f32 v54, v54
    v_exp_f32 v55, v55
    v_cvt_pk_bf16_f32 v232, v40, v41
    v_cvt_pk_bf16_f32 v233, v42, v43
    v_cvt_pk_bf16_f32 v234, v44, v45
    v_cvt_pk_bf16_f32 v235, v46, v47
    v_cvt_pk_bf16_f32 v236, v48, v49
    v_cvt_pk_bf16_f32 v237, v50, v51
    v_cvt_pk_bf16_f32 v238, v52, v53
    v_cvt_pk_bf16_f32 v239, v54, v55
    s_cmp_ge_u32 s32, 7
    s_cbranch_scc1 K2F_W7_1
    s_waitcnt vmcnt(4)
    s_branch K2F_WJ_1
K2F_W7_1:
    s_waitcnt vmcnt(5)
K2F_WJ_1:
    s_barrier
    s_add_u32 s40, s39, 24576
    s_add_u32 s41, s38, 2109440
    s_mov_b32 m0, s40
    s_nop 0
    buffer_load_dwordx4 v6, s[28:31], s41 offen lds
    s_add_u32 s40, s39, 28672
    s_add_u32 s41, s38, 2240512
    s_mov_b32 m0, s40
    s_nop 0
    buffer_load_dwordx4 v6, s[28:31], s41 offen lds
    ds_read_b128 v[96:99], v7 offset:6144
    ds_read_b128 v[100:103], v7 offset:7168
    s_waitcnt lgkmcnt(2)
    v_mfma_f32_32x32x16_bf16 v[40:55], v[88:91], v[16:19], 0
    v_exp_f32 v24, v24
    v_exp_f32 v25, v25
    v_exp_f32 v26, v26
    v_exp_f32 v27, v27
    v_mfma_f32_32x32x16_bf16 v[40:55], v[92:95], v[20:23], v[40:55]
    s_cmp_ge_u32 s32, 7
    s_cbranch_scc1 K2_Q7_5
    s_add_u32 s40, s45, 0
    s_add_u32 s41, s44, 229376
    s_mov_b32 m0, s40
    s_nop 0
    buffer_load_dwordx4 v6, s[28:31], s41 offen lds
    s_branch K2_QJ_5
K2_Q7_5:
    s_add_u32 s40, s52, 143360
    buffer_load_dwordx4 v[104:107], v10, s[20:23], s40 offen
K2_QJ_5:
    v_exp_f32 v28, v28
    v_exp_f32 v29, v29
    v_exp_f32 v30, v30
    v_exp_f32 v31, v31
    s_waitcnt lgkmcnt(0)
    v_mfma_f32_32x32x16_bf16 v[64:79], v[96:99], v[232:235], v[64:79]
    s_cmp_ge_u32 s32, 7
    s_cbranch_scc1 K2_Q7_6
    s_add_u32 s40, s45, 1024
    s_add_u32 s41, s44, 230400
    s_mov_b32 m0, s40
    s_nop 0
    buffer_load_dwordx4 v6, s[28:31], s41 offen lds
    s_branch K2_QJ_6
K2_Q7_6:
    s_add_u32 s40, s52, 172032
    buffer_load_dwordx4 v[108:111], v10, s[20:23], s40 offen
K2_QJ_6:
    v_exp_f32 v32, v32
    v_exp_f32 v33, v33
    v_exp_f32 v34, v34
    v_exp_f32 v35, v35
    v_mfma_f32_32x32x16_bf16 v[64:79], v[100:103], v[236:239], v[64:79]
    ds_read_b128 v[80:83], v7 offset:16384
    ds_read_b128 v[84:87], v7 offset:17408
    s_cmp_ge_u32 s32, 7
    s_cbranch_scc1 K2_Q7_7
    s_add_u32 s40, s45, 2048
    s_add_u32 s41, s44, 231424
    s_mov_b32 m0, s40
    s_nop 0
    buffer_load_dwordx4 v6, s[28:31], s41 offen lds
    s_branch K2_QJ_7
K2_Q7_7:
    s_add_u32 s40, s52, 200704
    buffer_load_dwordx4 v[112:115], v10, s[20:23], s40 offen
K2_QJ_7:
    v_exp_f32 v36, v36
    v_exp_f32 v37, v37
    v_exp_f32 v38, v38
    v_exp_f32 v39, v39
    v_cvt_pk_bf16_f32 v56, v24, v25
    v_cvt_pk_bf16_f32 v57, v26, v27
    v_cvt_pk_bf16_f32 v58, v28, v29
    v_cvt_pk_bf16_f32 v59, v30, v31
    v_cvt_pk_bf16_f32 v60, v32, v33
    v_cvt_pk_bf16_f32 v61, v34, v35
    v_cvt_pk_bf16_f32 v62, v36, v37
    v_cvt_pk_bf16_f32 v63, v38, v39
    ds_read_b128 v[96:99], v7 offset:12288
    ds_read_b128 v[100:103], v7 offset:13312
    s_waitcnt lgkmcnt(2)
    v_mfma_f32_32x32x16_bf16 v[24:39], v[80:83], v[16:19], 0
    v_exp_f32 v40, v40
    v_exp_f32 v41, v41
    v_exp_f32 v42, v42
    v_exp_f32 v43, v43
    v_mfma_f32_32x32x16_bf16 v[24:39], v[84:87], v[20:23], v[24:39]
    s_cmp_ge_u32 s32, 7
    s_cbranch_scc1 K2_Q7_8
    s_add_u32 s40, s45, 3072
    s_add_u32 s41, s44, 232448
    s_mov_b32 m0, s40
    s_nop 0
    buffer_load_dwordx4 v6, s[28:31], s41 offen lds
    s_branch K2_QJ_8
K2_Q7_8:
    s_add_u32 s40, s52, 1024
    buffer_load_dwordx4 v[116:119], v10, s[20:23], s40 offen
K2_QJ_8:
    v_exp_f32 v44, v44
    v_exp_f32 v45, v45
    v_exp_f32 v46, v46
    v_exp_f32 v47, v47
    s_waitcnt lgkmcnt(0)
    v_mfma_f32_32x32x16_bf16 v[64:79], v[96:99], v[56:59], v[64:79]
    s_cmp_ge_u32 s32, 7
    s_cbranch_scc1 K2_Q7_9
    s_branch K2_QJ_9
K2_Q7_9:
    s_add_u32 s40, s52, 29696
    buffer_load_dwordx4 v[120:123], v10, s[20:23], s40 offen
K2_QJ_9:
    v_exp_f32 v48, v48
    v_exp_f32 v49, v49
    v_exp_f32 v50, v50
    v_exp_f32 v51, v51
    v_mfma_f32_32x32x16_bf16 v[64:79], v[100:103], v[60:63], v[64:79]
    ds_read_b128 v[88:91], v7 offset:18432
    ds_read_b128 v[92:95], v7 offset:19456
    v_exp_f32 v52, v52
    v_exp_f32 v53, v53
    v_exp_f32 v54, v54
    v_exp_f32 v55, v55
    v_cvt_pk_bf16_f32 v232, v40, v41
    v_cvt_pk_bf16_f32 v233, v42, v43
    v_cvt_pk_bf16_f32 v234, v44, v45
    v_cvt_pk_bf16_f32 v235, v46, v47
    v_cvt_pk_bf16_f32 v236, v48, v49
    v_cvt_pk_bf16_f32 v237, v50, v51
    v_cvt_pk_bf16_f32 v238, v52, v53
    v_cvt_pk_bf16_f32 v239, v54, v55
    s_cmp_ge_u32 s32, 7
    s_cbranch_scc1 K2F_W7_2
    s_waitcnt vmcnt(4)
    s_branch K2F_WJ_2
K2F_W7_2:
    s_waitcnt vmcnt(5)
K2F_WJ_2:
    s_barrier
    s_add_u32 s40, s39, 0
    s_add_u32 s41, s38, 2113536
    s_mov_b32 m0, s40
    s_nop 0
    buffer_load_dwordx4 v6, s[28:31], s41 offen lds
    s_add_u32 s40, s39, 4096
    s_add_u32 s41, s38, 2244608
    s_mov_b32 m0, s40
    s_nop 0
    buffer_load_dwordx4 v6, s[28:31], s41 offen lds
    ds_read_b128 v[96:99], v7 offset:14336
    ds_read_b128 v[100:103], v7 offset:15360
    s_waitcnt lgkmcnt(2)
    v_mfma_f32_32x32x16_bf16 v[40:55], v[88:91], v[16:19], 0
    v_exp_f32 v24, v24
    v_exp_f32 v25, v25
    v_exp_f32 v26, v26
    v_exp_f32 v27, v27
    v_mfma_f32_32x32x16_bf16 v[40:55], v[92:95], v[20:23], v[40:55]
    s_cmp_ge_u32 s32, 7
    s_cbranch_scc1 K2_Q7_10
    s_add_u32 s40, s44, 28672
    buffer_load_dwordx4 v[120:123], v6, s[28:31], s40 offen
    s_branch K2_QJ_10
K2_Q7_10:
    s_add_u32 s40, s52, 58368
    buffer_load_dwordx4 v[104:107], v10, s[20:23], s40 offen
K2_QJ_10:
    v_exp_f32 v28, v28
    v_exp_f32 v29, v29
    v_exp_f32 v30, v30
    v_exp_f32 v31, v31
    s_waitcnt lgkmcnt(0)
    v_mfma_f32_32x32x16_bf16 v[64:79], v[96:99], v[232:235], v[64:79]
    s_cmp_ge_u32 s32, 7
    s_cbranch_scc1 K2_Q7_11
    s_add_u32 s40, s44, 29696
    buffer_load_dwordx4 v[124:127], v6, s[28:31], s40 offen
    s_branch K2_QJ_11
K2_Q7_11:
    s_add_u32 s40, s52, 87040
    buffer_load_dwordx4 v[108:111], v10, s[20:23], s40 offen
K2_QJ_11:
    v_exp_f32 v32, v32
    v_exp_f32 v33, v33
    v_exp_f32 v34, v34
    v_exp_f32 v35, v35
    v_mfma_f32_32x32x16_bf16 v[64:79], v[100:103], v[236:239], v[64:79]
    ds_read_b128 v[80:83], v7 offset:24576
    ds_read_b128 v[84:87], v7 offset:25600
    s_cmp_ge_u32 s32, 7
    s_cbranch_scc1 K2_Q7_12
    s_add_u32 s40, s44, 30720
    buffer_load_dwordx4 v[128:131], v6, s[28:31], s40 offen
    s_branch K2_QJ_12
K2_Q7_12:
    s_add_u32 s40, s52, 115712
    buffer_load_dwordx4 v[112:115], v10, s[20:23], s40 offen
K2_QJ_12:
    v_exp_f32 v36, v36
    v_exp_f32 v37, v37
    v_exp_f32 v38, v38
    v_exp_f32 v39, v39
    v_cvt_pk_bf16_f32 v56, v24, v25
    v_cvt_pk_bf16_f32 v57, v26, v27
    v_cvt_pk_bf16_f32 v58, v28, v29
    v_cvt_pk_bf16_f32 v59, v30, v31
    v_cvt_pk_bf16_f32 v60, v32, v33
    v_cvt_pk_bf16_f32 v61, v34, v35
    v_cvt_pk_bf16_f32 v62, v36, v37
    v_cvt_pk_bf16_f32 v63, v38, v39
    ds_read_b128 v[96:99], v7 offset:20480
    ds_read_b128 v[100:103], v7 offset:21504
    s_waitcnt lgkmcnt(2)
    v_mfma_f32_32x32x16_bf16 v[24:39], v[80:83], v[16:19], 0
    v_exp_f32 v40, v40
    v_exp_f32 v41, v41
    v_exp_f32 v42, v42
    v_exp_f32 v43, v43
    v_mfma_f32_32x32x16_bf16 v[24:39], v[84:87], v[20:23], v[24:39]
    s_cmp_ge_u32 s32, 7
    s_cbranch_scc1 K2_Q7_13
    s_add_u32 s40, s44, 31744
    buffer_load_dwordx4 v[132:135], v6, s[28:31], s40 offen
    s_branch K2_QJ_13
K2_Q7_13:
    s_add_u32 s40, s52, 144384
    buffer_load_dwordx4 v[116:119], v10, s[20:23], s40 offen
K2_QJ_13:
    v_exp_f32 v44, v44
    v_exp_f32 v45, v45
    v_exp_f32 v46, v46
    v_exp_f32 v47, v47
    s_waitcnt lgkmcnt(0)
    v_mfma_f32_32x32x16_bf16 v[64:79], v[96:99], v[56:59], v[64:79]
    s_cmp_ge_u32 s32, 7
    s_cbranch_scc1 K2_Q7_14
    s_branch K2_QJ_14
K2_Q7_14:
    s_add_u32 s40, s52, 173056
    buffer_load_dwordx4 v[120:123], v10, s[20:23], s40 offen
K2_QJ_14:
    v_exp_f32 v48, v48
    v_exp_f32 v49, v49
    v_exp_f32 v50, v50
    v_exp_f32 v51, v51
    v_mfma_f32_32x32x16_bf16 v[64:79], v[100:103], v[60:63], v[64:79]
    ds_read_b128 v[88:91], v7 offset:26624
    ds_read_b128 v[92:95], v7 offset:27648
    v_exp_f32 v52, v52
    v_exp_f32 v53, v53
    v_exp_f32 v54, v54
    v_exp_f32 v55, v55
    v_cvt_pk_bf16_f32 v232, v40, v41
    v_cvt_pk_bf16_f32 v233, v42, v43
    v_cvt_pk_bf16_f32 v234, v44, v45
    v_cvt_pk_bf16_f32 v235, v46, v47
    v_cvt_pk_bf16_f32 v236, v48, v49
    v_cvt_pk_bf16_f32 v237, v50, v51
    v_cvt_pk_bf16_f32 v238, v52, v53
    v_cvt_pk_bf16_f32 v239, v54, v55
    s_cmp_ge_u32 s32, 7
    s_cbranch_scc1 K2F_W7_3
    s_waitcnt vmcnt(4)
    s_branch K2F_WJ_3
K2F_W7_3:
    s_waitcnt vmcnt(5)
K2F_WJ_3:
    s_barrier
    s_add_u32 s40, s39, 8192
    s_add_u32 s41, s38, 2117632
    s_mov_b32 m0, s40
    s_nop 0
    buffer_load_dwordx4 v6, s[28:31], s41 offen lds
    s_add_u32 s40, s39, 12288
    s_add_u32 s41, s38, 2248704
    s_mov_b32 m0, s40
    s_nop 0
    buffer_load_dwordx4 v6, s[28:31], s41 offen lds
    ds_read_b128 v[96:99], v7 offset:22528
    ds_read_b128 v[100:103], v7 offset:23552
    s_waitcnt lgkmcnt(2)
    v_mfma_f32_32x32x16_bf16 v[40:55], v[88:91], v[16:19], 0
    v_exp_f32 v24, v24
    v_exp_f32 v25, v25
    v_exp_f32 v26, v26
    v_exp_f32 v27, v27
    v_mfma_f32_32x32x16_bf16 v[40:55], v[92:95], v[20:23], v[40:55]
    s_cmp_ge_u32 s32, 7
    s_cbranch_scc1 K2_Q7_15
    s_add_u32 s40, s45, 28672
    s_add_u32 s41, s44, 258048
    s_mov_b32 m0, s40
    s_nop 0
    buffer_load_dwordx4 v6, s[28:31], s41 offen lds
    s_branch K2_QJ_15
K2_Q7_15:
    s_add_u32 s40, s52, 201728
    buffer_load_dwordx4 v[104:107], v10, s[20:23], s40 offen
K2_QJ_15:
    v_exp_f32 v28, v28
    v_exp_f32 v29, v29
    v_exp_f32 v30, v30
    v_exp_f32 v31, v31
    s_waitcnt lgkmcnt(0)
    v_mfma_f32_32x32x16_bf16 v[64:79], v[96:99], v[232:235], v[64:79]
    s_cmp_ge_u32 s32, 7
    s_cbranch_scc1 K2_Q7_16
    s_add_u32 s40, s45, 29696
    s_add_u32 s41, s44, 259072
    s_mov_b32 m0, s40
    s_nop 0
    buffer_load_dwordx4 v6, s[28:31], s41 offen lds
    s_branch K2_QJ_16
K2_Q7_16:
    s_add_u32 s40, s52, 2048
    buffer_load_dwordx4 v[108:111], v10, s[20:23], s40 offen
K2_QJ_16:
    v_exp_f32 v32, v32
    v_exp_f32 v33, v33
    v_exp_f32 v34, v34
    v_exp_f32 v35, v35
    v_mfma_f32_32x32x16_bf16 v[64:79], v[100:103], v[236:239], v[64:79]
    ds_read_b128 v[80:83], v7 offset:0
    ds_read_b128 v[84:87], v7 offset:1024
    s_cmp_ge_u32 s32, 7
    s_cbranch_scc1 K2_Q7_17
    s_add_u32 s40, s45, 30720
    s_add_u32 s41, s44, 260096
    s_mov_b32 m0, s40
    s_nop 0
    buffer_load_dwordx4 v6, s[28:31], s41 offen lds
    s_branch K2_QJ_17
K2_Q7_17:
    s_add_u32 s40, s52, 30720
    buffer_load_dwordx4 v[112:115], v10, s[20:23], s40 offen
K2_QJ_17:
    v_exp_f32 v36, v36
    v_exp_f32 v37, v37
    v_exp_f32 v38, v38
    v_exp_f32 v39, v39
    v_cvt_pk_bf16_f32 v56, v24, v25
    v_cvt_pk_bf16_f32 v57, v26, v27
    v_cvt_pk_bf16_f32 v58, v28, v29
    v_cvt_pk_bf16_f32 v59, v30, v31
    v_cvt_pk_bf16_f32 v60, v32, v33
    v_cvt_pk_bf16_f32 v61, v34, v35
    v_cvt_pk_bf16_f32 v62, v36, v37
    v_cvt_pk_bf16_f32 v63, v38, v39
    ds_read_b128 v[96:99], v7 offset:28672
    ds_read_b128 v[100:103], v7 offset:29696
    s_waitcnt lgkmcnt(2)
    v_mfma_f32_32x32x16_bf16 v[24:39], v[80:83], v[16:19], 0
    v_exp_f32 v40, v40
    v_exp_f32 v41, v41
    v_exp_f32 v42, v42
    v_exp_f32 v43, v43
    v_mfma_f32_32x32x16_bf16 v[24:39], v[84:87], v[20:23], v[24:39]
    s_cmp_ge_u32 s32, 7
    s_cbranch_scc1 K2_Q7_18
    s_add_u32 s40, s45, 31744
    s_add_u32 s41, s44, 261120
    s_mov_b32 m0, s40
    s_nop 0
    buffer_load_dwordx4 v6, s[28:31], s41 offen lds
    s_branch K2_QJ_18
K2_Q7_18:
    s_add_u32 s40, s52, 59392
    buffer_load_dwordx4 v[116:119], v10, s[20:23], s40 offen
K2_QJ_18:
    v_exp_f32 v44, v44
    v_exp_f32 v45, v45
    v_exp_f32 v46, v46
    v_exp_f32 v47, v47
    s_waitcnt lgkmcnt(0)
    v_mfma_f32_32x32x16_bf16 v[64:79], v[96:99], v[56:59], v[64:79]
    s_cmp_ge_u32 s32, 7
    s_cbranch_scc1 K2_Q7_19
    s_branch K2_QJ_19
K2_Q7_19:
    s_add_u32 s40, s52, 88064
    buffer_load_dwordx4 v[120:123], v10, s[20:23], s40 offen
K2_QJ_19:
    v_exp_f32 v48, v48
    v_exp_f32 v49, v49
    v_exp_f32 v50, v50
    v_exp_f32 v51, v51
    v_mfma_f32_32x32x16_bf16 v[64:79], v[100:103], v[60:63], v[64:79]
    ds_read_b128 v[88:91], v7 offset:2048
    ds_read_b128 v[92:95], v7 offset:3072
    v_exp_f32 v52, v52
    v_exp_f32 v53, v53
    v_exp_f32 v54, v54
    v_exp_f32 v55, v55
    v_cvt_pk_bf16_f32 v232, v40, v41
    v_cvt_pk_bf16_f32 v233, v42, v43
    v_cvt_pk_bf16_f32 v234, v44, v45
    v_cvt_pk_bf16_f32 v235, v46, v47
    v_cvt_pk_bf16_f32 v236, v48, v49
    v_cvt_pk_bf16_f32 v237, v50, v51
    v_cvt_pk_bf16_f32 v238, v52, v53
    v_cvt_pk_bf16_f32 v239, v54, v55
    s_cmp_ge_u32 s32, 7
    s_cbranch_scc1 K2F_W7_4
    s_waitcnt vmcnt(4)
    s_branch K2F_WJ_4
K2F_W7_4:
    s_waitcnt vmcnt(5)
K2F_WJ_4:
    s_barrier
    s_add_u32 s40, s39, 16384
    s_add_u32 s41, s38, 2121728
    s_mov_b32 m0, s40
    s_nop 0
    buffer_load_dwordx4 v6, s[28:31], s41 offen lds
    s_add_u32 s40, s39, 20480
    s_add_u32 s41, s38, 2252800
    s_mov_b32 m0, s40
    s_nop 0
    buffer_load_dwordx4 v6, s[28:31], s41 offen lds
    ds_read_b128 v[96:99], v7 offset:30720
    ds_read_b128 v[100:103], v7 offset:31744
    s_waitcnt lgkmcnt(2)
    v_mfma_f32_32x32x16_bf16 v[40:55], v[88:91], v[16:19], 0
    v_exp_f32 v24, v24
    v_exp_f32 v25, v25
    v_exp_f32 v26, v26
    v_exp_f32 v27, v27
    v_mfma_f32_32x32x16_bf16 v[40:55], v[92:95], v[20:23], v[40:55]
    s_cmp_ge_u32 s32, 7
    s_cbranch_scc1 K2_Q7_20
    s_add_u32 s40, s44, 57344
    buffer_load_dwordx4 v[136:139], v6, s[28:31], s40 offen
    s_branch K2_QJ_20
K2_Q7_20:
    s_add_u32 s40, s52, 116736
    buffer_load_dwordx4 v[104:107], v10, s[20:23], s40 offen
K2_QJ_20:
    v_exp_f32 v28, v28
    v_exp_f32 v29, v29
    v_exp_f32 v30, v30
    v_exp_f32 v31, v31
    s_waitcnt lgkmcnt(0)
    v_mfma_f32_32x32x16_bf16 v[64:79], v[96:99], v[232:235], v[64:79]
    s_cmp_ge_u32 s32, 7
    s_cbranch_scc1 K2_Q7_21
    s_add_u32 s40, s44, 58368
    buffer_load_dwordx4 v[140:143], v6, s[28:31], s40 offen
    s_branch K2_QJ_21
K2_Q7_21:
    s_add_u32 s40, s52, 145408
    buffer_load_dwordx4 v[108:111], v10, s[20:23], s40 offen
K2_QJ_21:
    v_exp_f32 v32, v32
    v_exp_f32 v33, v33
    v_exp_f32 v34, v34
    v_exp_f32 v35, v35
    v_mfma_f32_32x32x16_bf16 v[64:79], v[100:103], v[236:239], v[64:79]
    ds_read_b128 v[80:83], v7 offset:8192
    ds_read_b128 v[84:87], v7 offset:9216
    s_cmp_ge_u32 s32, 7
    s_cbranch_scc1 K2_Q7_22
    s_add_u32 s40, s44, 59392
    buffer_load_dwordx4 v[144:147], v6, s[28:31], s40 offen
    s_branch K2_QJ_22
K2_Q7_22:
    s_add_u32 s40, s52, 174080
    buffer_load_dwordx4 v[112:115], v10, s[20:23], s40 offen
K2_QJ_22:
    v_exp_f32 v36, v36
    v_exp_f32 v37, v37
    v_exp_f32 v38, v38
    v_exp_f32 v39, v39
    v_cvt_pk_bf16_f32 v56, v24, v25
    v_cvt_pk_bf16_f32 v57, v26, v27
    v_cvt_pk_bf16_f32 v58, v28, v29
    v_cvt_pk_bf16_f32 v59, v30, v31
    v_cvt_pk_bf16_f32 v60, v32, v33
    v_cvt_pk_bf16_f32 v61, v34, v35
    v_cvt_pk_bf16_f32 v62, v36, v37
    v_cvt_pk_bf16_f32 v63, v38, v39
    ds_read_b128 v[96:99], v7 offset:4096
    ds_read_b128 v[100:103], v7 offset:5120
    s_waitcnt lgkmcnt(2)
    v_mfma_f32_32x32x16_bf16 v[24:39], v[80:83], v[16:19], 0
    v_exp_f32 v40, v40
    v_exp_f32 v41, v41
    v_exp_f32 v42, v42
    v_exp_f32 v43, v43
    v_mfma_f32_32x32x16_bf16 v[24:39], v[84:87], v[20:23], v[24:39]
    s_cmp_ge_u32 s32, 7
    s_cbranch_scc1 K2_Q7_23
    s_add_u32 s40, s44, 60416
    buffer_load_dwordx4 v[148:151], v6, s[28:31], s40 offen
    s_branch K2_QJ_23
K2_Q7_23:
    s_add_u32 s40, s52, 202752
    buffer_load_dwordx4 v[116:119], v10, s[20:23], s40 offen
K2_QJ_23:
    v_exp_f32 v44, v44
    v_exp_f32 v45, v45
    v_exp_f32 v46, v46
    v_exp_f32 v47, v47
    s_waitcnt lgkmcnt(0)
    v_mfma_f32_32x32x16_bf16 v[64:79], v[96:99], v[56:59], v[64:79]
    s_cmp_ge_u32 s32, 7
    s_cbranch_scc1 K2_Q7_24
    s_branch K2_QJ_24
K2_Q7_24:
    s_add_u32 s40, s52, 3072
    buffer_load_dwordx4 v[120:123], v10, s[20:23], s40 offen
K2_QJ_24:
    v_exp_f32 v48, v48
    v_exp_f32 v49, v49
    v_exp_f32 v50, v50
    v_exp_f32 v51, v51
    v_mfma_f32_32x32x16_bf16 v[64:79], v[100:103], v[60:63], v[64:79]
    ds_read_b128 v[88:91], v7 offset:10240
    ds_read_b128 v[92:95], v7 offset:11264
    v_exp_f32 v52, v52
    v_exp_f32 v53, v53
    v_exp_f32 v54, v54
    v_exp_f32 v55, v55
    v_cvt_pk_bf16_f32 v232, v40, v41
    v_cvt_pk_bf16_f32 v233, v42, v43
    v_cvt_pk_bf16_f32 v234, v44, v45
    v_cvt_pk_bf16_f32 v235, v46, v47
    v_cvt_pk_bf16_f32 v236, v48, v49
    v_cvt_pk_bf16_f32 v237, v50, v51
    v_cvt_pk_bf16_f32 v238, v52, v53
    v_cvt_pk_bf16_f32 v239, v54, v55
    s_cmp_ge_u32 s32, 7
    s_cbranch_scc1 K2F_W7_5
    s_waitcnt vmcnt(4)
    s_branch K2F_WJ_5
K2F_W7_5:
    s_waitcnt vmcnt(5)
K2F_WJ_5:
    s_barrier
    s_add_u32 s40, s39, 24576
    s_add_u32 s41, s38, 2125824
    s_mov_b32 m0, s40
    s_nop 0
    buffer_load_dwordx4 v6, s[28:31], s41 offen lds
    s_add_u32 s40, s39, 28672
    s_add_u32 s41, s38, 2256896
    s_mov_b32 m0, s40
    s_nop 0
    buffer_load_dwordx4 v6, s[28:31], s41 offen lds
    ds_read_b128 v[96:99], v7 offset:6144
    ds_read_b128 v[100:103], v7 offset:7168
    s_waitcnt lgkmcnt(2)
    v_mfma_f32_32x32x16_bf16 v[40:55], v[88:91], v[16:19], 0
    v_exp_f32 v24, v24
    v_exp_f32 v25, v25
    v_exp_f32 v26, v26
    v_exp_f32 v27, v27
    v_mfma_f32_32x32x16_bf16 v[40:55], v[92:95], v[20:23], v[40:55]
    s_cmp_ge_u32 s32, 7
    s_cbranch_scc1 K2_Q7_25
    s_add_u32 s40, s45, 57344
    s_add_u32 s41, s44, 286720
    s_mov_b32 m0, s40
    s_nop 0
    buffer_load_dwordx4 v6, s[28:31], s41 offen lds
    s_branch K2_QJ_25
K2_Q7_25:
    s_add_u32 s40, s52, 31744
    buffer_load_dwordx4 v[104:107], v10, s[20:23], s40 offen
K2_QJ_25:
    v_exp_f32 v28, v28
    v_exp_f32 v29, v29
    v_exp_f32 v30, v30
    v_exp_f32 v31, v31
    s_waitcnt lgkmcnt(0)
    v_mfma_f32_32x32x16_bf16 v[64:79], v[96:99], v[232:235], v[64:79]
    s_cmp_ge_u32 s32, 7
    s_cbranch_scc1 K2_Q7_26
    s_add_u32 s40, s45, 58368
    s_add_u32 s41, s44, 287744
    s_mov_b32 m0, s40
    s_nop 0
    buffer_load_dwordx4 v6, s[28:31], s41 offen lds
    s_branch K2_QJ_26
K2_Q7_26:
    s_add_u32 s40, s52, 60416
    buffer_load_dwordx4 v[108:111], v10, s[20:23], s40 offen
K2_QJ_26:
    v_exp_f32 v32, v32
    v_exp_f32 v33, v33
    v_exp_f32 v34, v34
    v_exp_f32 v35, v35
    v_mfma_f32_32x32x16_bf16 v[64:79], v[100:103], v[236:239], v[64:79]
    ds_read_b128 v[80:83], v7 offset:16384
    ds_read_b128 v[84:87], v7 offset:17408
    s_cmp_ge_u32 s32, 7
    s_cbranch_scc1 K2_Q7_27
    s_add_u32 s40, s45, 59392
    s_add_u32 s41, s44, 288768
    s_mov_b32 m0, s40
    s_nop 0
    buffer_load_dwordx4 v6, s[28:31], s41 offen lds
    s_branch K2_QJ_27
K2_Q7_27:
    s_add_u32 s40, s52, 89088
    buffer_load_dwordx4 v[112:115], v10, s[20:23], s40 offen
K2_QJ_27:
    v_exp_f32 v36, v36
    v_exp_f32 v37, v37
    v_exp_f32 v38, v38
    v_exp_f32 v39, v39
    v_cvt_pk_bf16_f32 v56, v24, v25
    v_cvt_pk_bf16_f32 v57, v26, v27
    v_cvt_pk_bf16_f32 v58, v28, v29
    v_cvt_pk_bf16_f32 v59, v30, v31
    v_cvt_pk_bf16_f32 v60, v32, v33
    v_cvt_pk_bf16_f32 v61, v34, v35
    v_cvt_pk_bf16_f32 v62, v36, v37
    v_cvt_pk_bf16_f32 v63, v38, v39
    ds_read_b128 v[96:99], v7 offset:12288
    ds_read_b128 v[100:103], v7 offset:13312
    s_waitcnt lgkmcnt(2)
    v_mfma_f32_32x32x16_bf16 v[24:39], v[80:83], v[16:19], 0
    v_exp_f32 v40, v40
    v_exp_f32 v41, v41
    v_exp_f32 v42, v42
    v_exp_f32 v43, v43
    v_mfma_f32_32x32x16_bf16 v[24:39], v[84:87], v[20:23], v[24:39]
    s_cmp_ge_u32 s32, 7
    s_cbranch_scc1 K2_Q7_28
    s_add_u32 s40, s45, 60416
    s_add_u32 s41, s44, 289792
    s_mov_b32 m0, s40
    s_nop 0
    buffer_load_dwordx4 v6, s[28:31], s41 offen lds
    s_branch K2_QJ_28
K2_Q7_28:
    s_add_u32 s40, s52, 117760
    buffer_load_dwordx4 v[116:119], v10, s[20:23], s40 offen
K2_QJ_28:
    v_exp_f32 v44, v44
    v_exp_f32 v45, v45
    v_exp_f32 v46, v46
    v_exp_f32 v47, v47
    s_waitcnt lgkmcnt(0)
    v_mfma_f32_32x32x16_bf16 v[64:79], v[96:99], v[56:59], v[64:79]
    s_cmp_ge_u32 s32, 7
    s_cbranch_scc1 K2_Q7_29
    s_branch K2_QJ_29
K2_Q7_29:
    s_add_u32 s40, s52, 146432
    buffer_load_dwordx4 v[120:123], v10, s[20:23], s40 offen
K2_QJ_29:
    v_exp_f32 v48, v48
    v_exp_f32 v49, v49
    v_exp_f32 v50, v50
    v_exp_f32 v51, v51
    v_mfma_f32_32x32x16_bf16 v[64:79], v[100:103], v[60:63], v[64:79]
    ds_read_b128 v[88:91], v7 offset:18432
    ds_read_b128 v[92:95], v7 offset:19456
    v_exp_f32 v52, v52
    v_exp_f32 v53, v53
    v_exp_f32 v54, v54
    v_exp_f32 v55, v55
    v_cvt_pk_bf16_f32 v232, v40, v41
    v_cvt_pk_bf16_f32 v233, v42, v43
    v_cvt_pk_bf16_f32 v234, v44, v45
    v_cvt_pk_bf16_f32 v235, v46, v47
    v_cvt_pk_bf16_f32 v236, v48, v49
    v_cvt_pk_bf16_f32 v237, v50, v51
    v_cvt_pk_bf16_f32 v238, v52, v53
    v_cvt_pk_bf16_f32 v239, v54, v55
    s_cmp_ge_u32 s32, 7
    s_cbranch_scc1 K2F_W7_6
    s_waitcnt vmcnt(4)
    s_branch K2F_WJ_6
K2F_W7_6:
    s_waitcnt vmcnt(5)
K2F_WJ_6:
    s_barrier
    s_add_u32 s40, s39, 0
    s_add_u32 s41, s38, 2129920
    s_mov_b32 m0, s40
    s_nop 0
    buffer_load_dwordx4 v6, s[28:31], s41 offen lds
    s_add_u32 s40, s39, 4096
    s_add_u32 s41, s38, 2260992
    s_mov_b32 m0, s40
    s_nop 0
    buffer_load_dwordx4 v6, s[28:31], s41 offen lds
    ds_read_b128 v[96:99], v7 offset:14336
    ds_read_b128 v[100:103], v7 offset:15360
    s_waitcnt lgkmcnt(2)
    v_mfma_f32_32x32x16_bf16 v[40:55], v[88:91], v[16:19], 0
    v_exp_f32 v24, v24
    v_exp_f32 v25, v25
    v_exp_f32 v26, v26
    v_exp_f32 v27, v27
    v_mfma_f32_32x32x16_bf16 v[40:55], v[92:95], v[20:23], v[40:55]
    s_cmp_ge_u32 s32, 7
    s_cbranch_scc1 K2_Q7_30
    s_add_u32 s40, s44, 86016
    buffer_load_dwordx4 v[152:155], v6, s[28:31], s40 offen
    s_branch K2_QJ_30
K2_Q7_30:
    s_add_u32 s40, s52, 175104
    buffer_load_dwordx4 v[104:107], v10, s[20:23], s40 offen
K2_QJ_30:
    v_exp_f32 v28, v28
    v_exp_f32 v29, v29
    v_exp_f32 v30, v30
    v_exp_f32 v31, v31
    s_waitcnt lgkmcnt(0)
    v_mfma_f32_32x32x16_bf16 v[64:79], v[96:99], v[232:235], v[64:79]
    s_cmp_ge_u32 s32, 7
    s_cbranch_scc1 K2_Q7_31
    s_add_u32 s40, s44, 87040
    buffer_load_dwordx4 v[156:159], v6, s[28:31], s40 offen
    s_branch K2_QJ_31
K2_Q7_31:
    s_add_u32 s40, s52, 203776
    buffer_load_dwordx4 v[108:111], v10, s[20:23], s40 offen
K2_QJ_31:
    v_exp_f32 v32, v32
    v_exp_f32 v33, v33
    v_exp_f32 v34, v34
    v_exp_f32 v35, v35
    v_mfma_f32_32x32x16_bf16 v[64:79], v[100:103], v[236:239], v[64:79]
    ds_read_b128 v[80:83], v7 offset:24576
    ds_read_b128 v[84:87], v7 offset:25600
    s_cmp_ge_u32 s32, 7
    s_cbranch_scc1 K2_Q7_32
    s_add_u32 s40, s44, 88064
    buffer_load_dwordx4 v[160:163], v6, s[28:31], s40 offen
    s_branch K2_QJ_32
K2_Q7_32:
    s_add_u32 s40, s53, 0
    buffer_load_dwordx4 v[112:115], v11, s[24:27], s40 offen
K2_QJ_32:
    v_exp_f32 v36, v36
    v_exp_f32 v37, v37
    v_exp_f32 v38, v38
    v_exp_f32 v39, v39
    v_cvt_pk_bf16_f32 v56, v24, v25
    v_cvt_pk_bf16_f32 v57, v26, v27
    v_cvt_pk_bf16_f32 v58, v28, v29
    v_cvt_pk_bf16_f32 v59, v30, v31
    v_cvt_pk_bf16_f32 v60, v32, v33
    v_cvt_pk_bf16_f32 v61, v34, v35
    v_cvt_pk_bf16_f32 v62, v36, v37
    v_cvt_pk_bf16_f32 v63, v38, v39
    ds_read_b128 v[96:99], v7 offset:20480
    ds_read_b128 v[100:103], v7 offset:21504
    s_waitcnt lgkmcnt(2)
    v_mfma_f32_32x32x16_bf16 v[24:39], v[80:83], v[16:19], 0
    v_exp_f32 v40, v40
    v_exp_f32 v41, v41
    v_exp_f32 v42, v42
    v_exp_f32 v43, v43
    v_mfma_f32_32x32x16_bf16 v[24:39], v[84:87], v[20:23], v[24:39]
    s_cmp_ge_u32 s32, 7
    s_cbranch_scc1 K2_Q7_33
    s_add_u32 s40, s44, 89088
    buffer_load_dwordx4 v[164:167], v6, s[28:31], s40 offen
    s_branch K2_QJ_33
K2_Q7_33:
    s_add_u32 s40, s53, 32768
    buffer_load_dwordx4 v[116:119], v11, s[24:27], s40 offen
K2_QJ_33:
    v_exp_f32 v44, v44
    v_exp_f32 v45, v45
    v_exp_f32 v46, v46
    v_exp_f32 v47, v47
    s_waitcnt lgkmcnt(0)
    v_mfma_f32_32x32x16_bf16 v[64:79], v[96:99], v[56:59], v[64:79]
    s_cmp_ge_u32 s32, 7
    s_cbranch_scc1 K2_Q7_34
    s_branch K2_QJ_34
K2_Q7_34:
    s_add_u32 s40, s53, 65536
    buffer_load_dwordx4 v[120:123], v11, s[24:27], s40 offen
K2_QJ_34:
    v_exp_f32 v48, v48
    v_exp_f32 v49, v49
    v_exp_f32 v50, v50
    v_exp_f32 v51, v51
    v_mfma_f32_32x32x16_bf16 v[64:79], v[100:103], v[60:63], v[64:79]
    ds_read_b128 v[88:91], v7 offset:26624
    ds_read_b128 v[92:95], v7 offset:27648
    v_exp_f32 v52, v52
    v_exp_f32 v53, v53
    v_exp_f32 v54, v54
    v_exp_f32 v55, v55
    v_cvt_pk_bf16_f32 v232, v40, v41
    v_cvt_pk_bf16_f32 v233, v42, v43
    v_cvt_pk_bf16_f32 v234, v44, v45
    v_cvt_pk_bf16_f32 v235, v46, v47
    v_cvt_pk_bf16_f32 v236, v48, v49
    v_cvt_pk_bf16_f32 v237, v50, v51
    v_cvt_pk_bf16_f32 v238, v52, v53
    v_cvt_pk_bf16_f32 v239, v54, v55
    s_cmp_ge_u32 s32, 7
    s_cbranch_scc1 K2F_W7_7
    s_waitcnt vmcnt(4)
    s_branch K2F_WJ_7
K2F_W7_7:
    s_waitcnt vmcnt(5)
K2F_WJ_7:
    s_barrier
    s_add_u32 s40, s39, 8192
    s_add_u32 s41, s38, 2134016
    s_mov_b32 m0, s40
    s_nop 0
    buffer_load_dwordx4 v6, s[28:31], s41 offen lds
    s_add_u32 s40, s39, 12288
    s_add_u32 s41, s38, 2265088
    s_mov_b32 m0, s40
    s_nop 0
    buffer_load_dwordx4 v6, s[28:31], s41 offen lds
    ds_read_b128 v[96:99], v7 offset:22528
    ds_read_b128 v[100:103], v7 offset:23552
    s_waitcnt lgkmcnt(2)
    v_mfma_f32_32x32x16_bf16 v[40:55], v[88:91], v[16:19], 0
    v_exp_f32 v24, v24
    v_exp_f32 v25, v25
    v_exp_f32 v26, v26
    v_exp_f32 v27, v27
    v_mfma_f32_32x32x16_bf16 v[40:55], v[92:95], v[20:23], v[40:55]
    s_cmp_ge_u32 s32, 7
    s_cbranch_scc1 K2_Q7_35
    s_branch K2_QJ_35
K2_Q7_35:
    s_add_u32 s40, s53, 98304
    buffer_load_dwordx4 v[104:107], v11, s[24:27], s40 offen
K2_QJ_35:
    v_exp_f32 v28, v28
    v_exp_f32 v29, v29
    v_exp_f32 v30, v30
    v_exp_f32 v31, v31
    s_waitcnt lgkmcnt(0)
    v_mfma_f32_32x32x16_bf16 v[64:79], v[96:99], v[232:235], v[64:79]
    s_cmp_ge_u32 s32, 7
    s_cbranch_scc1 K2_Q7_36
    s_branch K2_QJ_36
K2_Q7_36:
    s_add_u32 s40, s53, 131072
    buffer_load_dwordx4 v[108:111], v11, s[24:27], s40 offen
K2_QJ_36:
    v_exp_f32 v32, v32
    v_exp_f32 v33, v33
    v_exp_f32 v34, v34
    v_exp_f32 v35, v35
    v_mfma_f32_32x32x16_bf16 v[64:79], v[100:103], v[236:239], v[64:79]
    ds_read_b128 v[80:83], v7 offset:0
    ds_read_b128 v[84:87], v7 offset:1024
    s_cmp_ge_u32 s32, 7
    s_cbranch_scc1 K2_Q7_37
    s_branch K2_QJ_37
K2_Q7_37:
    s_add_u32 s40, s53, 163840
    buffer_load_dwordx4 v[112:115], v11, s[24:27], s40 offen
K2_QJ_37:
    v_exp_f32 v36, v36
    v_exp_f32 v37, v37
    v_exp_f32 v38, v38
    v_exp_f32 v39, v39
    v_cvt_pk_bf16_f32 v56, v24, v25
    v_cvt_pk_bf16_f32 v57, v26, v27
    v_cvt_pk_bf16_f32 v58, v28, v29
    v_cvt_pk_bf16_f32 v59, v30, v31
    v_cvt_pk_bf16_f32 v60, v32, v33
    v_cvt_pk_bf16_f32 v61, v34, v35
    v_cvt_pk_bf16_f32 v62, v36, v37
    v_cvt_pk_bf16_f32 v63, v38, v39
    ds_read_b128 v[96:99], v7 offset:28672
    ds_read_b128 v[100:103], v7 offset:29696
    s_waitcnt lgkmcnt(2)
    v_mfma_f32_32x32x16_bf16 v[24:39], v[80:83], v[16:19], 0
    v_exp_f32 v40, v40
    v_exp_f32 v41, v41
    v_exp_f32 v42, v42
    v_exp_f32 v43, v43
    v_mfma_f32_32x32x16_bf16 v[24:39], v[84:87], v[20:23], v[24:39]
    s_cmp_ge_u32 s32, 7
    s_cbranch_scc1 K2_Q7_38
    s_branch K2_QJ_38
K2_Q7_38:
    s_add_u32 s40, s53, 196608
    buffer_load_dwordx4 v[116:119], v11, s[24:27], s40 offen
K2_QJ_38:
    v_exp_f32 v44, v44
    v_exp_f32 v45, v45
    v_exp_f32 v46, v46
    v_exp_f32 v47, v47
    s_waitcnt lgkmcnt(0)
    v_mfma_f32_32x32x16_bf16 v[64:79], v[96:99], v[56:59], v[64:79]
    s_cmp_ge_u32 s32, 7
    s_cbranch_scc1 K2_Q7_39
    s_branch K2_QJ_39
K2_Q7_39:
    s_add_u32 s40, s53, 1024
    buffer_load_dwordx4 v[120:123], v11, s[24:27], s40 offen
K2_QJ_39:
    v_exp_f32 v48, v48
    v_exp_f32 v49, v49
    v_exp_f32 v50, v50
    v_exp_f32 v51, v51
    v_mfma_f32_32x32x16_bf16 v[64:79], v[100:103], v[60:63], v[64:79]
    ds_read_b128 v[88:91], v7 offset:2048
    ds_read_b128 v[92:95], v7 offset:3072
    v_exp_f32 v52, v52
    v_exp_f32 v53, v53
    v_exp_f32 v54, v54
    v_exp_f32 v55, v55
    v_cvt_pk_bf16_f32 v232, v40, v41
    v_cvt_pk_bf16_f32 v233, v42, v43
    v_cvt_pk_bf16_f32 v234, v44, v45
    v_cvt_pk_bf16_f32 v235, v46, v47
    v_cvt_pk_bf16_f32 v236, v48, v49
    v_cvt_pk_bf16_f32 v237, v50, v51
    v_cvt_pk_bf16_f32 v238, v52, v53
    v_cvt_pk_bf16_f32 v239, v54, v55
    s_cmp_ge_u32 s32, 7
    s_cbranch_scc1 K2F_W7_8
    s_waitcnt vmcnt(0)
    s_branch K2F_WJ_8
K2F_W7_8:
    s_waitcnt vmcnt(5)
K2F_WJ_8:
    s_barrier
    s_add_u32 s40, s39, 16384
    s_add_u32 s41, s38, 2138112
    s_mov_b32 m0, s40
    s_nop 0
    buffer_load_dwordx4 v6, s[28:31], s41 offen lds
    s_add_u32 s40, s39, 20480
    s_add_u32 s41, s38, 2269184
    s_mov_b32 m0, s40
    s_nop 0
    buffer_load_dwordx4 v6, s[28:31], s41 offen lds
    ds_read_b128 v[96:99], v7 offset:30720
    ds_read_b128 v[100:103], v7 offset:31744
    s_waitcnt lgkmcnt(2)
    v_mfma_f32_32x32x16_bf16 v[40:55], v[88:91], v[16:19], 0
    v_exp_f32 v24, v24
    v_exp_f32 v25, v25
    v_exp_f32 v26, v26
    v_exp_f32 v27, v27
    v_mfma_f32_32x32x16_bf16 v[40:55], v[92:95], v[20:23], v[40:55]
    s_cmp_ge_u32 s32, 7
    s_cbranch_scc1 K2_Q7_40
    s_add_u32 s40, s44, 114688
    buffer_load_dwordx4 v[168:171], v6, s[28:31], s40 offen
    s_branch K2_QJ_40
K2_Q7_40:
    s_add_u32 s40, s53, 33792
    buffer_load_dwordx4 v[104:107], v11, s[24:27], s40 offen
K2_QJ_40:
    v_exp_f32 v28, v28
    v_exp_f32 v29, v29
    v_exp_f32 v30, v30
    v_exp_f32 v31, v31
    s_waitcnt lgkmcnt(0)
    v_mfma_f32_32x32x16_bf16 v[64:79], v[96:99], v[232:235], v[64:79]
    s_cmp_ge_u32 s32, 7
    s_cbranch_scc1 K2_Q7_41
    s_add_u32 s40, s44, 115712
    buffer_load_dwordx4 v[172:175], v6, s[28:31], s40 offen
    s_branch K2_QJ_41
K2_Q7_41:
    s_add_u32 s40, s53, 66560
    buffer_load_dwordx4 v[108:111], v11, s[24:27], s40 offen
K2_QJ_41:
    v_exp_f32 v32, v32
    v_exp_f32 v33, v33
    v_exp_f32 v34, v34
    v_exp_f32 v35, v35
    v_mfma_f32_32x32x16_bf16 v[64:79], v[100:103], v[236:239], v[64:79]
    ds_read_b128 v[80:83], v7 offset:8192
    ds_read_b128 v[84:87], v7 offset:9216
    s_cmp_ge_u32 s32, 7
    s_cbranch_scc1 K2_Q7_42
    s_add_u32 s40, s44, 116736
    buffer_load_dwordx4 v[176:179], v6, s[28:31], s40 offen
    s_branch K2_QJ_42
K2_Q7_42:
    s_add_u32 s40, s53, 99328
    buffer_load_dwordx4 v[112:115], v11, s[24:27], s40 offen
K2_QJ_42:
    v_exp_f32 v36, v36
    v_exp_f32 v37, v37
    v_exp_f32 v38, v38
    v_exp_f32 v39, v39
    v_cvt_pk_bf16_f32 v56, v24, v25
    v_cvt_pk_bf16_f32 v57, v26, v27
    v_cvt_pk_bf16_f32 v58, v28, v29
    v_cvt_pk_bf16_f32 v59, v30, v31
    v_cvt_pk_bf16_f32 v60, v32, v33
    v_cvt_pk_bf16_f32 v61, v34, v35
    v_cvt_pk_bf16_f32 v62, v36, v37
    v_cvt_pk_bf16_f32 v63, v38, v39
    ds_read_b128 v[96:99], v7 offset:4096
    ds_read_b128 v[100:103], v7 offset:5120
    s_waitcnt lgkmcnt(2)
    v_mfma_f32_32x32x16_bf16 v[24:39], v[80:83], v[16:19], 0
    v_exp_f32 v40, v40
    v_exp_f32 v41, v41
    v_exp_f32 v42, v42
    v_exp_f32 v43, v43
    v_mfma_f32_32x32x16_bf16 v[24:39], v[84:87], v[20:23], v[24:39]
    s_cmp_ge_u32 s32, 7
    s_cbranch_scc1 K2_Q7_43
    s_add_u32 s40, s44, 117760
    buffer_load_dwordx4 v[180:183], v6, s[28:31], s40 offen
    s_branch K2_QJ_43
K2_Q7_43:
    s_add_u32 s40, s53, 132096
    buffer_load_dwordx4 v[116:119], v11, s[24:27], s40 offen
K2_QJ_43:
    v_exp_f32 v44, v44
    v_exp_f32 v45, v45
    v_exp_f32 v46, v46
    v_exp_f32 v47, v47
    s_waitcnt lgkmcnt(0)
    v_mfma_f32_32x32x16_bf16 v[64:79], v[96:99], v[56:59], v[64:79]
    s_cmp_ge_u32 s32, 7
    s_cbranch_scc1 K2_Q7_44
    s_branch K2_QJ_44
K2_Q7_44:
    s_add_u32 s40, s53, 164864
    buffer_load_dwordx4 v[120:123], v11, s[24:27], s40 offen
K2_QJ_44:
    v_exp_f32 v48, v48
    v_exp_f32 v49, v49
    v_exp_f32 v50, v50
    v_exp_f32 v51, v51
    v_mfma_f32_32x32x16_bf16 v[64:79], v[100:103], v[60:63], v[64:79]
    ds_read_b128 v[88:91], v7 offset:10240
    ds_read_b128 v[92:95], v7 offset:11264
    v_exp_f32 v52, v52
    v_exp_f32 v53, v53
    v_exp_f32 v54, v54
    v_exp_f32 v55, v55
    v_cvt_pk_bf16_f32 v232, v40, v41
    v_cvt_pk_bf16_f32 v233, v42, v43
    v_cvt_pk_bf16_f32 v234, v44, v45
    v_cvt_pk_bf16_f32 v235, v46, v47
    v_cvt_pk_bf16_f32 v236, v48, v49
    v_cvt_pk_bf16_f32 v237, v50, v51
    v_cvt_pk_bf16_f32 v238, v52, v53
    v_cvt_pk_bf16_f32 v239, v54, v55
    s_cmp_ge_u32 s32, 7
    s_cbranch_scc1 K2F_W7_9
    s_waitcnt vmcnt(4)
    s_branch K2F_WJ_9
K2F_W7_9:
    s_waitcnt vmcnt(5)
K2F_WJ_9:
    s_barrier
    s_add_u32 s40, s39, 24576
    s_add_u32 s41, s38, 2142208
    s_mov_b32 m0, s40
    s_nop 0
    buffer_load_dwordx4 v6, s[28:31], s41 offen lds
    s_add_u32 s40, s39, 28672
    s_add_u32 s41, s38, 2273280
    s_mov_b32 m0, s40
    s_nop 0
    buffer_load_dwordx4 v6, s[28:31], s41 offen lds
    ds_read_b128 v[96:99], v7 offset:6144
    ds_read_b128 v[100:103], v7 offset:7168
    s_waitcnt lgkmcnt(2)
    v_mfma_f32_32x32x16_bf16 v[40:55], v[88:91], v[16:19], 0
    v_exp_f32 v24, v24
    v_exp_f32 v25, v25
    v_exp_f32 v26, v26
    v_exp_f32 v27, v27
    v_mfma_f32_32x32x16_bf16 v[40:55], v[92:95], v[20:23], v[40:55]
    s_cmp_ge_u32 s32, 7
    s_cbranch_scc1 K2_Q7_45
    s_branch K2_QJ_45
K2_Q7_45:
    s_add_u32 s40, s53, 197632
    buffer_load_dwordx4 v[104:107], v11, s[24:27], s40 offen
K2_QJ_45:
    v_exp_f32 v28, v28
    v_exp_f32 v29, v29
    v_exp_f32 v30, v30
    v_exp_f32 v31, v31
    s_waitcnt lgkmcnt(0)
    v_mfma_f32_32x32x16_bf16 v[64:79], v[96:99], v[232:235], v[64:79]
    s_cmp_ge_u32 s32, 7
    s_cbranch_scc1 K2_Q7_46
    s_branch K2_QJ_46
K2_Q7_46:
    s_add_u32 s40, s53, 2048
    buffer_load_dwordx4 v[108:111], v11, s[24:27], s40 offen
K2_QJ_46:
    v_exp_f32 v32, v32
    v_exp_f32 v33, v33
    v_exp_f32 v34, v34
    v_exp_f32 v35, v35
    v_mfma_f32_32x32x16_bf16 v[64:79], v[100:103], v[236:239], v[64:79]
    ds_read_b128 v[80:83], v7 offset:16384
    ds_read_b128 v[84:87], v7 offset:17408
    s_cmp_ge_u32 s32, 7
    s_cbranch_scc1 K2_Q7_47
    s_branch K2_QJ_47
K2_Q7_47:
    s_add_u32 s40, s53, 34816
    buffer_load_dwordx4 v[112:115], v11, s[24:27], s40 offen
K2_QJ_47:
    v_exp_f32 v36, v36
    v_exp_f32 v37, v37
    v_exp_f32 v38, v38
    v_exp_f32 v39, v39
    v_cvt_pk_bf16_f32 v56, v24, v25
    v_cvt_pk_bf16_f32 v57, v26, v27
    v_cvt_pk_bf16_f32 v58, v28, v29
    v_cvt_pk_bf16_f32 v59, v30, v31
    v_cvt_pk_bf16_f32 v60, v32, v33
    v_cvt_pk_bf16_f32 v61, v34, v35
    v_cvt_pk_bf16_f32 v62, v36, v37
    v_cvt_pk_bf16_f32 v63, v38, v39
    ds_read_b128 v[96:99], v7 offset:12288
    ds_read_b128 v[100:103], v7 offset:13312
    s_waitcnt lgkmcnt(2)
    v_mfma_f32_32x32x16_bf16 v[24:39], v[80:83], v[16:19], 0
    v_exp_f32 v40, v40
    v_exp_f32 v41, v41
    v_exp_f32 v42, v42
    v_exp_f32 v43, v43
    v_mfma_f32_32x32x16_bf16 v[24:39], v[84:87], v[20:23], v[24:39]
    s_cmp_ge_u32 s32, 7
    s_cbranch_scc1 K2_Q7_48
    s_branch K2_QJ_48
K2_Q7_48:
    s_add_u32 s40, s53, 67584
    buffer_load_dwordx4 v[116:119], v11, s[24:27], s40 offen
K2_QJ_48:
    v_exp_f32 v44, v44
    v_exp_f32 v45, v45
    v_exp_f32 v46, v46
    v_exp_f32 v47, v47
    s_waitcnt lgkmcnt(0)
    v_mfma_f32_32x32x16_bf16 v[64:79], v[96:99], v[56:59], v[64:79]
    s_cmp_ge_u32 s32, 7
    s_cbranch_scc1 K2_Q7_49
    s_branch K2_QJ_49
K2_Q7_49:
    s_add_u32 s40, s53, 100352
    buffer_load_dwordx4 v[120:123], v11, s[24:27], s40 offen
K2_QJ_49:
    v_exp_f32 v48, v48
    v_exp_f32 v49, v49
    v_exp_f32 v50, v50
    v_exp_f32 v51, v51
    v_mfma_f32_32x32x16_bf16 v[64:79], v[100:103], v[60:63], v[64:79]
    ds_read_b128 v[88:91], v7 offset:18432
    ds_read_b128 v[92:95], v7 offset:19456
    v_exp_f32 v52, v52
    v_exp_f32 v53, v53
    v_exp_f32 v54, v54
    v_exp_f32 v55, v55
    v_cvt_pk_bf16_f32 v232, v40, v41
    v_cvt_pk_bf16_f32 v233, v42, v43
    v_cvt_pk_bf16_f32 v234, v44, v45
    v_cvt_pk_bf16_f32 v235, v46, v47
    v_cvt_pk_bf16_f32 v236, v48, v49
    v_cvt_pk_bf16_f32 v237, v50, v51
    v_cvt_pk_bf16_f32 v238, v52, v53
    v_cvt_pk_bf16_f32 v239, v54, v55
    s_cmp_ge_u32 s32, 7
    s_cbranch_scc1 K2F_W7_10
    s_waitcnt vmcnt(0)
    s_branch K2F_WJ_10
K2F_W7_10:
    s_waitcnt vmcnt(5)
K2F_WJ_10:
    s_barrier
    s_add_u32 s40, s39, 0
    s_add_u32 s41, s38, 2146304
    s_mov_b32 m0, s40
    s_nop 0
    buffer_load_dwordx4 v6, s[28:31], s41 offen lds
    s_add_u32 s40, s39, 4096
    s_add_u32 s41, s38, 2277376
    s_mov_b32 m0, s40
    s_nop 0
    buffer_load_dwordx4 v6, s[28:31], s41 offen lds
    ds_read_b128 v[96:99], v7 offset:14336
    ds_read_b128 v[100:103], v7 offset:15360
    s_waitcnt lgkmcnt(2)
    v_mfma_f32_32x32x16_bf16 v[40:55], v[88:91], v[16:19], 0
    v_exp_f32 v24, v24
    v_exp_f32 v25, v25
    v_exp_f32 v26, v26
    v_exp_f32 v27, v27
    v_mfma_f32_32x32x16_bf16 v[40:55], v[92:95], v[20:23], v[40:55]
    s_cmp_ge_u32 s32, 7
    s_cbranch_scc1 K2_Q7_50
    s_add_u32 s40, s44, 143360
    buffer_load_dwordx4 v[184:187], v6, s[28:31], s40 offen
    s_branch K2_QJ_50
K2_Q7_50:
    s_add_u32 s40, s53, 133120
    buffer_load_dwordx4 v[104:107], v11, s[24:27], s40 offen
K2_QJ_50:
    v_exp_f32 v28, v28
    v_exp_f32 v29, v29
    v_exp_f32 v30, v30
    v_exp_f32 v31, v31
    s_waitcnt lgkmcnt(0)
    v_mfma_f32_32x32x16_bf16 v[64:79], v[96:99], v[232:235], v[64:79]
    s_cmp_ge_u32 s32, 7
    s_cbranch_scc1 K2_Q7_51
    s_add_u32 s40, s44, 144384
    buffer_load_dwordx4 v[188:191], v6, s[28:31], s40 offen
    s_branch K2_QJ_51
K2_Q7_51:
    s_add_u32 s40, s53, 165888
    buffer_load_dwordx4 v[108:111], v11, s[24:27], s40 offen
K2_QJ_51:
    v_exp_f32 v32, v32
    v_exp_f32 v33, v33
    v_exp_f32 v34, v34
    v_exp_f32 v35, v35
    v_mfma_f32_32x32x16_bf16 v[64:79], v[100:103], v[236:239], v[64:79]
    ds_read_b128 v[80:83], v7 offset:24576
    ds_read_b128 v[84:87], v7 offset:25600
    s_cmp_ge_u32 s32, 7
    s_cbranch_scc1 K2_Q7_52
    s_add_u32 s40, s44, 145408
    buffer_load_dwordx4 v[192:195], v6, s[28:31], s40 offen
    s_branch K2_QJ_52
K2_Q7_52:
    s_add_u32 s40, s53, 198656
    buffer_load_dwordx4 v[112:115], v11, s[24:27], s40 offen
K2_QJ_52:
    v_exp_f32 v36, v36
    v_exp_f32 v37, v37
    v_exp_f32 v38, v38
    v_exp_f32 v39, v39
    v_cvt_pk_bf16_f32 v56, v24, v25
    v_cvt_pk_bf16_f32 v57, v26, v27
    v_cvt_pk_bf16_f32 v58, v28, v29
    v_cvt_pk_bf16_f32 v59, v30, v31
    v_cvt_pk_bf16_f32 v60, v32, v33
    v_cvt_pk_bf16_f32 v61, v34, v35
    v_cvt_pk_bf16_f32 v62, v36, v37
    v_cvt_pk_bf16_f32 v63, v38, v39
    ds_read_b128 v[96:99], v7 offset:20480
    ds_read_b128 v[100:103], v7 offset:21504
    s_waitcnt lgkmcnt(2)
    v_mfma_f32_32x32x16_bf16 v[24:39], v[80:83], v[16:19], 0
    v_exp_f32 v40, v40
    v_exp_f32 v41, v41
    v_exp_f32 v42, v42
    v_exp_f32 v43, v43
    v_mfma_f32_32x32x16_bf16 v[24:39], v[84:87], v[20:23], v[24:39]
    s_cmp_ge_u32 s32, 7
    s_cbranch_scc1 K2_Q7_53
    s_add_u32 s40, s44, 146432
    buffer_load_dwordx4 v[196:199], v6, s[28:31], s40 offen
    s_branch K2_QJ_53
K2_Q7_53:
    s_add_u32 s40, s53, 3072
    buffer_load_dwordx4 v[116:119], v11, s[24:27], s40 offen
K2_QJ_53:
    v_exp_f32 v44, v44
    v_exp_f32 v45, v45
    v_exp_f32 v46, v46
    v_exp_f32 v47, v47
    s_waitcnt lgkmcnt(0)
    v_mfma_f32_32x32x16_bf16 v[64:79], v[96:99], v[56:59], v[64:79]
    s_cmp_ge_u32 s32, 7
    s_cbranch_scc1 K2_Q7_54
    s_branch K2_QJ_54
K2_Q7_54:
    s_add_u32 s40, s53, 35840
    buffer_load_dwordx4 v[120:123], v11, s[24:27], s40 offen
K2_QJ_54:
    v_exp_f32 v48, v48
    v_exp_f32 v49, v49
    v_exp_f32 v50, v50
    v_exp_f32 v51, v51
    v_mfma_f32_32x32x16_bf16 v[64:79], v[100:103], v[60:63], v[64:79]
    ds_read_b128 v[88:91], v7 offset:26624
    ds_read_b128 v[92:95], v7 offset:27648
    v_exp_f32 v52, v52
    v_exp_f32 v53, v53
    v_exp_f32 v54, v54
    v_exp_f32 v55, v55
    v_cvt_pk_bf16_f32 v232, v40, v41
    v_cvt_pk_bf16_f32 v233, v42, v43
    v_cvt_pk_bf16_f32 v234, v44, v45
    v_cvt_pk_bf16_f32 v235, v46, v47
    v_cvt_pk_bf16_f32 v236, v48, v49
    v_cvt_pk_bf16_f32 v237, v50, v51
    v_cvt_pk_bf16_f32 v238, v52, v53
    v_cvt_pk_bf16_f32 v239, v54, v55
    s_cmp_ge_u32 s32, 7
    s_cbranch_scc1 K2F_W7_11
    s_waitcnt vmcnt(4)
    s_branch K2F_WJ_11
K2F_W7_11:
    s_waitcnt vmcnt(5)
K2F_WJ_11:
    s_barrier
    s_add_u32 s40, s39, 8192
    s_add_u32 s41, s38, 2150400
    s_mov_b32 m0, s40
    s_nop 0
    buffer_load_dwordx4 v6, s[28:31], s41 offen lds
    s_add_u32 s40, s39, 12288
    s_add_u32 s41, s38, 2281472
    s_mov_b32 m0, s40
    s_nop 0
    buffer_load_dwordx4 v6, s[28:31], s41 offen lds
    ds_read_b128 v[96:99], v7 offset:22528
    ds_read_b128 v[100:103], v7 offset:23552
    s_waitcnt lgkmcnt(2)
    v_mfma_f32_32x32x16_bf16 v[40:55], v[88:91], v[16:19], 0
    v_exp_f32 v24, v24
    v_exp_f32 v25, v25
    v_exp_f32 v26, v26
    v_exp_f32 v27, v27
    v_mfma_f32_32x32x16_bf16 v[40:55], v[92:95], v[20:23], v[40:55]
    s_cmp_ge_u32 s32, 7
    s_cbranch_scc1 K2_Q7_55
    s_branch K2_QJ_55
K2_Q7_55:
    s_add_u32 s40, s53, 68608
    buffer_load_dwordx4 v[104:107], v11, s[24:27], s40 offen
K2_QJ_55:
    v_exp_f32 v28, v28
    v_exp_f32 v29, v29
    v_exp_f32 v30, v30
    v_exp_f32 v31, v31
    s_waitcnt lgkmcnt(0)
    v_mfma_f32_32x32x16_bf16 v[64:79], v[96:99], v[232:235], v[64:79]
    s_cmp_ge_u32 s32, 7
    s_cbranch_scc1 K2_Q7_56
    s_branch K2_QJ_56
K2_Q7_56:
    s_add_u32 s40, s53, 101376
    buffer_load_dwordx4 v[108:111], v11, s[24:27], s40 offen
K2_QJ_56:
    v_exp_f32 v32, v32
    v_exp_f32 v33, v33
    v_exp_f32 v34, v34
    v_exp_f32 v35, v35
    v_mfma_f32_32x32x16_bf16 v[64:79], v[100:103], v[236:239], v[64:79]
    ds_read_b128 v[80:83], v7 offset:0
    ds_read_b128 v[84:87], v7 offset:1024
    s_cmp_ge_u32 s32, 7
    s_cbranch_scc1 K2_Q7_57
    s_branch K2_QJ_57
K2_Q7_57:
    s_add_u32 s40, s53, 134144
    buffer_load_dwordx4 v[112:115], v11, s[24:27], s40 offen
K2_QJ_57:
    v_exp_f32 v36, v36
    v_exp_f32 v37, v37
    v_exp_f32 v38, v38
    v_exp_f32 v39, v39
    v_cvt_pk_bf16_f32 v56, v24, v25
    v_cvt_pk_bf16_f32 v57, v26, v27
    v_cvt_pk_bf16_f32 v58, v28, v29
    v_cvt_pk_bf16_f32 v59, v30, v31
    v_cvt_pk_bf16_f32 v60, v32, v33
    v_cvt_pk_bf16_f32 v61, v34, v35
    v_cvt_pk_bf16_f32 v62, v36, v37
    v_cvt_pk_bf16_f32 v63, v38, v39
    ds_read_b128 v[96:99], v7 offset:28672
    ds_read_b128 v[100:103], v7 offset:29696
    s_waitcnt lgkmcnt(2)
    v_mfma_f32_32x32x16_bf16 v[24:39], v[80:83], v[16:19], 0
    v_exp_f32 v40, v40
    v_exp_f32 v41, v41
    v_exp_f32 v42, v42
    v_exp_f32 v43, v43
    v_mfma_f32_32x32x16_bf16 v[24:39], v[84:87], v[20:23], v[24:39]
    s_cmp_ge_u32 s32, 7
    s_cbranch_scc1 K2_Q7_58
    s_branch K2_QJ_58
K2_Q7_58:
    s_add_u32 s40, s53, 166912
    buffer_load_dwordx4 v[116:119], v11, s[24:27], s40 offen
K2_QJ_58:
    v_exp_f32 v44, v44
    v_exp_f32 v45, v45
    v_exp_f32 v46, v46
    v_exp_f32 v47, v47
    s_waitcnt lgkmcnt(0)
    v_mfma_f32_32x32x16_bf16 v[64:79], v[96:99], v[56:59], v[64:79]
    s_cmp_ge_u32 s32, 7
    s_cbranch_scc1 K2_Q7_59
    s_branch K2_QJ_59
K2_Q7_59:
    s_add_u32 s40, s53, 199680
    buffer_load_dwordx4 v[120:123], v11, s[24:27], s40 offen
K2_QJ_59:
    v_exp_f32 v48, v48
    v_exp_f32 v49, v49
    v_exp_f32 v50, v50
    v_exp_f32 v51, v51
    v_mfma_f32_32x32x16_bf16 v[64:79], v[100:103], v[60:63], v[64:79]
    ds_read_b128 v[88:91], v7 offset:2048
    ds_read_b128 v[92:95], v7 offset:3072
    v_exp_f32 v52, v52
    v_exp_f32 v53, v53
    v_exp_f32 v54, v54
    v_exp_f32 v55, v55
    v_cvt_pk_bf16_f32 v232, v40, v41
    v_cvt_pk_bf16_f32 v233, v42, v43
    v_cvt_pk_bf16_f32 v234, v44, v45
    v_cvt_pk_bf16_f32 v235, v46, v47
    v_cvt_pk_bf16_f32 v236, v48, v49
    v_cvt_pk_bf16_f32 v237, v50, v51
    v_cvt_pk_bf16_f32 v238, v52, v53
    v_cvt_pk_bf16_f32 v239, v54, v55
    s_cmp_ge_u32 s32, 7
    s_cbranch_scc1 K2F_W7_12
    s_waitcnt vmcnt(0)
    s_branch K2F_WJ_12
K2F_W7_12:
    s_waitcnt vmcnt(5)
K2F_WJ_12:
    s_barrier
    s_add_u32 s40, s39, 16384
    s_add_u32 s41, s38, 2154496
    s_mov_b32 m0, s40
    s_nop 0
    buffer_load_dwordx4 v6, s[28:31], s41 offen lds
    s_add_u32 s40, s39, 20480
    s_add_u32 s41, s38, 2285568
    s_mov_b32 m0, s40
    s_nop 0
    buffer_load_dwordx4 v6, s[28:31], s41 offen lds
    ds_read_b128 v[96:99], v7 offset:30720
    ds_read_b128 v[100:103], v7 offset:31744
    s_waitcnt lgkmcnt(2)
    v_mfma_f32_32x32x16_bf16 v[40:55], v[88:91], v[16:19], 0
    v_exp_f32 v24, v24
    v_exp_f32 v25, v25
    v_exp_f32 v26, v26
    v_exp_f32 v27, v27
    v_mfma_f32_32x32x16_bf16 v[40:55], v[92:95], v[20:23], v[40:55]
    s_cmp_ge_u32 s32, 7
    s_cbranch_scc1 K2_Q7_60
    s_add_u32 s40, s44, 172032
    buffer_load_dwordx4 v[200:203], v6, s[28:31], s40 offen
    s_branch K2_QJ_60
K2_Q7_60:
K2_QJ_60:
    v_exp_f32 v28, v28
    v_exp_f32 v29, v29
    v_exp_f32 v30, v30
    v_exp_f32 v31, v31
    s_waitcnt lgkmcnt(0)
    v_mfma_f32_32x32x16_bf16 v[64:79], v[96:99], v[232:235], v[64:79]
    s_cmp_ge_u32 s32, 7
    s_cbranch_scc1 K2_Q7_61
    s_add_u32 s40, s44, 173056
    buffer_load_dwordx4 v[204:207], v6, s[28:31], s40 offen
    s_branch K2_QJ_61
K2_Q7_61:
K2_QJ_61:
    v_exp_f32 v32, v32
    v_exp_f32 v33, v33
    v_exp_f32 v34, v34
    v_exp_f32 v35, v35
    v_mfma_f32_32x32x16_bf16 v[64:79], v[100:103], v[236:239], v[64:79]
    ds_read_b128 v[80:83], v7 offset:8192
    ds_read_b128 v[84:87], v7 offset:9216
    s_cmp_ge_u32 s32, 7
    s_cbranch_scc1 K2_Q7_62
    s_add_u32 s40, s44, 174080
    buffer_load_dwordx4 v[208:211], v6, s[28:31], s40 offen
    s_branch K2_QJ_62
K2_Q7_62:
K2_QJ_62:
    v_exp_f32 v36, v36
    v_exp_f32 v37, v37
    v_exp_f32 v38, v38
    v_exp_f32 v39, v39
    v_cvt_pk_bf16_f32 v56, v24, v25
    v_cvt_pk_bf16_f32 v57, v26, v27
    v_cvt_pk_bf16_f32 v58, v28, v29
    v_cvt_pk_bf16_f32 v59, v30, v31
    v_cvt_pk_bf16_f32 v60, v32, v33
    v_cvt_pk_bf16_f32 v61, v34, v35
    v_cvt_pk_bf16_f32 v62, v36, v37
    v_cvt_pk_bf16_f32 v63, v38, v39
    ds_read_b128 v[96:99], v7 offset:4096
    ds_read_b128 v[100:103], v7 offset:5120
    s_waitcnt lgkmcnt(2)
    v_mfma_f32_32x32x16_bf16 v[24:39], v[80:83], v[16:19], 0
    v_exp_f32 v40, v40
    v_exp_f32 v41, v41
    v_exp_f32 v42, v42
    v_exp_f32 v43, v43
    v_mfma_f32_32x32x16_bf16 v[24:39], v[84:87], v[20:23], v[24:39]
    s_cmp_ge_u32 s32, 7
    s_cbranch_scc1 K2_Q7_63
    s_add_u32 s40, s44, 175104
    buffer_load_dwordx4 v[212:215], v6, s[28:31], s40 offen
    s_branch K2_QJ_63
K2_Q7_63:
K2_QJ_63:
    v_exp_f32 v44, v44
    v_exp_f32 v45, v45
    v_exp_f32 v46, v46
    v_exp_f32 v47, v47
    s_waitcnt lgkmcnt(0)
    v_mfma_f32_32x32x16_bf16 v[64:79], v[96:99], v[56:59], v[64:79]
    v_exp_f32 v48, v48
    v_exp_f32 v49, v49
    v_exp_f32 v50, v50
    v_exp_f32 v51, v51
    v_mfma_f32_32x32x16_bf16 v[64:79], v[100:103], v[60:63], v[64:79]
    ds_read_b128 v[88:91], v7 offset:10240
    ds_read_b128 v[92:95], v7 offset:11264
    v_exp_f32 v52, v52
    v_exp_f32 v53, v53
    v_exp_f32 v54, v54
    v_exp_f32 v55, v55
    v_cvt_pk_bf16_f32 v232, v40, v41
    v_cvt_pk_bf16_f32 v233, v42, v43
    v_cvt_pk_bf16_f32 v234, v44, v45
    v_cvt_pk_bf16_f32 v235, v46, v47
    v_cvt_pk_bf16_f32 v236, v48, v49
    v_cvt_pk_bf16_f32 v237, v50, v51
    v_cvt_pk_bf16_f32 v238, v52, v53
    v_cvt_pk_bf16_f32 v239, v54, v55
    s_cmp_ge_u32 s32, 7
    s_cbranch_scc1 K2F_W7_13
    s_waitcnt vmcnt(4)
    s_branch K2F_WJ_13
K2F_W7_13:
    s_waitcnt vmcnt(0)
K2F_WJ_13:
    s_barrier
    s_add_u32 s40, s39, 24576
    s_add_u32 s41, s38, 2158592
    s_mov_b32 m0, s40
    s_nop 0
    buffer_load_dwordx4 v6, s[28:31], s41 offen lds
    s_add_u32 s40, s39, 28672
    s_add_u32 s41, s38, 2289664
    s_mov_b32 m0, s40
    s_nop 0
    buffer_load_dwordx4 v6, s[28:31], s41 offen lds
    ds_read_b128 v[96:99], v7 offset:6144
    ds_read_b128 v[100:103], v7 offset:7168
    s_waitcnt lgkmcnt(2)
    v_mfma_f32_32x32x16_bf16 v[40:55], v[88:91], v[16:19], 0
    v_exp_f32 v24, v24
    v_exp_f32 v25, v25
    v_exp_f32 v26, v26
    v_exp_f32 v27, v27
    v_mfma_f32_32x32x16_bf16 v[40:55], v[92:95], v[20:23], v[40:55]
    s_cmp_ge_u32 s32, 7
    s_cbranch_scc1 K2_Q7_64
    s_add_u32 s40, s44, 200704
    buffer_load_dwordx4 v[240:243], v6, s[28:31], s40 offen
    s_branch K2_QJ_64
K2_Q7_64:
K2_QJ_64:
    v_exp_f32 v28, v28
    v_exp_f32 v29, v29
    v_exp_f32 v30, v30
    v_exp_f32 v31, v31
    s_waitcnt lgkmcnt(0)
    v_mfma_f32_32x32x16_bf16 v[64:79], v[96:99], v[232:235], v[64:79]
    s_cmp_ge_u32 s32, 7
    s_cbranch_scc1 K2_Q7_65
    s_add_u32 s40, s44, 201728
    buffer_load_dwordx4 v[244:247], v6, s[28:31], s40 offen
    s_branch K2_QJ_65
K2_Q7_65:
K2_QJ_65:
    v_exp_f32 v32, v32
    v_exp_f32 v33, v33
    v_exp_f32 v34, v34
    v_exp_f32 v35, v35
    v_mfma_f32_32x32x16_bf16 v[64:79], v[100:103], v[236:239], v[64:79]
    ds_read_b128 v[80:83], v7 offset:16384
    ds_read_b128 v[84:87], v7 offset:17408
    s_cmp_ge_u32 s32, 7
    s_cbranch_scc1 K2_Q7_66
    s_add_u32 s40, s44, 202752
    buffer_load_dwordx4 v[248:251], v6, s[28:31], s40 offen
    s_branch K2_QJ_66
K2_Q7_66:
K2_QJ_66:
    v_exp_f32 v36, v36
    v_exp_f32 v37, v37
    v_exp_f32 v38, v38
    v_exp_f32 v39, v39
    v_cvt_pk_bf16_f32 v56, v24, v25
    v_cvt_pk_bf16_f32 v57, v26, v27
    v_cvt_pk_bf16_f32 v58, v28, v29
    v_cvt_pk_bf16_f32 v59, v30, v31
    v_cvt_pk_bf16_f32 v60, v32, v33
    v_cvt_pk_bf16_f32 v61, v34, v35
    v_cvt_pk_bf16_f32 v62, v36, v37
    v_cvt_pk_bf16_f32 v63, v38, v39
    ds_read_b128 v[96:99], v7 offset:12288
    ds_read_b128 v[100:103], v7 offset:13312
    s_waitcnt lgkmcnt(2)
    v_mfma_f32_32x32x16_bf16 v[24:39], v[80:83], v[16:19], 0
    v_exp_f32 v40, v40
    v_exp_f32 v41, v41
    v_exp_f32 v42, v42
    v_exp_f32 v43, v43
    v_mfma_f32_32x32x16_bf16 v[24:39], v[84:87], v[20:23], v[24:39]
    s_cmp_ge_u32 s32, 7
    s_cbranch_scc1 K2_Q7_67
    s_add_u32 s40, s44, 203776
    buffer_load_dwordx4 v[252:255], v6, s[28:31], s40 offen
    s_branch K2_QJ_67
K2_Q7_67:
K2_QJ_67:
    v_exp_f32 v44, v44
    v_exp_f32 v45, v45
    v_exp_f32 v46, v46
    v_exp_f32 v47, v47
    s_waitcnt lgkmcnt(0)
    v_mfma_f32_32x32x16_bf16 v[64:79], v[96:99], v[56:59], v[64:79]
    v_exp_f32 v48, v48
    v_exp_f32 v49, v49
    v_exp_f32 v50, v50
    v_exp_f32 v51, v51
    v_mfma_f32_32x32x16_bf16 v[64:79], v[100:103], v[60:63], v[64:79]
    ds_read_b128 v[88:91], v7 offset:18432
    ds_read_b128 v[92:95], v7 offset:19456
    v_exp_f32 v52, v52
    v_exp_f32 v53, v53
    v_exp_f32 v54, v54
    v_exp_f32 v55, v55
    v_cvt_pk_bf16_f32 v232, v40, v41
    v_cvt_pk_bf16_f32 v233, v42, v43
    v_cvt_pk_bf16_f32 v234, v44, v45
    v_cvt_pk_bf16_f32 v235, v46, v47
    v_cvt_pk_bf16_f32 v236, v48, v49
    v_cvt_pk_bf16_f32 v237, v50, v51
    v_cvt_pk_bf16_f32 v238, v52, v53
    v_cvt_pk_bf16_f32 v239, v54, v55
    s_cmp_ge_u32 s32, 7
    s_cbranch_scc1 K2F_W7_14
    s_waitcnt vmcnt(4)
    s_branch K2F_WJ_14
K2F_W7_14:
    s_waitcnt vmcnt(0)
K2F_WJ_14:
    s_barrier
    ds_read_b128 v[96:99], v7 offset:14336
    ds_read_b128 v[100:103], v7 offset:15360
    s_waitcnt lgkmcnt(2)
    v_mfma_f32_32x32x16_bf16 v[40:55], v[88:91], v[16:19], 0
    v_exp_f32 v24, v24
    v_exp_f32 v25, v25
    v_exp_f32 v26, v26
    v_exp_f32 v27, v27
    v_mfma_f32_32x32x16_bf16 v[40:55], v[92:95], v[20:23], v[40:55]
    v_exp_f32 v28, v28
    v_exp_f32 v29, v29
    v_exp_f32 v30, v30
    v_exp_f32 v31, v31
    s_waitcnt lgkmcnt(0)
    v_mfma_f32_32x32x16_bf16 v[64:79], v[96:99], v[232:235], v[64:79]
    v_exp_f32 v32, v32
    v_exp_f32 v33, v33
    v_exp_f32 v34, v34
    v_exp_f32 v35, v35
    v_mfma_f32_32x32x16_bf16 v[64:79], v[100:103], v[236:239], v[64:79]
    ds_read_b128 v[80:83], v7 offset:24576
    ds_read_b128 v[84:87], v7 offset:25600
    v_exp_f32 v36, v36
    v_exp_f32 v37, v37
    v_exp_f32 v38, v38
    v_exp_f32 v39, v39
    v_cvt_pk_bf16_f32 v56, v24, v25
    v_cvt_pk_bf16_f32 v57, v26, v27
    v_cvt_pk_bf16_f32 v58, v28, v29
    v_cvt_pk_bf16_f32 v59, v30, v31
    v_cvt_pk_bf16_f32 v60, v32, v33
    v_cvt_pk_bf16_f32 v61, v34, v35
    v_cvt_pk_bf16_f32 v62, v36, v37
    v_cvt_pk_bf16_f32 v63, v38, v39
    ds_read_b128 v[96:99], v7 offset:20480
    ds_read_b128 v[100:103], v7 offset:21504
    s_waitcnt lgkmcnt(2)
    v_mfma_f32_32x32x16_bf16 v[24:39], v[80:83], v[16:19], 0
    v_exp_f32 v40, v40
    v_exp_f32 v41, v41
    v_exp_f32 v42, v42
    v_exp_f32 v43, v43
    v_mfma_f32_32x32x16_bf16 v[24:39], v[84:87], v[20:23], v[24:39]
    v_exp_f32 v44, v44
    v_exp_f32 v45, v45
    v_exp_f32 v46, v46
    v_exp_f32 v47, v47
    s_waitcnt lgkmcnt(0)
    v_mfma_f32_32x32x16_bf16 v[64:79], v[96:99], v[56:59], v[64:79]
    v_exp_f32 v48, v48
    v_exp_f32 v49, v49
    v_exp_f32 v50, v50
    v_exp_f32 v51, v51
    v_mfma_f32_32x32x16_bf16 v[64:79], v[100:103], v[60:63], v[64:79]
    ds_read_b128 v[88:91], v7 offset:26624
    ds_read_b128 v[92:95], v7 offset:27648
    v_exp_f32 v52, v52
    v_exp_f32 v53, v53
    v_exp_f32 v54, v54
    v_exp_f32 v55, v55
    v_cvt_pk_bf16_f32 v232, v40, v41
    v_cvt_pk_bf16_f32 v233, v42, v43
    v_cvt_pk_bf16_f32 v234, v44, v45
    v_cvt_pk_bf16_f32 v235, v46, v47
    v_cvt_pk_bf16_f32 v236, v48, v49
    v_cvt_pk_bf16_f32 v237, v50, v51
    v_cvt_pk_bf16_f32 v238, v52, v53
    v_cvt_pk_bf16_f32 v239, v54, v55
    s_barrier
    ds_read_b128 v[96:99], v7 offset:22528
    ds_read_b128 v[100:103], v7 offset:23552
    s_waitcnt lgkmcnt(2)
    v_mfma_f32_32x32x16_bf16 v[40:55], v[88:91], v[16:19], 0
    v_exp_f32 v24, v24
    v_exp_f32 v25, v25
    v_exp_f32 v26, v26
    v_exp_f32 v27, v27
    v_mfma_f32_32x32x16_bf16 v[40:55], v[92:95], v[20:23], v[40:55]
    v_exp_f32 v28, v28
    v_exp_f32 v29, v29
    v_exp_f32 v30, v30
    v_exp_f32 v31, v31
    s_waitcnt lgkmcnt(0)
    v_mfma_f32_32x32x16_bf16 v[64:79], v[96:99], v[232:235], v[64:79]
    v_exp_f32 v32, v32
    v_exp_f32 v33, v33
    v_exp_f32 v34, v34
    v_exp_f32 v35, v35
    v_mfma_f32_32x32x16_bf16 v[64:79], v[100:103], v[236:239], v[64:79]
    v_exp_f32 v36, v36
    v_exp_f32 v37, v37
    v_exp_f32 v38, v38
    v_exp_f32 v39, v39
    v_cvt_pk_bf16_f32 v56, v24, v25
    v_cvt_pk_bf16_f32 v57, v26, v27
    v_cvt_pk_bf16_f32 v58, v28, v29
    v_cvt_pk_bf16_f32 v59, v30, v31
    v_cvt_pk_bf16_f32 v60, v32, v33
    v_cvt_pk_bf16_f32 v61, v34, v35
    v_cvt_pk_bf16_f32 v62, v36, v37
    v_cvt_pk_bf16_f32 v63, v38, v39
    ds_read_b128 v[96:99], v7 offset:28672
    ds_read_b128 v[100:103], v7 offset:29696
    v_exp_f32 v40, v40
    v_exp_f32 v41, v41
    v_exp_f32 v42, v42
    v_exp_f32 v43, v43
    v_exp_f32 v44, v44
    v_exp_f32 v45, v45
    v_exp_f32 v46, v46
    v_exp_f32 v47, v47
    s_waitcnt lgkmcnt(0)
    v_mfma_f32_32x32x16_bf16 v[64:79], v[96:99], v[56:59], v[64:79]
    v_exp_f32 v48, v48
    v_exp_f32 v49, v49
    v_exp_f32 v50, v50
    v_exp_f32 v51, v51
    v_mfma_f32_32x32x16_bf16 v[64:79], v[100:103], v[60:63], v[64:79]
    v_exp_f32 v52, v52
    v_exp_f32 v53, v53
    v_exp_f32 v54, v54
    v_exp_f32 v55, v55
    v_cvt_pk_bf16_f32 v232, v40, v41
    v_cvt_pk_bf16_f32 v233, v42, v43
    v_cvt_pk_bf16_f32 v234, v44, v45
    v_cvt_pk_bf16_f32 v235, v46, v47
    v_cvt_pk_bf16_f32 v236, v48, v49
    v_cvt_pk_bf16_f32 v237, v50, v51
    v_cvt_pk_bf16_f32 v238, v52, v53
    v_cvt_pk_bf16_f32 v239, v54, v55
    ds_read_b128 v[96:99], v7 offset:30720
    ds_read_b128 v[100:103], v7 offset:31744
    s_waitcnt lgkmcnt(0)
    v_mfma_f32_32x32x16_bf16 v[64:79], v[96:99], v[232:235], v[64:79]
    v_mfma_f32_32x32x16_bf16 v[64:79], v[100:103], v[236:239], v[64:79]
    s_branch K2_LOOPEND
K2_SAFE:
    s_add_u32 s40, s39, 16384
    s_add_u32 s41, s38, 2105344
    s_mov_b32 m0, s40
    s_nop 0
    buffer_load_dwordx4 v6, s[28:31], s41 offen lds
    s_add_u32 s40, s39, 20480
    s_add_u32 s41, s38, 2236416
    s_mov_b32 m0, s40
    s_nop 0
    buffer_load_dwordx4 v6, s[28:31], s41 offen lds
    ds_read_b128 v[96:99], v7 offset:4096
    ds_read_b128 v[100:103], v7 offset:5120
    s_waitcnt lgkmcnt(2)
    v_mfma_f32_32x32x16_bf16 v[40:55], v[88:91], v[16:19], 0
    v_mfma_f32_32x32x16_bf16 v[40:55], v[92:95], v[20:23], v[40:55]
    ds_read_b128 v[80:83], v7 offset:8192
    ds_read_b128 v[84:87], v7 offset:9216
    v_max3_f32 v217, v24, v25, v26
    v_max3_f32 v218, v27, v28, v29
    v_max3_f32 v217, v217, v30, v31
    v_max3_f32 v218, v218, v32, v33
    v_max3_f32 v217, v217, v34, v35
    v_max3_f32 v218, v218, v36, v37
    v_max3_f32 v217, v217, v38, v39
    v_max_f32 v217, v217, v218
    v_cmp_lt_f32 vcc, s46, v217
    s_cbranch_vccnz K2S_RARE0
K2S_BACK0:
    v_exp_f32 v24, v24
    v_exp_f32 v25, v25
    v_exp_f32 v26, v26
    v_exp_f32 v27, v27
    s_cmp_ge_u32 s32, 7
    s_cbranch_scc1 K2_Q7_68
    s_add_u32 s40, s44, 0
    buffer_load_dwordx4 v[104:107], v6, s[28:31], s40 offen
    s_branch K2_QJ_68
K2_Q7_68:
    s_add_u32 s40, s52, 0
    buffer_load_dwordx4 v[104:107], v10, s[20:23], s40 offen
K2_QJ_68:
    v_exp_f32 v28, v28
    v_exp_f32 v29, v29
    v_exp_f32 v30, v30
    v_exp_f32 v31, v31
    v_exp_f32 v32, v32
    v_exp_f32 v33, v33
    s_cmp_ge_u32 s32, 7
    s_cbranch_scc1 K2_Q7_69
    s_add_u32 s40, s44, 1024
    buffer_load_dwordx4 v[108:111], v6, s[28:31], s40 offen
    s_branch K2_QJ_69
K2_Q7_69:
    s_add_u32 s40, s52, 28672
    buffer_load_dwordx4 v[108:111], v10, s[20:23], s40 offen
K2_QJ_69:
    v_exp_f32 v34, v34
    v_exp_f32 v35, v35
    v_exp_f32 v36, v36
    v_exp_f32 v37, v37
    v_exp_f32 v38, v38
    v_exp_f32 v39, v39
    s_cmp_ge_u32 s32, 7
    s_cbranch_scc1 K2_Q7_70
    s_add_u32 s40, s44, 2048
    buffer_load_dwordx4 v[112:115], v6, s[28:31], s40 offen
    s_branch K2_QJ_70
K2_Q7_70:
    s_add_u32 s40, s52, 57344
    buffer_load_dwordx4 v[112:115], v10, s[20:23], s40 offen
K2_QJ_70:
    v_cvt_pk_bf16_f32 v56, v24, v25
    v_cvt_pk_bf16_f32 v57, v26, v27
    v_cvt_pk_bf16_f32 v58, v28, v29
    v_cvt_pk_bf16_f32 v59, v30, v31
    v_cvt_pk_bf16_f32 v60, v32, v33
    v_cvt_pk_bf16_f32 v61, v34, v35
    v_cvt_pk_bf16_f32 v62, v36, v37
    v_cvt_pk_bf16_f32 v63, v38, v39
    s_waitcnt lgkmcnt(2)
    v_mfma_f32_32x32x16_bf16 v[64:79], v[96:99], v[56:59], 0
    v_mfma_f32_32x32x16_bf16 v[64:79], v[100:103], v[60:63], v[64:79]
    ds_read_b128 v[96:99], v7 offset:6144
    ds_read_b128 v[100:103], v7 offset:7168
    s_waitcnt lgkmcnt(2)
    v_mfma_f32_32x32x16_bf16 v[24:39], v[80:83], v[16:19], 0
    v_mfma_f32_32x32x16_bf16 v[24:39], v[84:87], v[20:23], v[24:39]
    ds_read_b128 v[88:91], v7 offset:10240
    ds_read_b128 v[92:95], v7 offset:11264
    v_max3_f32 v217, v40, v41, v42
    v_max3_f32 v218, v43, v44, v45
    v_max3_f32 v217, v217, v46, v47
    v_max3_f32 v218, v218, v48, v49
    v_max3_f32 v217, v217, v50, v51
    v_max3_f32 v218, v218, v52, v53
    v_max3_f32 v217, v217, v54, v55
    v_max_f32 v217, v217, v218
    v_cmp_lt_f32 vcc, s46, v217
    s_cbranch_vccnz K2S_RARE1
K2S_BACK1:
    v_exp_f32 v40, v40
    v_exp_f32 v41, v41
    v_exp_f32 v42, v42
    v_exp_f32 v43, v43
    s_cmp_ge_u32 s32, 7
    s_cbranch_scc1 K2_Q7_71
    s_add_u32 s40, s44, 3072
    buffer_load_dwordx4 v[116:119], v6, s[28:31], s40 offen
    s_branch K2_QJ_71
K2_Q7_71:
    s_add_u32 s40, s52, 86016
    buffer_load_dwordx4 v[116:119], v10, s[20:23], s40 offen
K2_QJ_71:
    v_exp_f32 v44, v44
    v_exp_f32 v45, v45
    v_exp_f32 v46, v46
    v_exp_f32 v47, v47
    v_exp_f32 v48, v48
    v_exp_f32 v49, v49
    s_cmp_ge_u32 s32, 7
    s_cbranch_scc1 K2_Q7_72
    s_branch K2_QJ_72
K2_Q7_72:
    s_add_u32 s40, s52, 114688
    buffer_load_dwordx4 v[120:123], v10, s[20:23], s40 offen
K2_QJ_72:
    v_exp_f32 v50, v50
    v_exp_f32 v51, v51
    v_exp_f32 v52, v52
    v_exp_f32 v53, v53
    v_exp_f32 v54, v54
    v_exp_f32 v55, v55
    v_cvt_pk_bf16_f32 v56, v40, v41
    v_cvt_pk_bf16_f32 v57, v42, v43
    v_cvt_pk_bf16_f32 v58, v44, v45
    v_cvt_pk_bf16_f32 v59, v46, v47
    v_cvt_pk_bf16_f32 v60, v48, v49
    v_cvt_pk_bf16_f32 v61, v50, v51
    v_cvt_pk_bf16_f32 v62, v52, v53
    v_cvt_pk_bf16_f32 v63, v54, v55
    s_waitcnt lgkmcnt(2)
    v_mfma_f32_32x32x16_bf16 v[64:79], v[96:99], v[56:59], v[64:79]
    v_mfma_f32_32x32x16_bf16 v[64:79], v[100:103], v[60:63], v[64:79]
    s_cmp_ge_u32 s32, 7
    s_cbranch_scc1 K2S_W7_1
    s_waitcnt vmcnt(4)
    s_branch K2S_WJ_1
K2S_W7_1:
    s_waitcnt vmcnt(5)
K2S_WJ_1:
    s_barrier
    s_add_u32 s40, s39, 24576
    s_add_u32 s41, s38, 2109440
    s_mov_b32 m0, s40
    s_nop 0
    buffer_load_dwordx4 v6, s[28:31], s41 offen lds
    s_add_u32 s40, s39, 28672
    s_add_u32 s41, s38, 2240512
    s_mov_b32 m0, s40
    s_nop 0
    buffer_load_dwordx4 v6, s[28:31], s41 offen lds
    ds_read_b128 v[96:99], v7 offset:12288
    ds_read_b128 v[100:103], v7 offset:13312
    s_waitcnt lgkmcnt(2)
    v_mfma_f32_32x32x16_bf16 v[40:55], v[88:91], v[16:19], 0
    v_mfma_f32_32x32x16_bf16 v[40:55], v[92:95], v[20:23], v[40:55]
    ds_read_b128 v[80:83], v7 offset:16384
    ds_read_b128 v[84:87], v7 offset:17408
    v_max3_f32 v217, v24, v25, v26
    v_max3_f32 v218, v27, v28, v29
    v_max3_f32 v217, v217, v30, v31
    v_max3_f32 v218, v218, v32, v33
    v_max3_f32 v217, v217, v34, v35
    v_max3_f32 v218, v218, v36, v37
    v_max3_f32 v217, v217, v38, v39
    v_max_f32 v217, v217, v218
    v_cmp_lt_f32 vcc, s46, v217
    s_cbranch_vccnz K2S_RARE2
K2S_BACK2:
    v_exp_f32 v24, v24
    v_exp_f32 v25, v25
    v_exp_f32 v26, v26
    v_exp_f32 v27, v27
    s_cmp_ge_u32 s32, 7
    s_cbranch_scc1 K2_Q7_73
    s_add_u32 s40, s45, 0
    s_add_u32 s41, s44, 229376
    s_mov_b32 m0, s40
    s_nop 0
    buffer_load_dwordx4 v6, s[28:31], s41 offen lds
    s_branch K2_QJ_73
K2_Q7_73:
    s_add_u32 s40, s52, 143360
    buffer_load_dwordx4 v[104:107], v10, s[20:23], s40 offen
K2_QJ_73:
    v_exp_f32 v28, v28
    v_exp_f32 v29, v29
    v_exp_f32 v30, v30
    v_exp_f32 v31, v31
    v_exp_f32 v32, v32
    v_exp_f32 v33, v33
    s_cmp_ge_u32 s32, 7
    s_cbranch_scc1 K2_Q7_74
    s_add_u32 s40, s45, 1024
    s_add_u32 s41, s44, 230400
    s_mov_b32 m0, s40
    s_nop 0
    buffer_load_dwordx4 v6, s[28:31], s41 offen lds
    s_branch K2_QJ_74
K2_Q7_74:
    s_add_u32 s40, s52, 172032
    buffer_load_dwordx4 v[108:111], v10, s[20:23], s40 offen
K2_QJ_74:
    v_exp_f32 v34, v34
    v_exp_f32 v35, v35
    v_exp_f32 v36, v36
    v_exp_f32 v37, v37
    v_exp_f32 v38, v38
    v_exp_f32 v39, v39
    s_cmp_ge_u32 s32, 7
    s_cbranch_scc1 K2_Q7_75
    s_add_u32 s40, s45, 2048
    s_add_u32 s41, s44, 231424
    s_mov_b32 m0, s40
    s_nop 0
    buffer_load_dwordx4 v6, s[28:31], s41 offen lds
    s_branch K2_QJ_75
K2_Q7_75:
    s_add_u32 s40, s52, 200704
    buffer_load_dwordx4 v[112:115], v10, s[20:23], s40 offen
K2_QJ_75:
    v_cvt_pk_bf16_f32 v56, v24, v25
    v_cvt_pk_bf16_f32 v57, v26, v27
    v_cvt_pk_bf16_f32 v58, v28, v29
    v_cvt_pk_bf16_f32 v59, v30, v31
    v_cvt_pk_bf16_f32 v60, v32, v33
    v_cvt_pk_bf16_f32 v61, v34, v35
    v_cvt_pk_bf16_f32 v62, v36, v37
    v_cvt_pk_bf16_f32 v63, v38, v39
    s_waitcnt lgkmcnt(2)
    v_mfma_f32_32x32x16_bf16 v[64:79], v[96:99], v[56:59], v[64:79]
    v_mfma_f32_32x32x16_bf16 v[64:79], v[100:103], v[60:63], v[64:79]
    ds_read_b128 v[96:99], v7 offset:14336
    ds_read_b128 v[100:103], v7 offset:15360
    s_waitcnt lgkmcnt(2)
    v_mfma_f32_32x32x16_bf16 v[24:39], v[80:83], v[16:19], 0
    v_mfma_f32_32x32x16_bf16 v[24:39], v[84:87], v[20:23], v[24:39]
    ds_read_b128 v[88:91], v7 offset:18432
    ds_read_b128 v[92:95], v7 offset:19456
    v_max3_f32 v217, v40, v41, v42
    v_max3_f32 v218, v43, v44, v45
    v_max3_f32 v217, v217, v46, v47
    v_max3_f32 v218, v218, v48, v49
    v_max3_f32 v217, v217, v50, v51
    v_max3_f32 v218, v218, v52, v53
    v_max3_f32 v217, v217, v54, v55
    v_max_f32 v217, v217, v218
    v_cmp_lt_f32 vcc, s46, v217
    s_cbranch_vccnz K2S_RARE3
K2S_BACK3:
    v_exp_f32 v40, v40
    v_exp_f32 v41, v41
    v_exp_f32 v42, v42
    v_exp_f32 v43, v43
    s_cmp_ge_u32 s32, 7
    s_cbranch_scc1 K2_Q7_76
    s_add_u32 s40, s45, 3072
    s_add_u32 s41, s44, 232448
    s_mov_b32 m0, s40
    s_nop 0
    buffer_load_dwordx4 v6, s[28:31], s41 offen lds
    s_branch K2_QJ_76
K2_Q7_76:
    s_add_u32 s40, s52, 1024
    buffer_load_dwordx4 v[116:119], v10, s[20:23], s40 offen
K2_QJ_76:
    v_exp_f32 v44, v44
    v_exp_f32 v45, v45
    v_exp_f32 v46, v46
    v_exp_f32 v47, v47
    v_exp_f32 v48, v48
    v_exp_f32 v49, v49
    s_cmp_ge_u32 s32, 7
    s_cbranch_scc1 K2_Q7_77
    s_branch K2_QJ_77
K2_Q7_77:
    s_add_u32 s40, s52, 29696
    buffer_load_dwordx4 v[120:123], v10, s[20:23], s40 offen
K2_QJ_77:
    v_exp_f32 v50, v50
    v_exp_f32 v51, v51
    v_exp_f32 v52, v52
    v_exp_f32 v53, v53
    v_exp_f32 v54, v54
    v_exp_f32 v55, v55
    v_cvt_pk_bf16_f32 v56, v40, v41
    v_cvt_pk_bf16_f32 v57, v42, v43
    v_cvt_pk_bf16_f32 v58, v44, v45
    v_cvt_pk_bf16_f32 v59, v46, v47
    v_cvt_pk_bf16_f32 v60, v48, v49
    v_cvt_pk_bf16_f32 v61, v50, v51
    v_cvt_pk_bf16_f32 v62, v52, v53
    v_cvt_pk_bf16_f32 v63, v54, v55
    s_waitcnt lgkmcnt(2)
    v_mfma_f32_32x32x16_bf16 v[64:79], v[96:99], v[56:59], v[64:79]
    v_mfma_f32_32x32x16_bf16 v[64:79], v[100:103], v[60:63], v[64:79]
    s_cmp_ge_u32 s32, 7
    s_cbranch_scc1 K2S_W7_2
    s_waitcnt vmcnt(4)
    s_branch K2S_WJ_2
K2S_W7_2:
    s_waitcnt vmcnt(5)
K2S_WJ_2:
    s_barrier
    s_add_u32 s40, s39, 0
    s_add_u32 s41, s38, 2113536
    s_mov_b32 m0, s40
    s_nop 0
    buffer_load_dwordx4 v6, s[28:31], s41 offen lds
    s_add_u32 s40, s39, 4096
    s_add_u32 s41, s38, 2244608
    s_mov_b32 m0, s40
    s_nop 0
    buffer_load_dwordx4 v6, s[28:31], s41 offen lds
    ds_read_b128 v[96:99], v7 offset:20480
    ds_read_b128 v[100:103], v7 offset:21504
    s_waitcnt lgkmcnt(2)
    v_mfma_f32_32x32x16_bf16 v[40:55], v[88:91], v[16:19], 0
    v_mfma_f32_32x32x16_bf16 v[40:55], v[92:95], v[20:23], v[40:55]
    ds_read_b128 v[80:83], v7 offset:24576
    ds_read_b128 v[84:87], v7 offset:25600
    v_max3_f32 v217, v24, v25, v26
    v_max3_f32 v218, v27, v28, v29
    v_max3_f32 v217, v217, v30, v31
    v_max3_f32 v218, v218, v32, v33
    v_max3_f32 v217, v217, v34, v35
    v_max3_f32 v218, v218, v36, v37
    v_max3_f32 v217, v217, v38, v39
    v_max_f32 v217, v217, v218
    v_cmp_lt_f32 vcc, s46, v217
    s_cbranch_vccnz K2S_RARE4
K2S_BACK4:
    v_exp_f32 v24, v24
    v_exp_f32 v25, v25
    v_exp_f32 v26, v26
    v_exp_f32 v27, v27
    s_cmp_ge_u32 s32, 7
    s_cbranch_scc1 K2_Q7_78
    s_add_u32 s40, s44, 28672
    buffer_load_dwordx4 v[120:123], v6, s[28:31], s40 offen
    s_branch K2_QJ_78
K2_Q7_78:
    s_add_u32 s40, s52, 58368
    buffer_load_dwordx4 v[104:107], v10, s[20:23], s40 offen
K2_QJ_78:
    v_exp_f32 v28, v28
    v_exp_f32 v29, v29
    v_exp_f32 v30, v30
    v_exp_f32 v31, v31
    v_exp_f32 v32, v32
    v_exp_f32 v33, v33
    s_cmp_ge_u32 s32, 7
    s_cbranch_scc1 K2_Q7_79
    s_add_u32 s40, s44, 29696
    buffer_load_dwordx4 v[124:127], v6, s[28:31], s40 offen
    s_branch K2_QJ_79
K2_Q7_79:
    s_add_u32 s40, s52, 87040
    buffer_load_dwordx4 v[108:111], v10, s[20:23], s40 offen
K2_QJ_79:
    v_exp_f32 v34, v34
    v_exp_f32 v35, v35
    v_exp_f32 v36, v36
    v_exp_f32 v37, v37
    v_exp_f32 v38, v38
    v_exp_f32 v39, v39
    s_cmp_ge_u32 s32, 7
    s_cbranch_scc1 K2_Q7_80
    s_add_u32 s40, s44, 30720
    buffer_load_dwordx4 v[128:131], v6, s[28:31], s40 offen
    s_branch K2_QJ_80
K2_Q7_80:
    s_add_u32 s40, s52, 115712
    buffer_load_dwordx4 v[112:115], v10, s[20:23], s40 offen
K2_QJ_80:
    v_cvt_pk_bf16_f32 v56, v24, v25
    v_cvt_pk_bf16_f32 v57, v26, v27
    v_cvt_pk_bf16_f32 v58, v28, v29
    v_cvt_pk_bf16_f32 v59, v30, v31
    v_cvt_pk_bf16_f32 v60, v32, v33
    v_cvt_pk_bf16_f32 v61, v34, v35
    v_cvt_pk_bf16_f32 v62, v36, v37
    v_cvt_pk_bf16_f32 v63, v38, v39
    s_waitcnt lgkmcnt(2)
    v_mfma_f32_32x32x16_bf16 v[64:79], v[96:99], v[56:59], v[64:79]
    v_mfma_f32_32x32x16_bf16 v[64:79], v[100:103], v[60:63], v[64:79]
    ds_read_b128 v[96:99], v7 offset:22528
    ds_read_b128 v[100:103], v7 offset:23552
    s_waitcnt lgkmcnt(2)
    v_mfma_f32_32x32x16_bf16 v[24:39], v[80:83], v[16:19], 0
    v_mfma_f32_32x32x16_bf16 v[24:39], v[84:87], v[20:23], v[24:39]
    ds_read_b128 v[88:91], v7 offset:26624
    ds_read_b128 v[92:95], v7 offset:27648
    v_max3_f32 v217, v40, v41, v42
    v_max3_f32 v218, v43, v44, v45
    v_max3_f32 v217, v217, v46, v47
    v_max3_f32 v218, v218, v48, v49
    v_max3_f32 v217, v217, v50, v51
    v_max3_f32 v218, v218, v52, v53
    v_max3_f32 v217, v217, v54, v55
    v_max_f32 v217, v217, v218
    v_cmp_lt_f32 vcc, s46, v217
    s_cbranch_vccnz K2S_RARE5
K2S_BACK5:
    v_exp_f32 v40, v40
    v_exp_f32 v41, v41
    v_exp_f32 v42, v42
    v_exp_f32 v43, v43
    s_cmp_ge_u32 s32, 7
    s_cbranch_scc1 K2_Q7_81
    s_add_u32 s40, s44, 31744
    buffer_load_dwordx4 v[132:135], v6, s[28:31], s40 offen
    s_branch K2_QJ_81
K2_Q7_81:
    s_add_u32 s40, s52, 144384
    buffer_load_dwordx4 v[116:119], v10, s[20:23], s40 offen
K2_QJ_81:
    v_exp_f32 v44, v44
    v_exp_f32 v45, v45
    v_exp_f32 v46, v46
    v_exp_f32 v47, v47
    v_exp_f32 v48, v48
    v_exp_f32 v49, v49
    s_cmp_ge_u32 s32, 7
    s_cbranch_scc1 K2_Q7_82
    s_branch K2_QJ_82
K2_Q7_82:
    s_add_u32 s40, s52, 173056
    buffer_load_dwordx4 v[120:123], v10, s[20:23], s40 offen
K2_QJ_82:
    v_exp_f32 v50, v50
    v_exp_f32 v51, v51
    v_exp_f32 v52, v52
    v_exp_f32 v53, v53
    v_exp_f32 v54, v54
    v_exp_f32 v55, v55
    v_cvt_pk_bf16_f32 v56, v40, v41
    v_cvt_pk_bf16_f32 v57, v42, v43
    v_cvt_pk_bf16_f32 v58, v44, v45
    v_cvt_pk_bf16_f32 v59, v46, v47
    v_cvt_pk_bf16_f32 v60, v48, v49
    v_cvt_pk_bf16_f32 v61, v50, v51
    v_cvt_pk_bf16_f32 v62, v52, v53
    v_cvt_pk_bf16_f32 v63, v54, v55
    s_waitcnt lgkmcnt(2)
    v_mfma_f32_32x32x16_bf16 v[64:79], v[96:99], v[56:59], v[64:79]
    v_mfma_f32_32x32x16_bf16 v[64:79], v[100:103], v[60:63], v[64:79]
    s_cmp_ge_u32 s32, 7
    s_cbranch_scc1 K2S_W7_3
    s_waitcnt vmcnt(4)
    s_branch K2S_WJ_3
K2S_W7_3:
    s_waitcnt vmcnt(5)
K2S_WJ_3:
    s_barrier
    s_add_u32 s40, s39, 8192
    s_add_u32 s41, s38, 2117632
    s_mov_b32 m0, s40
    s_nop 0
    buffer_load_dwordx4 v6, s[28:31], s41 offen lds
    s_add_u32 s40, s39, 12288
    s_add_u32 s41, s38, 2248704
    s_mov_b32 m0, s40
    s_nop 0
    buffer_load_dwordx4 v6, s[28:31], s41 offen lds
    ds_read_b128 v[96:99], v7 offset:28672
    ds_read_b128 v[100:103], v7 offset:29696
    s_waitcnt lgkmcnt(2)
    v_mfma_f32_32x32x16_bf16 v[40:55], v[88:91], v[16:19], 0
    v_mfma_f32_32x32x16_bf16 v[40:55], v[92:95], v[20:23], v[40:55]
    ds_read_b128 v[80:83], v7 offset:0
    ds_read_b128 v[84:87], v7 offset:1024
    v_max3_f32 v217, v24, v25, v26
    v_max3_f32 v218, v27, v28, v29
    v_max3_f32 v217, v217, v30, v31
    v_max3_f32 v218, v218, v32, v33
    v_max3_f32 v217, v217, v34, v35
    v_max3_f32 v218, v218, v36, v37
    v_max3_f32 v217, v217, v38, v39
    v_max_f32 v217, v217, v218
    v_cmp_lt_f32 vcc, s46, v217
    s_cbranch_vccnz K2S_RARE6
K2S_BACK6:
    v_exp_f32 v24, v24
    v_exp_f32 v25, v25
    v_exp_f32 v26, v26
    v_exp_f32 v27, v27
    s_cmp_ge_u32 s32, 7
    s_cbranch_scc1 K2_Q7_83
    s_add_u32 s40, s45, 28672
    s_add_u32 s41, s44, 258048
    s_mov_b32 m0, s40
    s_nop 0
    buffer_load_dwordx4 v6, s[28:31], s41 offen lds
    s_branch K2_QJ_83
K2_Q7_83:
    s_add_u32 s40, s52, 201728
    buffer_load_dwordx4 v[104:107], v10, s[20:23], s40 offen
K2_QJ_83:
    v_exp_f32 v28, v28
    v_exp_f32 v29, v29
    v_exp_f32 v30, v30
    v_exp_f32 v31, v31
    v_exp_f32 v32, v32
    v_exp_f32 v33, v33
    s_cmp_ge_u32 s32, 7
    s_cbranch_scc1 K2_Q7_84
    s_add_u32 s40, s45, 29696
    s_add_u32 s41, s44, 259072
    s_mov_b32 m0, s40
    s_nop 0
    buffer_load_dwordx4 v6, s[28:31], s41 offen lds
    s_branch K2_QJ_84
K2_Q7_84:
    s_add_u32 s40, s52, 2048
    buffer_load_dwordx4 v[108:111], v10, s[20:23], s40 offen
K2_QJ_84:
    v_exp_f32 v34, v34
    v_exp_f32 v35, v35
    v_exp_f32 v36, v36
    v_exp_f32 v37, v37
    v_exp_f32 v38, v38
    v_exp_f32 v39, v39
    s_cmp_ge_u32 s32, 7
    s_cbranch_scc1 K2_Q7_85
    s_add_u32 s40, s45, 30720
    s_add_u32 s41, s44, 260096
    s_mov_b32 m0, s40
    s_nop 0
    buffer_load_dwordx4 v6, s[28:31], s41 offen lds
    s_branch K2_QJ_85
K2_Q7_85:
    s_add_u32 s40, s52, 30720
    buffer_load_dwordx4 v[112:115], v10, s[20:23], s40 offen
K2_QJ_85:
    v_cvt_pk_bf16_f32 v56, v24, v25
    v_cvt_pk_bf16_f32 v57, v26, v27
    v_cvt_pk_bf16_f32 v58, v28, v29
    v_cvt_pk_bf16_f32 v59, v30, v31
    v_cvt_pk_bf16_f32 v60, v32, v33
    v_cvt_pk_bf16_f32 v61, v34, v35
    v_cvt_pk_bf16_f32 v62, v36, v37
    v_cvt_pk_bf16_f32 v63, v38, v39
    s_waitcnt lgkmcnt(2)
    v_mfma_f32_32x32x16_bf16 v[64:79], v[96:99], v[56:59], v[64:79]
    v_mfma_f32_32x32x16_bf16 v[64:79], v[100:103], v[60:63], v[64:79]
    ds_read_b128 v[96:99], v7 offset:30720
    ds_read_b128 v[100:103], v7 offset:31744
    s_waitcnt lgkmcnt(2)
    v_mfma_f32_32x32x16_bf16 v[24:39], v[80:83], v[16:19], 0
    v_mfma_f32_32x32x16_bf16 v[24:39], v[84:87], v[20:23], v[24:39]
    ds_read_b128 v[88:91], v7 offset:2048
    ds_read_b128 v[92:95], v7 offset:3072
    v_max3_f32 v217, v40, v41, v42
    v_max3_f32 v218, v43, v44, v45
    v_max3_f32 v217, v217, v46, v47
    v_max3_f32 v218, v218, v48, v49
    v_max3_f32 v217, v217, v50, v51
    v_max3_f32 v218, v218, v52, v53
    v_max3_f32 v217, v217, v54, v55
    v_max_f32 v217, v217, v218
    v_cmp_lt_f32 vcc, s46, v217
    s_cbranch_vccnz K2S_RARE7
K2S_BACK7:
    v_exp_f32 v40, v40
    v_exp_f32 v41, v41
    v_exp_f32 v42, v42
    v_exp_f32 v43, v43
    s_cmp_ge_u32 s32, 7
    s_cbranch_scc1 K2_Q7_86
    s_add_u32 s40, s45, 31744
    s_add_u32 s41, s44, 261120
    s_mov_b32 m0, s40
    s_nop 0
    buffer_load_dwordx4 v6, s[28:31], s41 offen lds
    s_branch K2_QJ_86
K2_Q7_86:
    s_add_u32 s40, s52, 59392
    buffer_load_dwordx4 v[116:119], v10, s[20:23], s40 offen
K2_QJ_86:
    v_exp_f32 v44, v44
    v_exp_f32 v45, v45
    v_exp_f32 v46, v46
    v_exp_f32 v47, v47
    v_exp_f32 v48, v48
    v_exp_f32 v49, v49
    s_cmp_ge_u32 s32, 7
    s_cbranch_scc1 K2_Q7_87
    s_branch K2_QJ_87
K2_Q7_87:
    s_add_u32 s40, s52, 88064
    buffer_load_dwordx4 v[120:123], v10, s[20:23], s40 offen
K2_QJ_87:
    v_exp_f32 v50, v50
    v_exp_f32 v51, v51
    v_exp_f32 v52, v52
    v_exp_f32 v53, v53
    v_exp_f32 v54, v54
    v_exp_f32 v55, v55
    v_cvt_pk_bf16_f32 v56, v40, v41
    v_cvt_pk_bf16_f32 v57, v42, v43
    v_cvt_pk_bf16_f32 v58, v44, v45
    v_cvt_pk_bf16_f32 v59, v46, v47
    v_cvt_pk_bf16_f32 v60, v48, v49
    v_cvt_pk_bf16_f32 v61, v50, v51
    v_cvt_pk_bf16_f32 v62, v52, v53
    v_cvt_pk_bf16_f32 v63, v54, v55
    s_waitcnt lgkmcnt(2)
    v_mfma_f32_32x32x16_bf16 v[64:79], v[96:99], v[56:59], v[64:79]
    v_mfma_f32_32x32x16_bf16 v[64:79], v[100:103], v[60:63], v[64:79]
    s_cmp_ge_u32 s32, 7
    s_cbranch_scc1 K2S_W7_4
    s_waitcnt vmcnt(4)
    s_branch K2S_WJ_4
K2S_W7_4:
    s_waitcnt vmcnt(5)
K2S_WJ_4:
    s_barrier
    s_add_u32 s40, s39, 16384
    s_add_u32 s41, s38, 2121728
    s_mov_b32 m0, s40
    s_nop 0
    buffer_load_dwordx4 v6, s[28:31], s41 offen lds
    s_add_u32 s40, s39, 20480
    s_add_u32 s41, s38, 2252800
    s_mov_b32 m0, s40
    s_nop 0
    buffer_load_dwordx4 v6, s[28:31], s41 offen lds
    ds_read_b128 v[96:99], v7 offset:4096
    ds_read_b128 v[100:103], v7 offset:5120
    s_waitcnt lgkmcnt(2)
    v_mfma_f32_32x32x16_bf16 v[40:55], v[88:91], v[16:19], 0
    v_mfma_f32_32x32x16_bf16 v[40:55], v[92:95], v[20:23], v[40:55]
    ds_read_b128 v[80:83], v7 offset:8192
    ds_read_b128 v[84:87], v7 offset:9216
    v_max3_f32 v217, v24, v25, v26
    v_max3_f32 v218, v27, v28, v29
    v_max3_f32 v217, v217, v30, v31
    v_max3_f32 v218, v218, v32, v33
    v_max3_f32 v217, v217, v34, v35
    v_max3_f32 v218, v218, v36, v37
    v_max3_f32 v217, v217, v38, v39
    v_max_f32 v217, v217, v218
    v_cmp_lt_f32 vcc, s46, v217
    s_cbranch_vccnz K2S_RARE8
K2S_BACK8:
    v_exp_f32 v24, v24
    v_exp_f32 v25, v25
    v_exp_f32 v26, v26
    v_exp_f32 v27, v27
    s_cmp_ge_u32 s32, 7
    s_cbranch_scc1 K2_Q7_88
    s_add_u32 s40, s44, 57344
    buffer_load_dwordx4 v[136:139], v6, s[28:31], s40 offen
    s_branch K2_QJ_88
K2_Q7_88:
    s_add_u32 s40, s52, 116736
    buffer_load_dwordx4 v[104:107], v10, s[20:23], s40 offen
K2_QJ_88:
    v_exp_f32 v28, v28
    v_exp_f32 v29, v29
    v_exp_f32 v30, v30
    v_exp_f32 v31, v31
    v_exp_f32 v32, v32
    v_exp_f32 v33, v33
    s_cmp_ge_u32 s32, 7
    s_cbranch_scc1 K2_Q7_89
    s_add_u32 s40, s44, 58368
    buffer_load_dwordx4 v[140:143], v6, s[28:31], s40 offen
    s_branch K2_QJ_89
K2_Q7_89:
    s_add_u32 s40, s52, 145408
    buffer_load_dwordx4 v[108:111], v10, s[20:23], s40 offen
K2_QJ_89:
    v_exp_f32 v34, v34
    v_exp_f32 v35, v35
    v_exp_f32 v36, v36
    v_exp_f32 v37, v37
    v_exp_f32 v38, v38
    v_exp_f32 v39, v39
    s_cmp_ge_u32 s32, 7
    s_cbranch_scc1 K2_Q7_90
    s_add_u32 s40, s44, 59392
    buffer_load_dwordx4 v[144:147], v6, s[28:31], s40 offen
    s_branch K2_QJ_90
K2_Q7_90:
    s_add_u32 s40, s52, 174080
    buffer_load_dwordx4 v[112:115], v10, s[20:23], s40 offen
K2_QJ_90:
    v_cvt_pk_bf16_f32 v56, v24, v25
    v_cvt_pk_bf16_f32 v57, v26, v27
    v_cvt_pk_bf16_f32 v58, v28, v29
    v_cvt_pk_bf16_f32 v59, v30, v31
    v_cvt_pk_bf16_f32 v60, v32, v33
    v_cvt_pk_bf16_f32 v61, v34, v35
    v_cvt_pk_bf16_f32 v62, v36, v37
    v_cvt_pk_bf16_f32 v63, v38, v39
    s_waitcnt lgkmcnt(2)
    v_mfma_f32_32x32x16_bf16 v[64:79], v[96:99], v[56:59], v[64:79]
    v_mfma_f32_32x32x16_bf16 v[64:79], v[100:103], v[60:63], v[64:79]
    ds_read_b128 v[96:99], v7 offset:6144
    ds_read_b128 v[100:103], v7 offset:7168
    s_waitcnt lgkmcnt(2)
    v_mfma_f32_32x32x16_bf16 v[24:39], v[80:83], v[16:19], 0
    v_mfma_f32_32x32x16_bf16 v[24:39], v[84:87], v[20:23], v[24:39]
    ds_read_b128 v[88:91], v7 offset:10240
    ds_read_b128 v[92:95], v7 offset:11264
    v_max3_f32 v217, v40, v41, v42
    v_max3_f32 v218, v43, v44, v45
    v_max3_f32 v217, v217, v46, v47
    v_max3_f32 v218, v218, v48, v49
    v_max3_f32 v217, v217, v50, v51
    v_max3_f32 v218, v218, v52, v53
    v_max3_f32 v217, v217, v54, v55
    v_max_f32 v217, v217, v218
    v_cmp_lt_f32 vcc, s46, v217
    s_cbranch_vccnz K2S_RARE9
K2S_BACK9:
    v_exp_f32 v40, v40
    v_exp_f32 v41, v41
    v_exp_f32 v42, v42
    v_exp_f32 v43, v43
    s_cmp_ge_u32 s32, 7
    s_cbranch_scc1 K2_Q7_91
    s_add_u32 s40, s44, 60416
    buffer_load_dwordx4 v[148:151], v6, s[28:31], s40 offen
    s_branch K2_QJ_91
K2_Q7_91:
    s_add_u32 s40, s52, 202752
    buffer_load_dwordx4 v[116:119], v10, s[20:23], s40 offen
K2_QJ_91:
    v_exp_f32 v44, v44
    v_exp_f32 v45, v45
    v_exp_f32 v46, v46
    v_exp_f32 v47, v47
    v_exp_f32 v48, v48
    v_exp_f32 v49, v49
    s_cmp_ge_u32 s32, 7
    s_cbranch_scc1 K2_Q7_92
    s_branch K2_QJ_92
K2_Q7_92:
    s_add_u32 s40, s52, 3072
    buffer_load_dwordx4 v[120:123], v10, s[20:23], s40 offen
K2_QJ_92:
    v_exp_f32 v50, v50
    v_exp_f32 v51, v51
    v_exp_f32 v52, v52
    v_exp_f32 v53, v53
    v_exp_f32 v54, v54
    v_exp_f32 v55, v55
    v_cvt_pk_bf16_f32 v56, v40, v41
    v_cvt_pk_bf16_f32 v57, v42, v43
    v_cvt_pk_bf16_f32 v58, v44, v45
    v_cvt_pk_bf16_f32 v59, v46, v47
    v_cvt_pk_bf16_f32 v60, v48, v49
    v_cvt_pk_bf16_f32 v61, v50, v51
    v_cvt_pk_bf16_f32 v62, v52, v53
    v_cvt_pk_bf16_f32 v63, v54, v55
    s_waitcnt lgkmcnt(2)
    v_mfma_f32_32x32x16_bf16 v[64:79], v[96:99], v[56:59], v[64:79]
    v_mfma_f32_32x32x16_bf16 v[64:79], v[100:103], v[60:63], v[64:79]
    s_cmp_ge_u32 s32, 7
    s_cbranch_scc1 K2S_W7_5
    s_waitcnt vmcnt(4)
    s_branch K2S_WJ_5
K2S_W7_5:
    s_waitcnt vmcnt(5)
K2S_WJ_5:
    s_barrier
    s_add_u32 s40, s39, 24576
    s_add_u32 s41, s38, 2125824
    s_mov_b32 m0, s40
    s_nop 0
    buffer_load_dwordx4 v6, s[28:31], s41 offen lds
    s_add_u32 s40, s39, 28672
    s_add_u32 s41, s38, 2256896
    s_mov_b32 m0, s40
    s_nop 0
    buffer_load_dwordx4 v6, s[28:31], s41 offen lds
    ds_read_b128 v[96:99], v7 offset:12288
    ds_read_b128 v[100:103], v7 offset:13312
    s_waitcnt lgkmcnt(2)
    v_mfma_f32_32x32x16_bf16 v[40:55], v[88:91], v[16:19], 0
    v_mfma_f32_32x32x16_bf16 v[40:55], v[92:95], v[20:23], v[40:55]
    ds_read_b128 v[80:83], v7 offset:16384
    ds_read_b128 v[84:87], v7 offset:17408
    v_max3_f32 v217, v24, v25, v26
    v_max3_f32 v218, v27, v28, v29
    v_max3_f32 v217, v217, v30, v31
    v_max3_f32 v218, v218, v32, v33
    v_max3_f32 v217, v217, v34, v35
    v_max3_f32 v218, v218, v36, v37
    v_max3_f32 v217, v217, v38, v39
    v_max_f32 v217, v217, v218
    v_cmp_lt_f32 vcc, s46, v217
    s_cbranch_vccnz K2S_RARE10
K2S_BACK10:
    v_exp_f32 v24, v24
    v_exp_f32 v25, v25
    v_exp_f32 v26, v26
    v_exp_f32 v27, v27
    s_cmp_ge_u32 s32, 7
    s_cbranch_scc1 K2_Q7_93
    s_add_u32 s40, s45, 57344
    s_add_u32 s41, s44, 286720
    s_mov_b32 m0, s40
    s_nop 0
    buffer_load_dwordx4 v6, s[28:31], s41 offen lds
    s_branch K2_QJ_93
K2_Q7_93:
    s_add_u32 s40, s52, 31744
    buffer_load_dwordx4 v[104:107], v10, s[20:23], s40 offen
K2_QJ_93:
    v_exp_f32 v28, v28
    v_exp_f32 v29, v29
    v_exp_f32 v30, v30
    v_exp_f32 v31, v31
    v_exp_f32 v32, v32
    v_exp_f32 v33, v33
    s_cmp_ge_u32 s32, 7
    s_cbranch_scc1 K2_Q7_94
    s_add_u32 s40, s45, 58368
    s_add_u32 s41, s44, 287744
    s_mov_b32 m0, s40
    s_nop 0
    buffer_load_dwordx4 v6, s[28:31], s41 offen lds
    s_branch K2_QJ_94
K2_Q7_94:
    s_add_u32 s40, s52, 60416
    buffer_load_dwordx4 v[108:111], v10, s[20:23], s40 offen
K2_QJ_94:
    v_exp_f32 v34, v34
    v_exp_f32 v35, v35
    v_exp_f32 v36, v36
    v_exp_f32 v37, v37
    v_exp_f32 v38, v38
    v_exp_f32 v39, v39
    s_cmp_ge_u32 s32, 7
    s_cbranch_scc1 K2_Q7_95
    s_add_u32 s40, s45, 59392
    s_add_u32 s41, s44, 288768
    s_mov_b32 m0, s40
    s_nop 0
    buffer_load_dwordx4 v6, s[28:31], s41 offen lds
    s_branch K2_QJ_95
K2_Q7_95:
    s_add_u32 s40, s52, 89088
    buffer_load_dwordx4 v[112:115], v10, s[20:23], s40 offen
K2_QJ_95:
    v_cvt_pk_bf16_f32 v56, v24, v25
    v_cvt_pk_bf16_f32 v57, v26, v27
    v_cvt_pk_bf16_f32 v58, v28, v29
    v_cvt_pk_bf16_f32 v59, v30, v31
    v_cvt_pk_bf16_f32 v60, v32, v33
    v_cvt_pk_bf16_f32 v61, v34, v35
    v_cvt_pk_bf16_f32 v62, v36, v37
    v_cvt_pk_bf16_f32 v63, v38, v39
    s_waitcnt lgkmcnt(2)
    v_mfma_f32_32x32x16_bf16 v[64:79], v[96:99], v[56:59], v[64:79]
    v_mfma_f32_32x32x16_bf16 v[64:79], v[100:103], v[60:63], v[64:79]
    ds_read_b128 v[96:99], v7 offset:14336
    ds_read_b128 v[100:103], v7 offset:15360
    s_waitcnt lgkmcnt(2)
    v_mfma_f32_32x32x16_bf16 v[24:39], v[80:83], v[16:19], 0
    v_mfma_f32_32x32x16_bf16 v[24:39], v[84:87], v[20:23], v[24:39]
    ds_read_b128 v[88:91], v7 offset:18432
    ds_read_b128 v[92:95], v7 offset:19456
    v_max3_f32 v217, v40, v41, v42
    v_max3_f32 v218, v43, v44, v45
    v_max3_f32 v217, v217, v46, v47
    v_max3_f32 v218, v218, v48, v49
    v_max3_f32 v217, v217, v50, v51
    v_max3_f32 v218, v218, v52, v53
    v_max3_f32 v217, v217, v54, v55
    v_max_f32 v217, v217, v218
    v_cmp_lt_f32 vcc, s46, v217
    s_cbranch_vccnz K2S_RARE11
K2S_BACK11:
    v_exp_f32 v40, v40
    v_exp_f32 v41, v41
    v_exp_f32 v42, v42
    v_exp_f32 v43, v43
    s_cmp_ge_u32 s32, 7
    s_cbranch_scc1 K2_Q7_96
    s_add_u32 s40, s45, 60416
    s_add_u32 s41, s44, 289792
    s_mov_b32 m0, s40
    s_nop 0
    buffer_load_dwordx4 v6, s[28:31], s41 offen lds
    s_branch K2_QJ_96
K2_Q7_96:
    s_add_u32 s40, s52, 117760
    buffer_load_dwordx4 v[116:119], v10, s[20:23], s40 offen
K2_QJ_96:
    v_exp_f32 v44, v44
    v_exp_f32 v45, v45
    v_exp_f32 v46, v46
    v_exp_f32 v47, v47
    v_exp_f32 v48, v48
    v_exp_f32 v49, v49
    s_cmp_ge_u32 s32, 7
    s_cbranch_scc1 K2_Q7_97
    s_branch K2_QJ_97
K2_Q7_97:
    s_add_u32 s40, s52, 146432
    buffer_load_dwordx4 v[120:123], v10, s[20:23], s40 offen
K2_QJ_97:
    v_exp_f32 v50, v50
    v_exp_f32 v51, v51
    v_exp_f32 v52, v52
    v_exp_f32 v53, v53
    v_exp_f32 v54, v54
    v_exp_f32 v55, v55
    v_cvt_pk_bf16_f32 v56, v40, v41
    v_cvt_pk_bf16_f32 v57, v42, v43
    v_cvt_pk_bf16_f32 v58, v44, v45
    v_cvt_pk_bf16_f32 v59, v46, v47
    v_cvt_pk_bf16_f32 v60, v48, v49
    v_cvt_pk_bf16_f32 v61, v50, v51
    v_cvt_pk_bf16_f32 v62, v52, v53
    v_cvt_pk_bf16_f32 v63, v54, v55
    s_waitcnt lgkmcnt(2)
    v_mfma_f32_32x32x16_bf16 v[64:79], v[96:99], v[56:59], v[64:79]
    v_mfma_f32_32x32x16_bf16 v[64:79], v[100:103], v[60:63], v[64:79]
    s_cmp_ge_u32 s32, 7
    s_cbranch_scc1 K2S_W7_6
    s_waitcnt vmcnt(4)
    s_branch K2S_WJ_6
K2S_W7_6:
    s_waitcnt vmcnt(5)
K2S_WJ_6:
    s_barrier
    s_add_u32 s40, s39, 0
    s_add_u32 s41, s38, 2129920
    s_mov_b32 m0, s40
    s_nop 0
    buffer_load_dwordx4 v6, s[28:31], s41 offen lds
    s_add_u32 s40, s39, 4096
    s_add_u32 s41, s38, 2260992
    s_mov_b32 m0, s40
    s_nop 0
    buffer_load_dwordx4 v6, s[28:31], s41 offen lds
    ds_read_b128 v[96:99], v7 offset:20480
    ds_read_b128 v[100:103], v7 offset:21504
    s_waitcnt lgkmcnt(2)
    v_mfma_f32_32x32x16_bf16 v[40:55], v[88:91], v[16:19], 0
    v_mfma_f32_32x32x16_bf16 v[40:55], v[92:95], v[20:23], v[40:55]
    ds_read_b128 v[80:83], v7 offset:24576
    ds_read_b128 v[84:87], v7 offset:25600
    v_max3_f32 v217, v24, v25, v26
    v_max3_f32 v218, v27, v28, v29
    v_max3_f32 v217, v217, v30, v31
    v_max3_f32 v218, v218, v32, v33
    v_max3_f32 v217, v217, v34, v35
    v_max3_f32 v218, v218, v36, v37
    v_max3_f32 v217, v217, v38, v39
    v_max_f32 v217, v217, v218
    v_cmp_lt_f32 vcc, s46, v217
    s_cbranch_vccnz K2S_RARE12
K2S_BACK12:
    v_exp_f32 v24, v24
    v_exp_f32 v25, v25
    v_exp_f32 v26, v26
    v_exp_f32 v27, v27
    s_cmp_ge_u32 s32, 7
    s_cbranch_scc1 K2_Q7_98
    s_add_u32 s40, s44, 86016
    buffer_load_dwordx4 v[152:155], v6, s[28:31], s40 offen
    s_branch K2_QJ_98
K2_Q7_98:
    s_add_u32 s40, s52, 175104
    buffer_load_dwordx4 v[104:107], v10, s[20:23], s40 offen
K2_QJ_98:
    v_exp_f32 v28, v28
    v_exp_f32 v29, v29
    v_exp_f32 v30, v30
    v_exp_f32 v31, v31
    v_exp_f32 v32, v32
    v_exp_f32 v33, v33
    s_cmp_ge_u32 s32, 7
    s_cbranch_scc1 K2_Q7_99
    s_add_u32 s40, s44, 87040
    buffer_load_dwordx4 v[156:159], v6, s[28:31], s40 offen
    s_branch K2_QJ_99
K2_Q7_99:
    s_add_u32 s40, s52, 203776
    buffer_load_dwordx4 v[108:111], v10, s[20:23], s40 offen
K2_QJ_99:
    v_exp_f32 v34, v34
    v_exp_f32 v35, v35
    v_exp_f32 v36, v36
    v_exp_f32 v37, v37
    v_exp_f32 v38, v38
    v_exp_f32 v39, v39
    s_cmp_ge_u32 s32, 7
    s_cbranch_scc1 K2_Q7_100
    s_add_u32 s40, s44, 88064
    buffer_load_dwordx4 v[160:163], v6, s[28:31], s40 offen
    s_branch K2_QJ_100
K2_Q7_100:
    s_add_u32 s40, s53, 0
    buffer_load_dwordx4 v[112:115], v11, s[24:27], s40 offen
K2_QJ_100:
    v_cvt_pk_bf16_f32 v56, v24, v25
    v_cvt_pk_bf16_f32 v57, v26, v27
    v_cvt_pk_bf16_f32 v58, v28, v29
    v_cvt_pk_bf16_f32 v59, v30, v31
    v_cvt_pk_bf16_f32 v60, v32, v33
    v_cvt_pk_bf16_f32 v61, v34, v35
    v_cvt_pk_bf16_f32 v62, v36, v37
    v_cvt_pk_bf16_f32 v63, v38, v39
    s_waitcnt lgkmcnt(2)
    v_mfma_f32_32x32x16_bf16 v[64:79], v[96:99], v[56:59], v[64:79]
    v_mfma_f32_32x32x16_bf16 v[64:79], v[100:103], v[60:63], v[64:79]
    ds_read_b128 v[96:99], v7 offset:22528
    ds_read_b128 v[100:103], v7 offset:23552
    s_waitcnt lgkmcnt(2)
    v_mfma_f32_32x32x16_bf16 v[24:39], v[80:83], v[16:19], 0
    v_mfma_f32_32x32x16_bf16 v[24:39], v[84:87], v[20:23], v[24:39]
    ds_read_b128 v[88:91], v7 offset:26624
    ds_read_b128 v[92:95], v7 offset:27648
    v_max3_f32 v217, v40, v41, v42
    v_max3_f32 v218, v43, v44, v45
    v_max3_f32 v217, v217, v46, v47
    v_max3_f32 v218, v218, v48, v49
    v_max3_f32 v217, v217, v50, v51
    v_max3_f32 v218, v218, v52, v53
    v_max3_f32 v217, v217, v54, v55
    v_max_f32 v217, v217, v218
    v_cmp_lt_f32 vcc, s46, v217
    s_cbranch_vccnz K2S_RARE13
K2S_BACK13:
    v_exp_f32 v40, v40
    v_exp_f32 v41, v41
    v_exp_f32 v42, v42
    v_exp_f32 v43, v43
    s_cmp_ge_u32 s32, 7
    s_cbranch_scc1 K2_Q7_101
    s_add_u32 s40, s44, 89088
    buffer_load_dwordx4 v[164:167], v6, s[28:31], s40 offen
    s_branch K2_QJ_101
K2_Q7_101:
    s_add_u32 s40, s53, 32768
    buffer_load_dwordx4 v[116:119], v11, s[24:27], s40 offen
K2_QJ_101:
    v_exp_f32 v44, v44
    v_exp_f32 v45, v45
    v_exp_f32 v46, v46
    v_exp_f32 v47, v47
    v_exp_f32 v48, v48
    v_exp_f32 v49, v49
    s_cmp_ge_u32 s32, 7
    s_cbranch_scc1 K2_Q7_102
    s_branch K2_QJ_102
K2_Q7_102:
    s_add_u32 s40, s53, 65536
    buffer_load_dwordx4 v[120:123], v11, s[24:27], s40 offen
K2_QJ_102:
    v_exp_f32 v50, v50
    v_exp_f32 v51, v51
    v_exp_f32 v52, v52
    v_exp_f32 v53, v53
    v_exp_f32 v54, v54
    v_exp_f32 v55, v55
    v_cvt_pk_bf16_f32 v56, v40, v41
    v_cvt_pk_bf16_f32 v57, v42, v43
    v_cvt_pk_bf16_f32 v58, v44, v45
    v_cvt_pk_bf16_f32 v59, v46, v47
    v_cvt_pk_bf16_f32 v60, v48, v49
    v_cvt_pk_bf16_f32 v61, v50, v51
    v_cvt_pk_bf16_f32 v62, v52, v53
    v_cvt_pk_bf16_f32 v63, v54, v55
    s_waitcnt lgkmcnt(2)
    v_mfma_f32_32x32x16_bf16 v[64:79], v[96:99], v[56:59], v[64:79]
    v_mfma_f32_32x32x16_bf16 v[64:79], v[100:103], v[60:63], v[64:79]
    s_cmp_ge_u32 s32, 7
    s_cbranch_scc1 K2S_W7_7
    s_waitcnt vmcnt(4)
    s_branch K2S_WJ_7
K2S_W7_7:
    s_waitcnt vmcnt(5)
K2S_WJ_7:
    s_barrier
    s_add_u32 s40, s39, 8192
    s_add_u32 s41, s38, 2134016
    s_mov_b32 m0, s40
    s_nop 0
    buffer_load_dwordx4 v6, s[28:31], s41 offen lds
    s_add_u32 s40, s39, 12288
    s_add_u32 s41, s38, 2265088
    s_mov_b32 m0, s40
    s_nop 0
    buffer_load_dwordx4 v6, s[28:31], s41 offen lds
    ds_read_b128 v[96:99], v7 offset:28672
    ds_read_b128 v[100:103], v7 offset:29696
    s_waitcnt lgkmcnt(2)
    v_mfma_f32_32x32x16_bf16 v[40:55], v[88:91], v[16:19], 0
    v_mfma_f32_32x32x16_bf16 v[40:55], v[92:95], v[20:23], v[40:55]
    ds_read_b128 v[80:83], v7 offset:0
    ds_read_b128 v[84:87], v7 offset:1024
    v_max3_f32 v217, v24, v25, v26
    v_max3_f32 v218, v27, v28, v29
    v_max3_f32 v217, v217, v30, v31
    v_max3_f32 v218, v218, v32, v33
    v_max3_f32 v217, v217, v34, v35
    v_max3_f32 v218, v218, v36, v37
    v_max3_f32 v217, v217, v38, v39
    v_max_f32 v217, v217, v218
    v_cmp_lt_f32 vcc, s46, v217
    s_cbranch_vccnz K2S_RARE14
K2S_BACK14:
    v_exp_f32 v24, v24
    v_exp_f32 v25, v25
    v_exp_f32 v26, v26
    v_exp_f32 v27, v27
    s_cmp_ge_u32 s32, 7
    s_cbranch_scc1 K2_Q7_103
    s_branch K2_QJ_103
K2_Q7_103:
    s_add_u32 s40, s53, 98304
    buffer_load_dwordx4 v[104:107], v11, s[24:27], s40 offen
K2_QJ_103:
    v_exp_f32 v28, v28
    v_exp_f32 v29, v29
    v_exp_f32 v30, v30
    v_exp_f32 v31, v31
    v_exp_f32 v32, v32
    v_exp_f32 v33, v33
    s_cmp_ge_u32 s32, 7
    s_cbranch_scc1 K2_Q7_104
    s_branch K2_QJ_104
K2_Q7_104:
    s_add_u32 s40, s53, 131072
    buffer_load_dwordx4 v[108:111], v11, s[24:27], s40 offen
K2_QJ_104:
    v_exp_f32 v34, v34
    v_exp_f32 v35, v35
    v_exp_f32 v36, v36
    v_exp_f32 v37, v37
    v_exp_f32 v38, v38
    v_exp_f32 v39, v39
    s_cmp_ge_u32 s32, 7
    s_cbranch_scc1 K2_Q7_105
    s_branch K2_QJ_105
K2_Q7_105:
    s_add_u32 s40, s53, 163840
    buffer_load_dwordx4 v[112:115], v11, s[24:27], s40 offen
K2_QJ_105:
    v_cvt_pk_bf16_f32 v56, v24, v25
    v_cvt_pk_bf16_f32 v57, v26, v27
    v_cvt_pk_bf16_f32 v58, v28, v29
    v_cvt_pk_bf16_f32 v59, v30, v31
    v_cvt_pk_bf16_f32 v60, v32, v33
    v_cvt_pk_bf16_f32 v61, v34, v35
    v_cvt_pk_bf16_f32 v62, v36, v37
    v_cvt_pk_bf16_f32 v63, v38, v39
    s_waitcnt lgkmcnt(2)
    v_mfma_f32_32x32x16_bf16 v[64:79], v[96:99], v[56:59], v[64:79]
    v_mfma_f32_32x32x16_bf16 v[64:79], v[100:103], v[60:63], v[64:79]
    ds_read_b128 v[96:99], v7 offset:30720
    ds_read_b128 v[100:103], v7 offset:31744
    s_waitcnt lgkmcnt(2)
    v_mfma_f32_32x32x16_bf16 v[24:39], v[80:83], v[16:19], 0
    v_mfma_f32_32x32x16_bf16 v[24:39], v[84:87], v[20:23], v[24:39]
    ds_read_b128 v[88:91], v7 offset:2048
    ds_read_b128 v[92:95], v7 offset:3072
    v_max3_f32 v217, v40, v41, v42
    v_max3_f32 v218, v43, v44, v45
    v_max3_f32 v217, v217, v46, v47
    v_max3_f32 v218, v218, v48, v49
    v_max3_f32 v217, v217, v50, v51
    v_max3_f32 v218, v218, v52, v53
    v_max3_f32 v217, v217, v54, v55
    v_max_f32 v217, v217, v218
    v_cmp_lt_f32 vcc, s46, v217
    s_cbranch_vccnz K2S_RARE15
K2S_BACK15:
    v_exp_f32 v40, v40
    v_exp_f32 v41, v41
    v_exp_f32 v42, v42
    v_exp_f32 v43, v43
    s_cmp_ge_u32 s32, 7
    s_cbranch_scc1 K2_Q7_106
    s_branch K2_QJ_106
K2_Q7_106:
    s_add_u32 s40, s53, 196608
    buffer_load_dwordx4 v[116:119], v11, s[24:27], s40 offen
K2_QJ_106:
    v_exp_f32 v44, v44
    v_exp_f32 v45, v45
    v_exp_f32 v46, v46
    v_exp_f32 v47, v47
    v_exp_f32 v48, v48
    v_exp_f32 v49, v49
    s_cmp_ge_u32 s32, 7
    s_cbranch_scc1 K2_Q7_107
    s_branch K2_QJ_107
K2_Q7_107:
    s_add_u32 s40, s53, 1024
    buffer_load_dwordx4 v[120:123], v11, s[24:27], s40 offen
K2_QJ_107:
    v_exp_f32 v50, v50
    v_exp_f32 v51, v51
    v_exp_f32 v52, v52
    v_exp_f32 v53, v53
    v_exp_f32 v54, v54
    v_exp_f32 v55, v55
    v_cvt_pk_bf16_f32 v56, v40, v41
    v_cvt_pk_bf16_f32 v57, v42, v43
    v_cvt_pk_bf16_f32 v58, v44, v45
    v_cvt_pk_bf16_f32 v59, v46, v47
    v_cvt_pk_bf16_f32 v60, v48, v49
    v_cvt_pk_bf16_f32 v61, v50, v51
    v_cvt_pk_bf16_f32 v62, v52, v53
    v_cvt_pk_bf16_f32 v63, v54, v55
    s_waitcnt lgkmcnt(2)
    v_mfma_f32_32x32x16_bf16 v[64:79], v[96:99], v[56:59], v[64:79]
    v_mfma_f32_32x32x16_bf16 v[64:79], v[100:103], v[60:63], v[64:79]
    s_cmp_ge_u32 s32, 7
    s_cbranch_scc1 K2S_W7_8
    s_waitcnt vmcnt(0)
    s_branch K2S_WJ_8
K2S_W7_8:
    s_waitcnt vmcnt(5)
K2S_WJ_8:
    s_barrier
    s_add_u32 s40, s39, 16384
    s_add_u32 s41, s38, 2138112
    s_mov_b32 m0, s40
    s_nop 0
    buffer_load_dwordx4 v6, s[28:31], s41 offen lds
    s_add_u32 s40, s39, 20480
    s_add_u32 s41, s38, 2269184
    s_mov_b32 m0, s40
    s_nop 0
    buffer_load_dwordx4 v6, s[28:31], s41 offen lds
    ds_read_b128 v[96:99], v7 offset:4096
    ds_read_b128 v[100:103], v7 offset:5120
    s_waitcnt lgkmcnt(2)
    v_mfma_f32_32x32x16_bf16 v[40:55], v[88:91], v[16:19], 0
    v_mfma_f32_32x32x16_bf16 v[40:55], v[92:95], v[20:23], v[40:55]
    ds_read_b128 v[80:83], v7 offset:8192
    ds_read_b128 v[84:87], v7 offset:9216
    v_max3_f32 v217, v24, v25, v26
    v_max3_f32 v218, v27, v28, v29
    v_max3_f32 v217, v217, v30, v31
    v_max3_f32 v218, v218, v32, v33
    v_max3_f32 v217, v217, v34, v35
    v_max3_f32 v218, v218, v36, v37
    v_max3_f32 v217, v217, v38, v39
    v_max_f32 v217, v217, v218
    v_cmp_lt_f32 vcc, s46, v217
    s_cbranch_vccnz K2S_RARE16
K2S_BACK16:
    v_exp_f32 v24, v24
    v_exp_f32 v25, v25
    v_exp_f32 v26, v26
    v_exp_f32 v27, v27
    s_cmp_ge_u32 s32, 7
    s_cbranch_scc1 K2_Q7_108
    s_add_u32 s40, s44, 114688
    buffer_load_dwordx4 v[168:171], v6, s[28:31], s40 offen
    s_branch K2_QJ_108
K2_Q7_108:
    s_add_u32 s40, s53, 33792
    buffer_load_dwordx4 v[104:107], v11, s[24:27], s40 offen
K2_QJ_108:
    v_exp_f32 v28, v28
    v_exp_f32 v29, v29
    v_exp_f32 v30, v30
    v_exp_f32 v31, v31
    v_exp_f32 v32, v32
    v_exp_f32 v33, v33
    s_cmp_ge_u32 s32, 7
    s_cbranch_scc1 K2_Q7_109
    s_add_u32 s40, s44, 115712
    buffer_load_dwordx4 v[172:175], v6, s[28:31], s40 offen
    s_branch K2_QJ_109
K2_Q7_109:
    s_add_u32 s40, s53, 66560
    buffer_load_dwordx4 v[108:111], v11, s[24:27], s40 offen
K2_QJ_109:
    v_exp_f32 v34, v34
    v_exp_f32 v35, v35
    v_exp_f32 v36, v36
    v_exp_f32 v37, v37
    v_exp_f32 v38, v38
    v_exp_f32 v39, v39
    s_cmp_ge_u32 s32, 7
    s_cbranch_scc1 K2_Q7_110
    s_add_u32 s40, s44, 116736
    buffer_load_dwordx4 v[176:179], v6, s[28:31], s40 offen
    s_branch K2_QJ_110
K2_Q7_110:
    s_add_u32 s40, s53, 99328
    buffer_load_dwordx4 v[112:115], v11, s[24:27], s40 offen
K2_QJ_110:
    v_cvt_pk_bf16_f32 v56, v24, v25
    v_cvt_pk_bf16_f32 v57, v26, v27
    v_cvt_pk_bf16_f32 v58, v28, v29
    v_cvt_pk_bf16_f32 v59, v30, v31
    v_cvt_pk_bf16_f32 v60, v32, v33
    v_cvt_pk_bf16_f32 v61, v34, v35
    v_cvt_pk_bf16_f32 v62, v36, v37
    v_cvt_pk_bf16_f32 v63, v38, v39
    s_waitcnt lgkmcnt(2)
    v_mfma_f32_32x32x16_bf16 v[64:79], v[96:99], v[56:59], v[64:79]
    v_mfma_f32_32x32x16_bf16 v[64:79], v[100:103], v[60:63], v[64:79]
    ds_read_b128 v[96:99], v7 offset:6144
    ds_read_b128 v[100:103], v7 offset:7168
    s_waitcnt lgkmcnt(2)
    v_mfma_f32_32x32x16_bf16 v[24:39], v[80:83], v[16:19], 0
    v_mfma_f32_32x32x16_bf16 v[24:39], v[84:87], v[20:23], v[24:39]
    ds_read_b128 v[88:91], v7 offset:10240
    ds_read_b128 v[92:95], v7 offset:11264
    v_max3_f32 v217, v40, v41, v42
    v_max3_f32 v218, v43, v44, v45
    v_max3_f32 v217, v217, v46, v47
    v_max3_f32 v218, v218, v48, v49
    v_max3_f32 v217, v217, v50, v51
    v_max3_f32 v218, v218, v52, v53
    v_max3_f32 v217, v217, v54, v55
    v_max_f32 v217, v217, v218
    v_cmp_lt_f32 vcc, s46, v217
    s_cbranch_vccnz K2S_RARE17
K2S_BACK17:
    v_exp_f32 v40, v40
    v_exp_f32 v41, v41
    v_exp_f32 v42, v42
    v_exp_f32 v43, v43
    s_cmp_ge_u32 s32, 7
    s_cbranch_scc1 K2_Q7_111
    s_add_u32 s40, s44, 117760
    buffer_load_dwordx4 v[180:183], v6, s[28:31], s40 offen
    s_branch K2_QJ_111
K2_Q7_111:
    s_add_u32 s40, s53, 132096
    buffer_load_dwordx4 v[116:119], v11, s[24:27], s40 offen
K2_QJ_111:
    v_exp_f32 v44, v44
    v_exp_f32 v45, v45
    v_exp_f32 v46, v46
    v_exp_f32 v47, v47
    v_exp_f32 v48, v48
    v_exp_f32 v49, v49
    s_cmp_ge_u32 s32, 7
    s_cbranch_scc1 K2_Q7_112
    s_branch K2_QJ_112
K2_Q7_112:
    s_add_u32 s40, s53, 164864
    buffer_load_dwordx4 v[120:123], v11, s[24:27], s40 offen
K2_QJ_112:
    v_exp_f32 v50, v50
    v_exp_f32 v51, v51
    v_exp_f32 v52, v52
    v_exp_f32 v53, v53
    v_exp_f32 v54, v54
    v_exp_f32 v55, v55
    v_cvt_pk_bf16_f32 v56, v40, v41
    v_cvt_pk_bf16_f32 v57, v42, v43
    v_cvt_pk_bf16_f32 v58, v44, v45
    v_cvt_pk_bf16_f32 v59, v46, v47
    v_cvt_pk_bf16_f32 v60, v48, v49
    v_cvt_pk_bf16_f32 v61, v50, v51
    v_cvt_pk_bf16_f32 v62, v52, v53
    v_cvt_pk_bf16_f32 v63, v54, v55
    s_waitcnt lgkmcnt(2)
    v_mfma_f32_32x32x16_bf16 v[64:79], v[96:99], v[56:59], v[64:79]
    v_mfma_f32_32x32x16_bf16 v[64:79], v[100:103], v[60:63], v[64:79]
    s_cmp_ge_u32 s32, 7
    s_cbranch_scc1 K2S_W7_9
    s_waitcnt vmcnt(4)
    s_branch K2S_WJ_9
K2S_W7_9:
    s_waitcnt vmcnt(5)
K2S_WJ_9:
    s_barrier
    s_add_u32 s40, s39, 24576
    s_add_u32 s41, s38, 2142208
    s_mov_b32 m0, s40
    s_nop 0
    buffer_load_dwordx4 v6, s[28:31], s41 offen lds
    s_add_u32 s40, s39, 28672
    s_add_u32 s41, s38, 2273280
    s_mov_b32 m0, s40
    s_nop 0
    buffer_load_dwordx4 v6, s[28:31], s41 offen lds
    ds_read_b128 v[96:99], v7 offset:12288
    ds_read_b128 v[100:103], v7 offset:13312
    s_waitcnt lgkmcnt(2)
    v_mfma_f32_32x32x16_bf16 v[40:55], v[88:91], v[16:19], 0
    v_mfma_f32_32x32x16_bf16 v[40:55], v[92:95], v[20:23], v[40:55]
    ds_read_b128 v[80:83], v7 offset:16384
    ds_read_b128 v[84:87], v7 offset:17408
    v_max3_f32 v217, v24, v25, v26
    v_max3_f32 v218, v27, v28, v29
    v_max3_f32 v217, v217, v30, v31
    v_max3_f32 v218, v218, v32, v33
    v_max3_f32 v217, v217, v34, v35
    v_max3_f32 v218, v218, v36, v37
    v_max3_f32 v217, v217, v38, v39
    v_max_f32 v217, v217, v218
    v_cmp_lt_f32 vcc, s46, v217
    s_cbranch_vccnz K2S_RARE18
K2S_BACK18:
    v_exp_f32 v24, v24
    v_exp_f32 v25, v25
    v_exp_f32 v26, v26
    v_exp_f32 v27, v27
    s_cmp_ge_u32 s32, 7
    s_cbranch_scc1 K2_Q7_113
    s_branch K2_QJ_113
K2_Q7_113:
    s_add_u32 s40, s53, 197632
    buffer_load_dwordx4 v[104:107], v11, s[24:27], s40 offen
K2_QJ_113:
    v_exp_f32 v28, v28
    v_exp_f32 v29, v29
    v_exp_f32 v30, v30
    v_exp_f32 v31, v31
    v_exp_f32 v32, v32
    v_exp_f32 v33, v33
    s_cmp_ge_u32 s32, 7
    s_cbranch_scc1 K2_Q7_114
    s_branch K2_QJ_114
K2_Q7_114:
    s_add_u32 s40, s53, 2048
    buffer_load_dwordx4 v[108:111], v11, s[24:27], s40 offen
K2_QJ_114:
    v_exp_f32 v34, v34
    v_exp_f32 v35, v35
    v_exp_f32 v36, v36
    v_exp_f32 v37, v37
    v_exp_f32 v38, v38
    v_exp_f32 v39, v39
    s_cmp_ge_u32 s32, 7
    s_cbranch_scc1 K2_Q7_115
    s_branch K2_QJ_115
K2_Q7_115:
    s_add_u32 s40, s53, 34816
    buffer_load_dwordx4 v[112:115], v11, s[24:27], s40 offen
K2_QJ_115:
    v_cvt_pk_bf16_f32 v56, v24, v25
    v_cvt_pk_bf16_f32 v57, v26, v27
    v_cvt_pk_bf16_f32 v58, v28, v29
    v_cvt_pk_bf16_f32 v59, v30, v31
    v_cvt_pk_bf16_f32 v60, v32, v33
    v_cvt_pk_bf16_f32 v61, v34, v35
    v_cvt_pk_bf16_f32 v62, v36, v37
    v_cvt_pk_bf16_f32 v63, v38, v39
    s_waitcnt lgkmcnt(2)
    v_mfma_f32_32x32x16_bf16 v[64:79], v[96:99], v[56:59], v[64:79]
    v_mfma_f32_32x32x16_bf16 v[64:79], v[100:103], v[60:63], v[64:79]
    ds_read_b128 v[96:99], v7 offset:14336
    ds_read_b128 v[100:103], v7 offset:15360
    s_waitcnt lgkmcnt(2)
    v_mfma_f32_32x32x16_bf16 v[24:39], v[80:83], v[16:19], 0
    v_mfma_f32_32x32x16_bf16 v[24:39], v[84:87], v[20:23], v[24:39]
    ds_read_b128 v[88:91], v7 offset:18432
    ds_read_b128 v[92:95], v7 offset:19456
    v_max3_f32 v217, v40, v41, v42
    v_max3_f32 v218, v43, v44, v45
    v_max3_f32 v217, v217, v46, v47
    v_max3_f32 v218, v218, v48, v49
    v_max3_f32 v217, v217, v50, v51
    v_max3_f32 v218, v218, v52, v53
    v_max3_f32 v217, v217, v54, v55
    v_max_f32 v217, v217, v218
    v_cmp_lt_f32 vcc, s46, v217
    s_cbranch_vccnz K2S_RARE19
K2S_BACK19:
    v_exp_f32 v40, v40
    v_exp_f32 v41, v41
    v_exp_f32 v42, v42
    v_exp_f32 v43, v43
    s_cmp_ge_u32 s32, 7
    s_cbranch_scc1 K2_Q7_116
    s_branch K2_QJ_116
K2_Q7_116:
    s_add_u32 s40, s53, 67584
    buffer_load_dwordx4 v[116:119], v11, s[24:27], s40 offen
K2_QJ_116:
    v_exp_f32 v44, v44
    v_exp_f32 v45, v45
    v_exp_f32 v46, v46
    v_exp_f32 v47, v47
    v_exp_f32 v48, v48
    v_exp_f32 v49, v49
    s_cmp_ge_u32 s32, 7
    s_cbranch_scc1 K2_Q7_117
    s_branch K2_QJ_117
K2_Q7_117:
    s_add_u32 s40, s53, 100352
    buffer_load_dwordx4 v[120:123], v11, s[24:27], s40 offen
K2_QJ_117:
    v_exp_f32 v50, v50
    v_exp_f32 v51, v51
    v_exp_f32 v52, v52
    v_exp_f32 v53, v53
    v_exp_f32 v54, v54
    v_exp_f32 v55, v55
    v_cvt_pk_bf16_f32 v56, v40, v41
    v_cvt_pk_bf16_f32 v57, v42, v43
    v_cvt_pk_bf16_f32 v58, v44, v45
    v_cvt_pk_bf16_f32 v59, v46, v47
    v_cvt_pk_bf16_f32 v60, v48, v49
    v_cvt_pk_bf16_f32 v61, v50, v51
    v_cvt_pk_bf16_f32 v62, v52, v53
    v_cvt_pk_bf16_f32 v63, v54, v55
    s_waitcnt lgkmcnt(2)
    v_mfma_f32_32x32x16_bf16 v[64:79], v[96:99], v[56:59], v[64:79]
    v_mfma_f32_32x32x16_bf16 v[64:79], v[100:103], v[60:63], v[64:79]
    s_cmp_ge_u32 s32, 7
    s_cbranch_scc1 K2S_W7_10
    s_waitcnt vmcnt(0)
    s_branch K2S_WJ_10
K2S_W7_10:
    s_waitcnt vmcnt(5)
K2S_WJ_10:
    s_barrier
    s_add_u32 s40, s39, 0
    s_add_u32 s41, s38, 2146304
    s_mov_b32 m0, s40
    s_nop 0
    buffer_load_dwordx4 v6, s[28:31], s41 offen lds
    s_add_u32 s40, s39, 4096
    s_add_u32 s41, s38, 2277376
    s_mov_b32 m0, s40
    s_nop 0
    buffer_load_dwordx4 v6, s[28:31], s41 offen lds
    ds_read_b128 v[96:99], v7 offset:20480
    ds_read_b128 v[100:103], v7 offset:21504
    s_waitcnt lgkmcnt(2)
    v_mfma_f32_32x32x16_bf16 v[40:55], v[88:91], v[16:19], 0
    v_mfma_f32_32x32x16_bf16 v[40:55], v[92:95], v[20:23], v[40:55]
    ds_read_b128 v[80:83], v7 offset:24576
    ds_read_b128 v[84:87], v7 offset:25600
    v_max3_f32 v217, v24, v25, v26
    v_max3_f32 v218, v27, v28, v29
    v_max3_f32 v217, v217, v30, v31
    v_max3_f32 v218, v218, v32, v33
    v_max3_f32 v217, v217, v34, v35
    v_max3_f32 v218, v218, v36, v37
    v_max3_f32 v217, v217, v38, v39
    v_max_f32 v217, v217, v218
    v_cmp_lt_f32 vcc, s46, v217
    s_cbranch_vccnz K2S_RARE20
K2S_BACK20:
    v_exp_f32 v24, v24
    v_exp_f32 v25, v25
    v_exp_f32 v26, v26
    v_exp_f32 v27, v27
    s_cmp_ge_u32 s32, 7
    s_cbranch_scc1 K2_Q7_118
    s_add_u32 s40, s44, 143360
    buffer_load_dwordx4 v[184:187], v6, s[28:31], s40 offen
    s_branch K2_QJ_118
K2_Q7_118:
    s_add_u32 s40, s53, 133120
    buffer_load_dwordx4 v[104:107], v11, s[24:27], s40 offen
K2_QJ_118:
    v_exp_f32 v28, v28
    v_exp_f32 v29, v29
    v_exp_f32 v30, v30
    v_exp_f32 v31, v31
    v_exp_f32 v32, v32
    v_exp_f32 v33, v33
    s_cmp_ge_u32 s32, 7
    s_cbranch_scc1 K2_Q7_119
    s_add_u32 s40, s44, 144384
    buffer_load_dwordx4 v[188:191], v6, s[28:31], s40 offen
    s_branch K2_QJ_119
K2_Q7_119:
    s_add_u32 s40, s53, 165888
    buffer_load_dwordx4 v[108:111], v11, s[24:27], s40 offen
K2_QJ_119:
    v_exp_f32 v34, v34
    v_exp_f32 v35, v35
    v_exp_f32 v36, v36
    v_exp_f32 v37, v37
    v_exp_f32 v38, v38
    v_exp_f32 v39, v39
    s_cmp_ge_u32 s32, 7
    s_cbranch_scc1 K2_Q7_120
    s_add_u32 s40, s44, 145408
    buffer_load_dwordx4 v[192:195], v6, s[28:31], s40 offen
    s_branch K2_QJ_120
K2_Q7_120:
    s_add_u32 s40, s53, 198656
    buffer_load_dwordx4 v[112:115], v11, s[24:27], s40 offen
K2_QJ_120:
    v_cvt_pk_bf16_f32 v56, v24, v25
    v_cvt_pk_bf16_f32 v57, v26, v27
    v_cvt_pk_bf16_f32 v58, v28, v29
    v_cvt_pk_bf16_f32 v59, v30, v31
    v_cvt_pk_bf16_f32 v60, v32, v33
    v_cvt_pk_bf16_f32 v61, v34, v35
    v_cvt_pk_bf16_f32 v62, v36, v37
    v_cvt_pk_bf16_f32 v63, v38, v39
    s_waitcnt lgkmcnt(2)
    v_mfma_f32_32x32x16_bf16 v[64:79], v[96:99], v[56:59], v[64:79]
    v_mfma_f32_32x32x16_bf16 v[64:79], v[100:103], v[60:63], v[64:79]
    ds_read_b128 v[96:99], v7 offset:22528
    ds_read_b128 v[100:103], v7 offset:23552
    s_waitcnt lgkmcnt(2)
    v_mfma_f32_32x32x16_bf16 v[24:39], v[80:83], v[16:19], 0
    v_mfma_f32_32x32x16_bf16 v[24:39], v[84:87], v[20:23], v[24:39]
    ds_read_b128 v[88:91], v7 offset:26624
    ds_read_b128 v[92:95], v7 offset:27648
    v_max3_f32 v217, v40, v41, v42
    v_max3_f32 v218, v43, v44, v45
    v_max3_f32 v217, v217, v46, v47
    v_max3_f32 v218, v218, v48, v49
    v_max3_f32 v217, v217, v50, v51
    v_max3_f32 v218, v218, v52, v53
    v_max3_f32 v217, v217, v54, v55
    v_max_f32 v217, v217, v218
    v_cmp_lt_f32 vcc, s46, v217
    s_cbranch_vccnz K2S_RARE21
K2S_BACK21:
    v_exp_f32 v40, v40
    v_exp_f32 v41, v41
    v_exp_f32 v42, v42
    v_exp_f32 v43, v43
    s_cmp_ge_u32 s32, 7
    s_cbranch_scc1 K2_Q7_121
    s_add_u32 s40, s44, 146432
    buffer_load_dwordx4 v[196:199], v6, s[28:31], s40 offen
    s_branch K2_QJ_121
K2_Q7_121:
    s_add_u32 s40, s53, 3072
    buffer_load_dwordx4 v[116:119], v11, s[24:27], s40 offen
K2_QJ_121:
    v_exp_f32 v44, v44
    v_exp_f32 v45, v45
    v_exp_f32 v46, v46
    v_exp_f32 v47, v47
    v_exp_f32 v48, v48
    v_exp_f32 v49, v49
    s_cmp_ge_u32 s32, 7
    s_cbranch_scc1 K2_Q7_122
    s_branch K2_QJ_122
K2_Q7_122:
    s_add_u32 s40, s53, 35840
    buffer_load_dwordx4 v[120:123], v11, s[24:27], s40 offen
K2_QJ_122:
    v_exp_f32 v50, v50
    v_exp_f32 v51, v51
    v_exp_f32 v52, v52
    v_exp_f32 v53, v53
    v_exp_f32 v54, v54
    v_exp_f32 v55, v55
    v_cvt_pk_bf16_f32 v56, v40, v41
    v_cvt_pk_bf16_f32 v57, v42, v43
    v_cvt_pk_bf16_f32 v58, v44, v45
    v_cvt_pk_bf16_f32 v59, v46, v47
    v_cvt_pk_bf16_f32 v60, v48, v49
    v_cvt_pk_bf16_f32 v61, v50, v51
    v_cvt_pk_bf16_f32 v62, v52, v53
    v_cvt_pk_bf16_f32 v63, v54, v55
    s_waitcnt lgkmcnt(2)
    v_mfma_f32_32x32x16_bf16 v[64:79], v[96:99], v[56:59], v[64:79]
    v_mfma_f32_32x32x16_bf16 v[64:79], v[100:103], v[60:63], v[64:79]
    s_cmp_ge_u32 s32, 7
    s_cbranch_scc1 K2S_W7_11
    s_waitcnt vmcnt(4)
    s_branch K2S_WJ_11
K2S_W7_11:
    s_waitcnt vmcnt(5)
K2S_WJ_11:
    s_barrier
    s_add_u32 s40, s39, 8192
    s_add_u32 s41, s38, 2150400
    s_mov_b32 m0, s40
    s_nop 0
    buffer_load_dwordx4 v6, s[28:31], s41 offen lds
    s_add_u32 s40, s39, 12288
    s_add_u32 s41, s38, 2281472
    s_mov_b32 m0, s40
    s_nop 0
    buffer_load_dwordx4 v6, s[28:31], s41 offen lds
    ds_read_b128 v[96:99], v7 offset:28672
    ds_read_b128 v[100:103], v7 offset:29696
    s_waitcnt lgkmcnt(2)
    v_mfma_f32_32x32x16_bf16 v[40:55], v[88:91], v[16:19], 0
    v_mfma_f32_32x32x16_bf16 v[40:55], v[92:95], v[20:23], v[40:55]
    ds_read_b128 v[80:83], v7 offset:0
    ds_read_b128 v[84:87], v7 offset:1024
    v_max3_f32 v217, v24, v25, v26
    v_max3_f32 v218, v27, v28, v29
    v_max3_f32 v217, v217, v30, v31
    v_max3_f32 v218, v218, v32, v33
    v_max3_f32 v217, v217, v34, v35
    v_max3_f32 v218, v218, v36, v37
    v_max3_f32 v217, v217, v38, v39
    v_max_f32 v217, v217, v218
    v_cmp_lt_f32 vcc, s46, v217
    s_cbranch_vccnz K2S_RARE22
K2S_BACK22:
    v_exp_f32 v24, v24
    v_exp_f32 v25, v25
    v_exp_f32 v26, v26
    v_exp_f32 v27, v27
    s_cmp_ge_u32 s32, 7
    s_cbranch_scc1 K2_Q7_123
    s_branch K2_QJ_123
K2_Q7_123:
    s_add_u32 s40, s53, 68608
    buffer_load_dwordx4 v[104:107], v11, s[24:27], s40 offen
K2_QJ_123:
    v_exp_f32 v28, v28
    v_exp_f32 v29, v29
    v_exp_f32 v30, v30
    v_exp_f32 v31, v31
    v_exp_f32 v32, v32
    v_exp_f32 v33, v33
    s_cmp_ge_u32 s32, 7
    s_cbranch_scc1 K2_Q7_124
    s_branch K2_QJ_124
K2_Q7_124:
    s_add_u32 s40, s53, 101376
    buffer_load_dwordx4 v[108:111], v11, s[24:27], s40 offen
K2_QJ_124:
    v_exp_f32 v34, v34
    v_exp_f32 v35, v35
    v_exp_f32 v36, v36
    v_exp_f32 v37, v37
    v_exp_f32 v38, v38
    v_exp_f32 v39, v39
    s_cmp_ge_u32 s32, 7
    s_cbranch_scc1 K2_Q7_125
    s_branch K2_QJ_125
K2_Q7_125:
    s_add_u32 s40, s53, 134144
    buffer_load_dwordx4 v[112:115], v11, s[24:27], s40 offen
K2_QJ_125:
    v_cvt_pk_bf16_f32 v56, v24, v25
    v_cvt_pk_bf16_f32 v57, v26, v27
    v_cvt_pk_bf16_f32 v58, v28, v29
    v_cvt_pk_bf16_f32 v59, v30, v31
    v_cvt_pk_bf16_f32 v60, v32, v33
    v_cvt_pk_bf16_f32 v61, v34, v35
    v_cvt_pk_bf16_f32 v62, v36, v37
    v_cvt_pk_bf16_f32 v63, v38, v39
    s_waitcnt lgkmcnt(2)
    v_mfma_f32_32x32x16_bf16 v[64:79], v[96:99], v[56:59], v[64:79]
    v_mfma_f32_32x32x16_bf16 v[64:79], v[100:103], v[60:63], v[64:79]
    ds_read_b128 v[96:99], v7 offset:30720
    ds_read_b128 v[100:103], v7 offset:31744
    s_waitcnt lgkmcnt(2)
    v_mfma_f32_32x32x16_bf16 v[24:39], v[80:83], v[16:19], 0
    v_mfma_f32_32x32x16_bf16 v[24:39], v[84:87], v[20:23], v[24:39]
    ds_read_b128 v[88:91], v7 offset:2048
    ds_read_b128 v[92:95], v7 offset:3072
    v_max3_f32 v217, v40, v41, v42
    v_max3_f32 v218, v43, v44, v45
    v_max3_f32 v217, v217, v46, v47
    v_max3_f32 v218, v218, v48, v49
    v_max3_f32 v217, v217, v50, v51
    v_max3_f32 v218, v218, v52, v53
    v_max3_f32 v217, v217, v54, v55
    v_max_f32 v217, v217, v218
    v_cmp_lt_f32 vcc, s46, v217
    s_cbranch_vccnz K2S_RARE23
K2S_BACK23:
    v_exp_f32 v40, v40
    v_exp_f32 v41, v41
    v_exp_f32 v42, v42
    v_exp_f32 v43, v43
    s_cmp_ge_u32 s32, 7
    s_cbranch_scc1 K2_Q7_126
    s_branch K2_QJ_126
K2_Q7_126:
    s_add_u32 s40, s53, 166912
    buffer_load_dwordx4 v[116:119], v11, s[24:27], s40 offen
K2_QJ_126:
    v_exp_f32 v44, v44
    v_exp_f32 v45, v45
    v_exp_f32 v46, v46
    v_exp_f32 v47, v47
    v_exp_f32 v48, v48
    v_exp_f32 v49, v49
    s_cmp_ge_u32 s32, 7
    s_cbranch_scc1 K2_Q7_127
    s_branch K2_QJ_127
K2_Q7_127:
    s_add_u32 s40, s53, 199680
    buffer_load_dwordx4 v[120:123], v11, s[24:27], s40 offen
K2_QJ_127:
    v_exp_f32 v50, v50
    v_exp_f32 v51, v51
    v_exp_f32 v52, v52
    v_exp_f32 v53, v53
    v_exp_f32 v54, v54
    v_exp_f32 v55, v55
    v_cvt_pk_bf16_f32 v56, v40, v41
    v_cvt_pk_bf16_f32 v57, v42, v43
    v_cvt_pk_bf16_f32 v58, v44, v45
    v_cvt_pk_bf16_f32 v59, v46, v47
    v_cvt_pk_bf16_f32 v60, v48, v49
    v_cvt_pk_bf16_f32 v61, v50, v51
    v_cvt_pk_bf16_f32 v62, v52, v53
    v_cvt_pk_bf16_f32 v63, v54, v55
    s_waitcnt lgkmcnt(2)
    v_mfma_f32_32x32x16_bf16 v[64:79], v[96:99], v[56:59], v[64:79]
    v_mfma_f32_32x32x16_bf16 v[64:79], v[100:103], v[60:63], v[64:79]
    s_cmp_ge_u32 s32, 7
    s_cbranch_scc1 K2S_W7_12
    s_waitcnt vmcnt(0)
    s_branch K2S_WJ_12
K2S_W7_12:
    s_waitcnt vmcnt(5)
K2S_WJ_12:
    s_barrier
    s_add_u32 s40, s39, 16384
    s_add_u32 s41, s38, 2154496
    s_mov_b32 m0, s40
    s_nop 0
    buffer_load_dwordx4 v6, s[28:31], s41 offen lds
    s_add_u32 s40, s39, 20480
    s_add_u32 s41, s38, 2285568
    s_mov_b32 m0, s40
    s_nop 0
    buffer_load_dwordx4 v6, s[28:31], s41 offen lds
    ds_read_b128 v[96:99], v7 offset:4096
    ds_read_b128 v[100:103], v7 offset:5120
    s_waitcnt lgkmcnt(2)
    v_mfma_f32_32x32x16_bf16 v[40:55], v[88:91], v[16:19], 0
    v_mfma_f32_32x32x16_bf16 v[40:55], v[92:95], v[20:23], v[40:55]
    ds_read_b128 v[80:83], v7 offset:8192
    ds_read_b128 v[84:87], v7 offset:9216
    v_max3_f32 v217, v24, v25, v26
    v_max3_f32 v218, v27, v28, v29
    v_max3_f32 v217, v217, v30, v31
    v_max3_f32 v218, v218, v32, v33
    v_max3_f32 v217, v217, v34, v35
    v_max3_f32 v218, v218, v36, v37
    v_max3_f32 v217, v217, v38, v39
    v_max_f32 v217, v217, v218
    v_cmp_lt_f32 vcc, s46, v217
    s_cbranch_vccnz K2S_RARE24
K2S_BACK24:
    v_exp_f32 v24, v24
    v_exp_f32 v25, v25
    v_exp_f32 v26, v26
    v_exp_f32 v27, v27
    s_cmp_ge_u32 s32, 7
    s_cbranch_scc1 K2_Q7_128
    s_add_u32 s40, s44, 172032
    buffer_load_dwordx4 v[200:203], v6, s[28:31], s40 offen
    s_branch K2_QJ_128
K2_Q7_128:
K2_QJ_128:
    v_exp_f32 v28, v28
    v_exp_f32 v29, v29
    v_exp_f32 v30, v30
    v_exp_f32 v31, v31
    v_exp_f32 v32, v32
    v_exp_f32 v33, v33
    s_cmp_ge_u32 s32, 7
    s_cbranch_scc1 K2_Q7_129
    s_add_u32 s40, s44, 173056
    buffer_load_dwordx4 v[204:207], v6, s[28:31], s40 offen
    s_branch K2_QJ_129
K2_Q7_129:
K2_QJ_129:
    v_exp_f32 v34, v34
    v_exp_f32 v35, v35
    v_exp_f32 v36, v36
    v_exp_f32 v37, v37
    v_exp_f32 v38, v38
    v_exp_f32 v39, v39
    s_cmp_ge_u32 s32, 7
    s_cbranch_scc1 K2_Q7_130
    s_add_u32 s40, s44, 174080
    buffer_load_dwordx4 v[208:211], v6, s[28:31], s40 offen
    s_branch K2_QJ_130
K2_Q7_130:
K2_QJ_130:
    v_cvt_pk_bf16_f32 v56, v24, v25
    v_cvt_pk_bf16_f32 v57, v26, v27
    v_cvt_pk_bf16_f32 v58, v28, v29
    v_cvt_pk_bf16_f32 v59, v30, v31
    v_cvt_pk_bf16_f32 v60, v32, v33
    v_cvt_pk_bf16_f32 v61, v34, v35
    v_cvt_pk_bf16_f32 v62, v36, v37
    v_cvt_pk_bf16_f32 v63, v38, v39
    s_waitcnt lgkmcnt(2)
    v_mfma_f32_32x32x16_bf16 v[64:79], v[96:99], v[56:59], v[64:79]
    v_mfma_f32_32x32x16_bf16 v[64:79], v[100:103], v[60:63], v[64:79]
    ds_read_b128 v[96:99], v7 offset:6144
    ds_read_b128 v[100:103], v7 offset:7168
    s_waitcnt lgkmcnt(2)
    v_mfma_f32_32x32x16_bf16 v[24:39], v[80:83], v[16:19], 0
    v_mfma_f32_32x32x16_bf16 v[24:39], v[84:87], v[20:23], v[24:39]
    ds_read_b128 v[88:91], v7 offset:10240
    ds_read_b128 v[92:95], v7 offset:11264
    v_max3_f32 v217, v40, v41, v42
    v_max3_f32 v218, v43, v44, v45
    v_max3_f32 v217, v217, v46, v47
    v_max3_f32 v218, v218, v48, v49
    v_max3_f32 v217, v217, v50, v51
    v_max3_f32 v218, v218, v52, v53
    v_max3_f32 v217, v217, v54, v55
    v_max_f32 v217, v217, v218
    v_cmp_lt_f32 vcc, s46, v217
    s_cbranch_vccnz K2S_RARE25
K2S_BACK25:
    v_exp_f32 v40, v40
    v_exp_f32 v41, v41
    v_exp_f32 v42, v42
    v_exp_f32 v43, v43
    s_cmp_ge_u32 s32, 7
    s_cbranch_scc1 K2_Q7_131
    s_add_u32 s40, s44, 175104
    buffer_load_dwordx4 v[212:215], v6, s[28:31], s40 offen
    s_branch K2_QJ_131
K2_Q7_131:
K2_QJ_131:
    v_exp_f32 v44, v44
    v_exp_f32 v45, v45
    v_exp_f32 v46, v46
    v_exp_f32 v47, v47
    v_exp_f32 v48, v48
    v_exp_f32 v49, v49
    v_exp_f32 v50, v50
    v_exp_f32 v51, v51
    v_exp_f32 v52, v52
    v_exp_f32 v53, v53
    v_exp_f32 v54, v54
    v_exp_f32 v55, v55
    v_cvt_pk_bf16_f32 v56, v40, v41
    v_cvt_pk_bf16_f32 v57, v42, v43
    v_cvt_pk_bf16_f32 v58, v44, v45
    v_cvt_pk_bf16_f32 v59, v46, v47
    v_cvt_pk_bf16_f32 v60, v48, v49
    v_cvt_pk_bf16_f32 v61, v50, v51
    v_cvt_pk_bf16_f32 v62, v52, v53
    v_cvt_pk_bf16_f32 v63, v54, v55
    s_waitcnt lgkmcnt(2)
    v_mfma_f32_32x32x16_bf16 v[64:79], v[96:99], v[56:59], v[64:79]
    v_mfma_f32_32x32x16_bf16 v[64:79], v[100:103], v[60:63], v[64:79]
    s_cmp_ge_u32 s32, 7
    s_cbranch_scc1 K2S_W7_13
    s_waitcnt vmcnt(4)
    s_branch K2S_WJ_13
K2S_W7_13:
    s_waitcnt vmcnt(0)
K2S_WJ_13:
    s_barrier
    s_add_u32 s40, s39, 24576
    s_add_u32 s41, s38, 2158592
    s_mov_b32 m0, s40
    s_nop 0
    buffer_load_dwordx4 v6, s[28:31], s41 offen lds
    s_add_u32 s40, s39, 28672
    s_add_u32 s41, s38, 2289664
    s_mov_b32 m0, s40
    s_nop 0
    buffer_load_dwordx4 v6, s[28:31], s41 offen lds
    ds_read_b128 v[96:99], v7 offset:12288
    ds_read_b128 v[100:103], v7 offset:13312
    s_waitcnt lgkmcnt(2)
    v_mfma_f32_32x32x16_bf16 v[40:55], v[88:91], v[16:19], 0
    v_mfma_f32_32x32x16_bf16 v[40:55], v[92:95], v[20:23], v[40:55]
    ds_read_b128 v[80:83], v7 offset:16384
    ds_read_b128 v[84:87], v7 offset:17408
    v_max3_f32 v217, v24, v25, v26
    v_max3_f32 v218, v27, v28, v29
    v_max3_f32 v217, v217, v30, v31
    v_max3_f32 v218, v218, v32, v33
    v_max3_f32 v217, v217, v34, v35
    v_max3_f32 v218, v218, v36, v37
    v_max3_f32 v217, v217, v38, v39
    v_max_f32 v217, v217, v218
    v_cmp_lt_f32 vcc, s46, v217
    s_cbranch_vccnz K2S_RARE26
K2S_BACK26:
    v_exp_f32 v24, v24
    v_exp_f32 v25, v25
    v_exp_f32 v26, v26
    v_exp_f32 v27, v27
    s_cmp_ge_u32 s32, 7
    s_cbranch_scc1 K2_Q7_132
    s_add_u32 s40, s44, 200704
    buffer_load_dwordx4 v[240:243], v6, s[28:31], s40 offen
    s_branch K2_QJ_132
K2_Q7_132:
K2_QJ_132:
    v_exp_f32 v28, v28
    v_exp_f32 v29, v29
    v_exp_f32 v30, v30
    v_exp_f32 v31, v31
    v_exp_f32 v32, v32
    v_exp_f32 v33, v33
    s_cmp_ge_u32 s32, 7
    s_cbranch_scc1 K2_Q7_133
    s_add_u32 s40, s44, 201728
    buffer_load_dwordx4 v[244:247], v6, s[28:31], s40 offen
    s_branch K2_QJ_133
K2_Q7_133:
K2_QJ_133:
    v_exp_f32 v34, v34
    v_exp_f32 v35, v35
    v_exp_f32 v36, v36
    v_exp_f32 v37, v37
    v_exp_f32 v38, v38
    v_exp_f32 v39, v39
    s_cmp_ge_u32 s32, 7
    s_cbranch_scc1 K2_Q7_134
    s_add_u32 s40, s44, 202752
    buffer_load_dwordx4 v[248:251], v6, s[28:31], s40 offen
    s_branch K2_QJ_134
K2_Q7_134:
K2_QJ_134:
    v_cvt_pk_bf16_f32 v56, v24, v25
    v_cvt_pk_bf16_f32 v57, v26, v27
    v_cvt_pk_bf16_f32 v58, v28, v29
    v_cvt_pk_bf16_f32 v59, v30, v31
    v_cvt_pk_bf16_f32 v60, v32, v33
    v_cvt_pk_bf16_f32 v61, v34, v35
    v_cvt_pk_bf16_f32 v62, v36, v37
    v_cvt_pk_bf16_f32 v63, v38, v39
    s_waitcnt lgkmcnt(2)
    v_mfma_f32_32x32x16_bf16 v[64:79], v[96:99], v[56:59], v[64:79]
    v_mfma_f32_32x32x16_bf16 v[64:79], v[100:103], v[60:63], v[64:79]
    ds_read_b128 v[96:99], v7 offset:14336
    ds_read_b128 v[100:103], v7 offset:15360
    s_waitcnt lgkmcnt(2)
    v_mfma_f32_32x32x16_bf16 v[24:39], v[80:83], v[16:19], 0
    v_mfma_f32_32x32x16_bf16 v[24:39], v[84:87], v[20:23], v[24:39]
    ds_read_b128 v[88:91], v7 offset:18432
    ds_read_b128 v[92:95], v7 offset:19456
    v_max3_f32 v217, v40, v41, v42
    v_max3_f32 v218, v43, v44, v45
    v_max3_f32 v217, v217, v46, v47
    v_max3_f32 v218, v218, v48, v49
    v_max3_f32 v217, v217, v50, v51
    v_max3_f32 v218, v218, v52, v53
    v_max3_f32 v217, v217, v54, v55
    v_max_f32 v217, v217, v218
    v_cmp_lt_f32 vcc, s46, v217
    s_cbranch_vccnz K2S_RARE27
K2S_BACK27:
    v_exp_f32 v40, v40
    v_exp_f32 v41, v41
    v_exp_f32 v42, v42
    v_exp_f32 v43, v43
    s_cmp_ge_u32 s32, 7
    s_cbranch_scc1 K2_Q7_135
    s_add_u32 s40, s44, 203776
    buffer_load_dwordx4 v[252:255], v6, s[28:31], s40 offen
    s_branch K2_QJ_135
K2_Q7_135:
K2_QJ_135:
    v_exp_f32 v44, v44
    v_exp_f32 v45, v45
    v_exp_f32 v46, v46
    v_exp_f32 v47, v47
    v_exp_f32 v48, v48
    v_exp_f32 v49, v49
    v_exp_f32 v50, v50
    v_exp_f32 v51, v51
    v_exp_f32 v52, v52
    v_exp_f32 v53, v53
    v_exp_f32 v54, v54
    v_exp_f32 v55, v55
    v_cvt_pk_bf16_f32 v56, v40, v41
    v_cvt_pk_bf16_f32 v57, v42, v43
    v_cvt_pk_bf16_f32 v58, v44, v45
    v_cvt_pk_bf16_f32 v59, v46, v47
    v_cvt_pk_bf16_f32 v60, v48, v49
    v_cvt_pk_bf16_f32 v61, v50, v51
    v_cvt_pk_bf16_f32 v62, v52, v53
    v_cvt_pk_bf16_f32 v63, v54, v55
    s_waitcnt lgkmcnt(2)
    v_mfma_f32_32x32x16_bf16 v[64:79], v[96:99], v[56:59], v[64:79]
    v_mfma_f32_32x32x16_bf16 v[64:79], v[100:103], v[60:63], v[64:79]
    s_cmp_ge_u32 s32, 7
    s_cbranch_scc1 K2S_W7_14
    s_waitcnt vmcnt(4)
    s_branch K2S_WJ_14
K2S_W7_14:
    s_waitcnt vmcnt(0)
K2S_WJ_14:
    s_barrier
    ds_read_b128 v[96:99], v7 offset:20480
    ds_read_b128 v[100:103], v7 offset:21504
    s_waitcnt lgkmcnt(2)
    v_mfma_f32_32x32x16_bf16 v[40:55], v[88:91], v[16:19], 0
    v_mfma_f32_32x32x16_bf16 v[40:55], v[92:95], v[20:23], v[40:55]
    ds_read_b128 v[80:83], v7 offset:24576
    ds_read_b128 v[84:87], v7 offset:25600
    v_max3_f32 v217, v24, v25, v26
    v_max3_f32 v218, v27, v28, v29
    v_max3_f32 v217, v217, v30, v31
    v_max3_f32 v218, v218, v32, v33
    v_max3_f32 v217, v217, v34, v35
    v_max3_f32 v218, v218, v36, v37
    v_max3_f32 v217, v217, v38, v39
    v_max_f32 v217, v217, v218
    v_cmp_lt_f32 vcc, s46, v217
    s_cbranch_vccnz K2S_RARE28
K2S_BACK28:
    v_exp_f32 v24, v24
    v_exp_f32 v25, v25
    v_exp_f32 v26, v26
    v_exp_f32 v27, v27
    v_exp_f32 v28, v28
    v_exp_f32 v29, v29
    v_exp_f32 v30, v30
    v_exp_f32 v31, v31
    v_exp_f32 v32, v32
    v_exp_f32 v33, v33
    v_exp_f32 v34, v34
    v_exp_f32 v35, v35
    v_exp_f32 v36, v36
    v_exp_f32 v37, v37
    v_exp_f32 v38, v38
    v_exp_f32 v39, v39
    v_cvt_pk_bf16_f32 v56, v24, v25
    v_cvt_pk_bf16_f32 v57, v26, v27
    v_cvt_pk_bf16_f32 v58, v28, v29
    v_cvt_pk_bf16_f32 v59, v30, v31
    v_cvt_pk_bf16_f32 v60, v32, v33
    v_cvt_pk_bf16_f32 v61, v34, v35
    v_cvt_pk_bf16_f32 v62, v36, v37
    v_cvt_pk_bf16_f32 v63, v38, v39
    s_waitcnt lgkmcnt(2)
    v_mfma_f32_32x32x16_bf16 v[64:79], v[96:99], v[56:59], v[64:79]
    v_mfma_f32_32x32x16_bf16 v[64:79], v[100:103], v[60:63], v[64:79]
    ds_read_b128 v[96:99], v7 offset:22528
    ds_read_b128 v[100:103], v7 offset:23552
    s_waitcnt lgkmcnt(2)
    v_mfma_f32_32x32x16_bf16 v[24:39], v[80:83], v[16:19], 0
    v_mfma_f32_32x32x16_bf16 v[24:39], v[84:87], v[20:23], v[24:39]
    ds_read_b128 v[88:91], v7 offset:26624
    ds_read_b128 v[92:95], v7 offset:27648
    v_max3_f32 v217, v40, v41, v42
    v_max3_f32 v218, v43, v44, v45
    v_max3_f32 v217, v217, v46, v47
    v_max3_f32 v218, v218, v48, v49
    v_max3_f32 v217, v217, v50, v51
    v_max3_f32 v218, v218, v52, v53
    v_max3_f32 v217, v217, v54, v55
    v_max_f32 v217, v217, v218
    v_cmp_lt_f32 vcc, s46, v217
    s_cbranch_vccnz K2S_RARE29
K2S_BACK29:
    v_exp_f32 v40, v40
    v_exp_f32 v41, v41
    v_exp_f32 v42, v42
    v_exp_f32 v43, v43
    v_exp_f32 v44, v44
    v_exp_f32 v45, v45
    v_exp_f32 v46, v46
    v_exp_f32 v47, v47
    v_exp_f32 v48, v48
    v_exp_f32 v49, v49
    v_exp_f32 v50, v50
    v_exp_f32 v51, v51
    v_exp_f32 v52, v52
    v_exp_f32 v53, v53
    v_exp_f32 v54, v54
    v_exp_f32 v55, v55
    v_cvt_pk_bf16_f32 v56, v40, v41
    v_cvt_pk_bf16_f32 v57, v42, v43
    v_cvt_pk_bf16_f32 v58, v44, v45
    v_cvt_pk_bf16_f32 v59, v46, v47
    v_cvt_pk_bf16_f32 v60, v48, v49
    v_cvt_pk_bf16_f32 v61, v50, v51
    v_cvt_pk_bf16_f32 v62, v52, v53
    v_cvt_pk_bf16_f32 v63, v54, v55
    s_waitcnt lgkmcnt(2)
    v_mfma_f32_32x32x16_bf16 v[64:79], v[96:99], v[56:59], v[64:79]
    v_mfma_f32_32x32x16_bf16 v[64:79], v[100:103], v[60:63], v[64:79]
    s_barrier
    ds_read_b128 v[96:99], v7 offset:28672
    ds_read_b128 v[100:103], v7 offset:29696
    s_waitcnt lgkmcnt(2)
    v_mfma_f32_32x32x16_bf16 v[40:55], v[88:91], v[16:19], 0
    v_mfma_f32_32x32x16_bf16 v[40:55], v[92:95], v[20:23], v[40:55]
    v_max3_f32 v217, v24, v25, v26
    v_max3_f32 v218, v27, v28, v29
    v_max3_f32 v217, v217, v30, v31
    v_max3_f32 v218, v218, v32, v33
    v_max3_f32 v217, v217, v34, v35
    v_max3_f32 v218, v218, v36, v37
    v_max3_f32 v217, v217, v38, v39
    v_max_f32 v217, v217, v218
    v_cmp_lt_f32 vcc, s46, v217
    s_cbranch_vccnz K2S_RARE30
K2S_BACK30:
    v_exp_f32 v24, v24
    v_exp_f32 v25, v25
    v_exp_f32 v26, v26
    v_exp_f32 v27, v27
    v_exp_f32 v28, v28
    v_exp_f32 v29, v29
    v_exp_f32 v30, v30
    v_exp_f32 v31, v31
    v_exp_f32 v32, v32
    v_exp_f32 v33, v33
    v_exp_f32 v34, v34
    v_exp_f32 v35, v35
    v_exp_f32 v36, v36
    v_exp_f32 v37, v37
    v_exp_f32 v38, v38
    v_exp_f32 v39, v39
    v_cvt_pk_bf16_f32 v56, v24, v25
    v_cvt_pk_bf16_f32 v57, v26, v27
    v_cvt_pk_bf16_f32 v58, v28, v29
    v_cvt_pk_bf16_f32 v59, v30, v31
    v_cvt_pk_bf16_f32 v60, v32, v33
    v_cvt_pk_bf16_f32 v61, v34, v35
    v_cvt_pk_bf16_f32 v62, v36, v37
    v_cvt_pk_bf16_f32 v63, v38, v39
    s_waitcnt lgkmcnt(0)
    v_mfma_f32_32x32x16_bf16 v[64:79], v[96:99], v[56:59], v[64:79]
    v_mfma_f32_32x32x16_bf16 v[64:79], v[100:103], v[60:63], v[64:79]
    ds_read_b128 v[96:99], v7 offset:30720
    ds_read_b128 v[100:103], v7 offset:31744
    s_nop 7
    v_max3_f32 v217, v40, v41, v42
    v_max3_f32 v218, v43, v44, v45
    v_max3_f32 v217, v217, v46, v47
    v_max3_f32 v218, v218, v48, v49
    v_max3_f32 v217, v217, v50, v51
    v_max3_f32 v218, v218, v52, v53
    v_max3_f32 v217, v217, v54, v55
    v_max_f32 v217, v217, v218
    v_cmp_lt_f32 vcc, s46, v217
    s_cbranch_vccnz K2S_RARE31
K2S_BACK31:
    v_exp_f32 v40, v40
    v_exp_f32 v41, v41
    v_exp_f32 v42, v42
    v_exp_f32 v43, v43
    v_exp_f32 v44, v44
    v_exp_f32 v45, v45
    v_exp_f32 v46, v46
    v_exp_f32 v47, v47
    v_exp_f32 v48, v48
    v_exp_f32 v49, v49
    v_exp_f32 v50, v50
    v_exp_f32 v51, v51
    v_exp_f32 v52, v52
    v_exp_f32 v53, v53
    v_exp_f32 v54, v54
    v_exp_f32 v55, v55
    v_cvt_pk_bf16_f32 v56, v40, v41
    v_cvt_pk_bf16_f32 v57, v42, v43
    v_cvt_pk_bf16_f32 v58, v44, v45
    v_cvt_pk_bf16_f32 v59, v46, v47
    v_cvt_pk_bf16_f32 v60, v48, v49
    v_cvt_pk_bf16_f32 v61, v50, v51
    v_cvt_pk_bf16_f32 v62, v52, v53
    v_cvt_pk_bf16_f32 v63, v54, v55
    s_waitcnt lgkmcnt(0)
    v_mfma_f32_32x32x16_bf16 v[64:79], v[96:99], v[56:59], v[64:79]
    v_mfma_f32_32x32x16_bf16 v[64:79], v[100:103], v[60:63], v[64:79]
K2_LOOPEND:
    s_cmp_ge_u32 s32, 7
    s_cbranch_scc1 K2_NOLATE
    s_add_u32 s40, s44, 315392
    buffer_load_dwordx4 v[24:27], v6, s[28:31], s40 offen
    s_add_u32 s40, s44, 316416
    buffer_load_dwordx4 v[28:31], v6, s[28:31], s40 offen
    s_add_u32 s40, s44, 317440
    buffer_load_dwordx4 v[32:35], v6, s[28:31], s40 offen
    s_add_u32 s40, s44, 318464
    buffer_load_dwordx4 v[36:39], v6, s[28:31], s40 offen
    s_add_u32 s40, s44, 344064
    buffer_load_dwordx4 v[40:43], v6, s[28:31], s40 offen
    s_add_u32 s40, s44, 345088
    buffer_load_dwordx4 v[44:47], v6, s[28:31], s40 offen
    s_add_u32 s40, s44, 346112
    buffer_load_dwordx4 v[48:51], v6, s[28:31], s40 offen
    s_add_u32 s40, s44, 347136
    buffer_load_dwordx4 v[52:55], v6, s[28:31], s40 offen
    s_add_u32 s40, s44, 372736
    buffer_load_dwordx4 v[56:59], v6, s[28:31], s40 offen
    s_add_u32 s40, s44, 373760
    buffer_load_dwordx4 v[60:63], v6, s[28:31], s40 offen
    s_add_u32 s40, s44, 374784
    buffer_load_dwordx4 v[80:83], v6, s[28:31], s40 offen
    s_add_u32 s40, s44, 375808
    buffer_load_dwordx4 v[84:87], v6, s[28:31], s40 offen
K2_NOLATE:
    s_barrier
    v_and_b32 v10, 15, v2
    v_lshrrev_b32 v11, 4, v2
    s_movk_i32 s40, 896
    v_mul_lo_u32 v12, v10, s40
    v_lshl_add_u32 v12, v11, 3, v12
    s_mul_i32 s40, s2, 7168
    s_lshl_b32 s41, s32, 7
    s_add_u32 s40, s40, s41
    v_cmp_gt_u32 vcc, 8, v10
    v_mov_b32 v13, 0x7fffffff
    s_nop 0
    v_cndmask_b32 v12, v13, v12, vcc
    buffer_load_dwordx2 v[232:233], v12, s[16:19], s40 offen offset:0
    buffer_load_dwordx2 v[234:235], v12, s[16:19], s40 offen offset:32
    buffer_load_dwordx2 v[236:237], v12, s[16:19], s40 offen offset:64
    buffer_load_dwordx2 v[238:239], v12, s[16:19], s40 offen offset:96
    v_lshlrev_b32 v14, 6, v2
    s_lshl_b32 s40, s33, 12
    v_add_u32 v14, s40, v14
    s_lshl_b32 s40, s33, 8
    s_add_u32 s40, s40, 151552
    v_lshlrev_b32 v9, 2, v2
    v_add_u32 v9, s40, v9
    s_cmp_eq_u32 s34, 0
    s_cbranch_scc1 K2_MRG0
    ds_write_b128 v14, v[64:67] offset:0
    ds_write_b128 v14, v[68:71] offset:16
    ds_write_b128 v14, v[72:75] offset:32
    ds_write_b128 v14, v[76:79] offset:48
    ds_write_b32 v9, v216
    s_waitcnt lgkmcnt(0)
    s_barrier
    s_branch K2_MRG1
K2_MRG0:
    s_barrier
    ds_read_b128 v[88:91], v14 offset:0
    ds_read_b128 v[92:95], v14 offset:16
    ds_read_b128 v[96:99], v14 offset:32
    ds_read_b128 v[100:103], v14 offset:48
    ds_read_b32 v217, v9
    s_waitcnt lgkmcnt(0)
    v_max_f32 v218, v216, v217
    v_sub_f32 v219, v216, v218
    v_sub_f32 v220, v217, v218
    v_exp_f32 v219, v219
    v_exp_f32 v220, v220
    s_nop 0
    v_mul_f32 v64, v64, v219
    v_mul_f32 v65, v65, v219
    v_mul_f32 v66, v66, v219
    v_mul_f32 v67, v67, v219
    v_mul_f32 v68, v68, v219
    v_mul_f32 v69, v69, v219
    v_mul_f32 v70, v70, v219
    v_mul_f32 v71, v71, v219
    v_mul_f32 v72, v72, v219
    v_mul_f32 v73, v73, v219
    v_mul_f32 v74, v74, v219
    v_mul_f32 v75, v75, v219
    v_mul_f32 v76, v76, v219
    v_mul_f32 v77, v77, v219
    v_mul_f32 v78, v78, v219
    v_mul_f32 v79, v79, v219
    v_fmac_f32 v64, v88, v220
    v_fmac_f32 v65, v89, v220
    v_fmac_f32 v66, v90, v220
    v_fmac_f32 v67, v91, v220
    v_fmac_f32 v68, v92, v220
    v_fmac_f32 v69, v93, v220
    v_fmac_f32 v70, v94, v220
    v_fmac_f32 v71, v95, v220
    v_fmac_f32 v72, v96, v220
    v_fmac_f32 v73, v97, v220
    v_fmac_f32 v74, v98, v220
    v_fmac_f32 v75, v99, v220
    v_fmac_f32 v76, v100, v220
    v_fmac_f32 v77, v101, v220
    v_fmac_f32 v78, v102, v220
    v_fmac_f32 v79, v103, v220
    v_or_b32 v221, 32, v2
    v_lshlrev_b32 v221, 2, v221
    ds_bpermute_b32 v222, v221, v76
    s_waitcnt lgkmcnt(0)
    v_rcp_f32 v222, v222
    s_nop 0
    v_mul_f32 v64, v64, v222
    v_mul_f32 v65, v65, v222
    v_mul_f32 v66, v66, v222
    v_mul_f32 v67, v67, v222
    v_mul_f32 v68, v68, v222
    v_mul_f32 v69, v69, v222
    v_mul_f32 v70, v70, v222
    v_mul_f32 v71, v71, v222
    v_mul_f32 v72, v72, v222
    v_mul_f32 v73, v73, v222
    v_mul_f32 v74, v74, v222
    v_mul_f32 v75, v75, v222
    v_mul_f32 v76, v76, v222
    v_mul_f32 v77, v77, v222
    v_mul_f32 v78, v78, v222
    v_mul_f32 v79, v79, v222
    v_cvt_pk_bf16_f32 v88, v64, v65
    v_cvt_pk_bf16_f32 v89, v66, v67
    v_cvt_pk_bf16_f32 v90, v68, v69
    v_cvt_pk_bf16_f32 v91, v70, v71
    v_cvt_pk_bf16_f32 v92, v72, v73
    v_cvt_pk_bf16_f32 v93, v74, v75
    v_cvt_pk_bf16_f32 v94, v76, v77
    v_cvt_pk_bf16_f32 v95, v78, v79
    v_and_b32 v8, 7, v2
    v_mul_u32_u24 v8, 912, v8
    v_bfe_u32 v9, v2, 3, 2
    s_lshl_b32 s40, s33, 2
    v_add_u32 v9, s40, v9
    v_mul_u32_u24 v9, 56, v9
    v_add_u32 v8, v8, v9
    v_lshl_add_u32 v8, v5, 3, v8
    ds_write_b64 v8, v[88:89] offset:36864
    ds_write_b64 v8, v[90:91] offset:36880
    ds_write_b64 v8, v[92:93] offset:36896
    v_cmp_gt_u32 vcc, 32, v2
    s_and_saveexec_b64 s[46:47], vcc
    ds_write_b64 v8, v[94:95] offset:36912
    s_mov_b64 exec, s[46:47]
K2_MRG1:
    s_waitcnt vmcnt(0) lgkmcnt(0)
    s_barrier
    s_cmp_ge_u32 s32, 7
    s_cbranch_scc1 K2_HS
    v_mul_u32_u24 v8, 912, v10
    v_lshl_add_u32 v8, v11, 4, v8
    v_add_u32 v9, s45, v6
    ds_read_b128 v[216:219], v8 offset:36864
    ds_read_b128 v[88:91], v9 offset:0
    ds_read_b128 v[92:95], v9 offset:1024
    ds_read_b128 v[96:99], v9 offset:2048
    ds_read_b128 v[100:103], v9 offset:3072
    ds_read_b128 v[220:223], v8 offset:36928
    s_waitcnt lgkmcnt(1)
    v_mfma_f32_16x16x32_bf16 v[64:67], v[104:107], v[216:219], 0
    v_mfma_f32_16x16x32_bf16 v[68:71], v[108:111], v[216:219], 0
    v_mfma_f32_16x16x32_bf16 v[72:75], v[112:115], v[216:219], 0
    v_mfma_f32_16x16x32_bf16 v[76:79], v[116:119], v[216:219], 0
    ds_read_b128 v[216:219], v8 offset:36992
    ds_read_b128 v[104:107], v9 offset:28672
    ds_read_b128 v[108:111], v9 offset:29696
    ds_read_b128 v[112:115], v9 offset:30720
    ds_read_b128 v[116:119], v9 offset:31744
    s_waitcnt lgkmcnt(5)
    v_mfma_f32_16x16x32_bf16 v[64:67], v[120:123], v[220:223], v[64:67]
    v_mfma_f32_16x16x32_bf16 v[68:71], v[124:127], v[220:223], v[68:71]
    v_mfma_f32_16x16x32_bf16 v[72:75], v[128:131], v[220:223], v[72:75]
    v_mfma_f32_16x16x32_bf16 v[76:79], v[132:135], v[220:223], v[76:79]
    ds_read_b128 v[220:223], v8 offset:37056
    ds_read_b128 v[120:123], v9 offset:57344
    ds_read_b128 v[124:127], v9 offset:58368
    ds_read_b128 v[128:131], v9 offset:59392
    ds_read_b128 v[132:135], v9 offset:60416
    s_waitcnt lgkmcnt(5)
    v_mfma_f32_16x16x32_bf16 v[64:67], v[136:139], v[216:219], v[64:67]
    v_mfma_f32_16x16x32_bf16 v[68:71], v[140:143], v[216:219], v[68:71]
    v_mfma_f32_16x16x32_bf16 v[72:75], v[144:147], v[216:219], v[72:75]
    v_mfma_f32_16x16x32_bf16 v[76:79], v[148:151], v[216:219], v[76:79]
    ds_read_b128 v[216:219], v8 offset:37120
    s_waitcnt lgkmcnt(1)
    v_mfma_f32_16x16x32_bf16 v[64:67], v[152:155], v[220:223], v[64:67]
    v_mfma_f32_16x16x32_bf16 v[68:71], v[156:159], v[220:223], v[68:71]
    v_mfma_f32_16x16x32_bf16 v[72:75], v[160:163], v[220:223], v[72:75]
    v_mfma_f32_16x16x32_bf16 v[76:79], v[164:167], v[220:223], v[76:79]
    ds_read_b128 v[220:223], v8 offset:37184
    s_waitcnt lgkmcnt(1)
    v_mfma_f32_16x16x32_bf16 v[64:67], v[168:171], v[216:219], v[64:67]
    v_mfma_f32_16x16x32_bf16 v[68:71], v[172:175], v[216:219], v[68:71]
    v_mfma_f32_16x16x32_bf16 v[72:75], v[176:179], v[216:219], v[72:75]
    v_mfma_f32_16x16x32_bf16 v[76:79], v[180:183], v[216:219], v[76:79]
    ds_read_b128 v[216:219], v8 offset:37248
    s_waitcnt lgkmcnt(1)
    v_mfma_f32_16x16x32_bf16 v[64:67], v[184:187], v[220:223], v[64:67]
    v_mfma_f32_16x16x32_bf16 v[68:71], v[188:191], v[220:223], v[68:71]
    v_mfma_f32_16x16x32_bf16 v[72:75], v[192:195], v[220:223], v[72:75]
    v_mfma_f32_16x16x32_bf16 v[76:79], v[196:199], v[220:223], v[76:79]
    ds_read_b128 v[220:223], v8 offset:37312
    s_waitcnt lgkmcnt(1)
    v_mfma_f32_16x16x32_bf16 v[64:67], v[200:203], v[216:219], v[64:67]
    v_mfma_f32_16x16x32_bf16 v[68:71], v[204:207], v[216:219], v[68:71]
    v_mfma_f32_16x16x32_bf16 v[72:75], v[208:211], v[216:219], v[72:75]
    v_mfma_f32_16x16x32_bf16 v[76:79], v[212:215], v[216:219], v[76:79]
    ds_read_b128 v[216:219], v8 offset:37568
    s_waitcnt lgkmcnt(1)
    v_mfma_f32_16x16x32_bf16 v[64:67], v[240:243], v[220:223], v[64:67]
    v_mfma_f32_16x16x32_bf16 v[68:71], v[244:247], v[220:223], v[68:71]
    v_mfma_f32_16x16x32_bf16 v[72:75], v[248:251], v[220:223], v[72:75]
    v_mfma_f32_16x16x32_bf16 v[76:79], v[252:255], v[220:223], v[76:79]
    ds_read_b128 v[220:223], v8 offset:37632
    s_waitcnt lgkmcnt(1)
    v_mfma_f32_16x16x32_bf16 v[64:67], v[24:27], v[216:219], v[64:67]
    v_mfma_f32_16x16x32_bf16 v[68:71], v[28:31], v[216:219], v[68:71]
    v_mfma_f32_16x16x32_bf16 v[72:75], v[32:35], v[216:219], v[72:75]
    v_mfma_f32_16x16x32_bf16 v[76:79], v[36:39], v[216:219], v[76:79]
    ds_read_b128 v[216:219], v8 offset:37696
    s_waitcnt lgkmcnt(1)
    v_mfma_f32_16x16x32_bf16 v[64:67], v[40:43], v[220:223], v[64:67]
    v_mfma_f32_16x16x32_bf16 v[68:71], v[44:47], v[220:223], v[68:71]
    v_mfma_f32_16x16x32_bf16 v[72:75], v[48:51], v[220:223], v[72:75]
    v_mfma_f32_16x16x32_bf16 v[76:79], v[52:55], v[220:223], v[76:79]
    ds_read_b128 v[220:223], v8 offset:37376
    s_waitcnt lgkmcnt(1)
    v_mfma_f32_16x16x32_bf16 v[64:67], v[56:59], v[216:219], v[64:67]
    v_mfma_f32_16x16x32_bf16 v[68:71], v[60:63], v[216:219], v[68:71]
    v_mfma_f32_16x16x32_bf16 v[72:75], v[80:83], v[216:219], v[72:75]
    v_mfma_f32_16x16x32_bf16 v[76:79], v[84:87], v[216:219], v[76:79]
    ds_read_b128 v[216:219], v8 offset:37440
    s_waitcnt lgkmcnt(1)
    v_mfma_f32_16x16x32_bf16 v[64:67], v[88:91], v[220:223], v[64:67]
    v_mfma_f32_16x16x32_bf16 v[68:71], v[92:95], v[220:223], v[68:71]
    v_mfma_f32_16x16x32_bf16 v[72:75], v[96:99], v[220:223], v[72:75]
    v_mfma_f32_16x16x32_bf16 v[76:79], v[100:103], v[220:223], v[76:79]
    ds_read_b128 v[220:223], v8 offset:37504
    s_waitcnt lgkmcnt(1)
    v_mfma_f32_16x16x32_bf16 v[64:67], v[104:107], v[216:219], v[64:67]
    v_mfma_f32_16x16x32_bf16 v[68:71], v[108:111], v[216:219], v[68:71]
    v_mfma_f32_16x16x32_bf16 v[72:75], v[112:115], v[216:219], v[72:75]
    v_mfma_f32_16x16x32_bf16 v[76:79], v[116:119], v[216:219], v[76:79]
    s_waitcnt lgkmcnt(0)
    v_mfma_f32_16x16x32_bf16 v[64:67], v[120:123], v[220:223], v[64:67]
    v_mfma_f32_16x16x32_bf16 v[68:71], v[124:127], v[220:223], v[68:71]
    v_mfma_f32_16x16x32_bf16 v[72:75], v[128:131], v[220:223], v[72:75]
    v_mfma_f32_16x16x32_bf16 v[76:79], v[132:135], v[220:223], v[76:79]
    s_nop 15
    v_cvt_pk_bf16_f32 v24, v64, v65
    v_cvt_pk_bf16_f32 v25, v66, v67
    v_lshlrev_b32 v26, 16, v24
    v_and_b32 v27, 0xffff0000, v24
    v_lshlrev_b32 v28, 16, v25
    v_and_b32 v29, 0xffff0000, v25
    v_lshlrev_b32 v30, 16, v232
    v_and_b32 v31, 0xffff0000, v232
    v_lshlrev_b32 v32, 16, v233
    v_and_b32 v33, 0xffff0000, v233
    v_add_f32 v26, v26, v30
    v_add_f32 v27, v27, v31
    v_add_f32 v28, v28, v32
    v_add_f32 v29, v29, v33
    v_cvt_pk_bf16_f32 v24, v26, v27
    v_cvt_pk_bf16_f32 v25, v28, v29
    v_lshlrev_b32 v64, 16, v24
    v_and_b32 v65, 0xffff0000, v24
    v_lshlrev_b32 v66, 16, v25
    v_and_b32 v67, 0xffff0000, v25
    v_cvt_pk_bf16_f32 v24, v68, v69
    v_cvt_pk_bf16_f32 v25, v70, v71
    v_lshlrev_b32 v26, 16, v24
    v_and_b32 v27, 0xffff0000, v24
    v_lshlrev_b32 v28, 16, v25
    v_and_b32 v29, 0xffff0000, v25
    v_lshlrev_b32 v30, 16, v234
    v_and_b32 v31, 0xffff0000, v234
    v_lshlrev_b32 v32, 16, v235
    v_and_b32 v33, 0xffff0000, v235
    v_add_f32 v26, v26, v30
    v_add_f32 v27, v27, v31
    v_add_f32 v28, v28, v32
    v_add_f32 v29, v29, v33
    v_cvt_pk_bf16_f32 v24, v26, v27
    v_cvt_pk_bf16_f32 v25, v28, v29
    v_lshlrev_b32 v68, 16, v24
    v_and_b32 v69, 0xffff0000, v24
    v_lshlrev_b32 v70, 16, v25
    v_and_b32 v71, 0xffff0000, v25
    v_cvt_pk_bf16_f32 v24, v72, v73
    v_cvt_pk_bf16_f32 v25, v74, v75
    v_lshlrev_b32 v26, 16, v24
    v_and_b32 v27, 0xffff0000, v24
    v_lshlrev_b32 v28, 16, v25
    v_and_b32 v29, 0xffff0000, v25
    v_lshlrev_b32 v30, 16, v236
    v_and_b32 v31, 0xffff0000, v236
    v_lshlrev_b32 v32, 16, v237
    v_and_b32 v33, 0xffff0000, v237
    v_add_f32 v26, v26, v30
    v_add_f32 v27, v27, v31
    v_add_f32 v28, v28, v32
    v_add_f32 v29, v29, v33
    v_cvt_pk_bf16_f32 v24, v26, v27
    v_cvt_pk_bf16_f32 v25, v28, v29
    v_lshlrev_b32 v72, 16, v24
    v_and_b32 v73, 0xffff0000, v24
    v_lshlrev_b32 v74, 16, v25
    v_and_b32 v75, 0xffff0000, v25
    v_cvt_pk_bf16_f32 v24, v76, v77
    v_cvt_pk_bf16_f32 v25, v78, v79
    v_lshlrev_b32 v26, 16, v24
    v_and_b32 v27, 0xffff0000, v24
    v_lshlrev_b32 v28, 16, v25
    v_and_b32 v29, 0xffff0000, v25
    v_lshlrev_b32 v30, 16, v238
    v_and_b32 v31, 0xffff0000, v238
    v_lshlrev_b32 v32, 16, v239
    v_and_b32 v33, 0xffff0000, v239
    v_add_f32 v26, v26, v30
    v_add_f32 v27, v27, v31
    v_add_f32 v28, v28, v32
    v_add_f32 v29, v29, v33
    v_cvt_pk_bf16_f32 v24, v26, v27
    v_cvt_pk_bf16_f32 v25, v28, v29
    v_lshlrev_b32 v76, 16, v24
    v_and_b32 v77, 0xffff0000, v24
    v_lshlrev_b32 v78, 16, v25
    v_and_b32 v79, 0xffff0000, v25
    v_mul_u32_u24 v24, 1808, v10
    v_lshl_add_u32 v24, v11, 4, v24
    s_lshl_b32 s40, s32, 8
    v_add_u32 v24, s40, v24
    v_cmp_gt_u32 vcc, 8, v10
    s_and_saveexec_b64 s[46:47], vcc
    ds_write_b128 v24, v[64:67] offset:0
    ds_write_b128 v24, v[68:71] offset:64
    ds_write_b128 v24, v[72:75] offset:128
    ds_write_b128 v24, v[76:79] offset:192
    s_mov_b64 exec, s[46:47]
K2_HS:
    s_waitcnt lgkmcnt(0)
    s_barrier
    v_lshlrev_b32 v24, 5, v2
    s_mul_i32 s40, s32, 1808
    v_add_u32 v24, s40, v24
    v_mov_b32 v32, 0
    v_mov_b32 v33, 0
    v_mov_b32 v34, 0
    v_mov_b32 v35, 0
    v_mov_b32 v36, 0
    v_mov_b32 v37, 0
    v_mov_b32 v38, 0
    v_mov_b32 v39, 0
    v_cmp_gt_u32 vcc, 56, v2
    s_and_saveexec_b64 s[46:47], vcc
    ds_read_b128 v[32:35], v24 offset:0
    ds_read_b128 v[36:39], v24 offset:16
    s_waitcnt lgkmcnt(0)
    s_mov_b64 exec, s[46:47]
    v_add_f32 v40, v32, v33
    v_add_f32 v40, v40, v34
    v_add_f32 v40, v40, v35
    v_add_f32 v40, v40, v36
    v_add_f32 v40, v40, v37
    v_add_f32 v40, v40, v38
    v_add_f32 v40, v40, v39
    s_nop 1
    v_add_f32 v40, v40, v40 row_shr:1 row_mask:0xf bank_mask:0xf bound_ctrl:0
    s_nop 1
    v_add_f32 v40, v40, v40 row_shr:2 row_mask:0xf bank_mask:0xf bound_ctrl:0
    s_nop 1
    v_add_f32 v40, v40, v40 row_shr:4 row_mask:0xf bank_mask:0xf bound_ctrl:0
    s_nop 1
    v_add_f32 v40, v40, v40 row_shr:8 row_mask:0xf bank_mask:0xf bound_ctrl:0
    s_nop 1
    v_add_f32 v40, v40, v40 row_bcast:15 row_mask:0xa bank_mask:0xf
    s_nop 1
    v_add_f32 v40, v40, v40 row_bcast:31 row_mask:0xc bank_mask:0xf
    s_nop 1
    v_readlane_b32 s48, v40, 63
    s_nop 3
    v_mov_b32 v41, s48
    v_mul_f32 v42, 0x3b124925, v41
    v_mov_b32 v40, 0
    s_and_saveexec_b64 s[46:47], vcc
    v_sub_f32 v44, v32, v42
    v_sub_f32 v45, v33, v42
    v_sub_f32 v46, v34, v42
    v_sub_f32 v47, v35, v42
    v_sub_f32 v48, v36, v42
    v_sub_f32 v49, v37, v42
    v_sub_f32 v50, v38, v42
    v_sub_f32 v51, v39, v42
    v_mul_f32 v40, v44, v44
    v_fmac_f32 v40, v45, v45
    v_fmac_f32 v40, v46, v46
    v_fmac_f32 v40, v47, v47
    v_fmac_f32 v40, v48, v48
    v_fmac_f32 v40, v49, v49
    v_fmac_f32 v40, v50, v50
    v_fmac_f32 v40, v51, v51
    v_cvt_pk_bf16_f32 v52, v32, v33
    v_cvt_pk_bf16_f32 v53, v34, v35
    v_cvt_pk_bf16_f32 v54, v36, v37
    v_cvt_pk_bf16_f32 v55, v38, v39
    v_lshlrev_b32 v25, 4, v2
    s_lshl_b32 s40, s2, 3
    s_add_u32 s40, s40, s32
    s_mul_i32 s40, s40, 896
    s_add_u32 s40, s40, 3145728
    buffer_store_dwordx4 v[52:55], v25, s[28:31], s40 offen
    s_mov_b64 exec, s[46:47]
    s_nop 1
    v_add_f32 v40, v40, v40 row_shr:1 row_mask:0xf bank_mask:0xf bound_ctrl:0
    s_nop 1
    v_add_f32 v40, v40, v40 row_shr:2 row_mask:0xf bank_mask:0xf bound_ctrl:0
    s_nop 1
    v_add_f32 v40, v40, v40 row_shr:4 row_mask:0xf bank_mask:0xf bound_ctrl:0
    s_nop 1
    v_add_f32 v40, v40, v40 row_shr:8 row_mask:0xf bank_mask:0xf bound_ctrl:0
    s_nop 1
    v_add_f32 v40, v40, v40 row_bcast:15 row_mask:0xa bank_mask:0xf
    s_nop 1
    v_add_f32 v40, v40, v40 row_bcast:31 row_mask:0xc bank_mask:0xf
    s_nop 1
    v_readlane_b32 s48, v40, 63
    s_nop 3
    v_mov_b32 v41, s48
    v_mov_b32 v43, 0x3727c5ac
    v_fmac_f32 v43, 0x3b124925, v41
    v_rsq_f32 v43, v43
    s_lshl_b32 s40, s32, 3
    s_add_u32 s40, s40, 16384
    v_mov_b32 v25, s40
    v_cmp_eq_u32 vcc, 0, v2
    s_and_saveexec_b64 s[46:47], vcc
    ds_write_b64 v25, v[42:43]
    s_mov_b64 exec, s[46:47]
    s_waitcnt lgkmcnt(0)
    s_barrier
    v_cmp_gt_u32 vcc, 448, v0
    s_and_saveexec_b64 s[46:47], vcc
    s_cbranch_execz K2_DONE
    v_lshlrev_b32 v24, 2, v0
    ds_read_b32 v32, v24 offset:0
    ds_read_b32 v33, v24 offset:1808
    ds_read_b32 v34, v24 offset:3616
    ds_read_b32 v35, v24 offset:5424
    ds_read_b32 v36, v24 offset:7232
    ds_read_b32 v37, v24 offset:9040
    ds_read_b32 v38, v24 offset:10848
    ds_read_b32 v39, v24 offset:12656
    v_mov_b32 v25, 16384
    ds_read_b128 v[48:51], v25 offset:0
    ds_read_b128 v[52:55], v25 offset:16
    ds_read_b128 v[56:59], v25 offset:32
    ds_read_b128 v[60:63], v25 offset:48
    v_lshrrev_b32 v26, 6, v0
    v_and_b32 v27, 63, v0
    v_lshlrev_b32 v26, 18, v26
    v_lshl_add_u32 v26, v27, 7, v26
    v_bfe_u32 v27, v27, 1, 3
    s_and_b32 s40, s2, 7
    v_xor_b32 v27, s40, v27
    v_lshl_add_u32 v26, v27, 4, v26
    s_lshr_b32 s40, s2, 3
    s_lshl_b32 s40, s40, 13
    s_add_u32 s40, s40, 5242880
    s_waitcnt lgkmcnt(0)
    v_sub_f32 v32, v32, v48
    v_mul_f32 v32, v32, v49
    v_sub_f32 v33, v33, v50
    v_mul_f32 v33, v33, v51
    v_sub_f32 v34, v34, v52
    v_mul_f32 v34, v34, v53
    v_sub_f32 v35, v35, v54
    v_mul_f32 v35, v35, v55
    v_sub_f32 v36, v36, v56
    v_mul_f32 v36, v36, v57
    v_sub_f32 v37, v37, v58
    v_mul_f32 v37, v37, v59
    v_sub_f32 v38, v38, v60
    v_mul_f32 v38, v38, v61
    v_sub_f32 v39, v39, v62
    v_mul_f32 v39, v39, v63
    v_cvt_pk_bf16_f32 v40, v32, v33
    v_cvt_pk_bf16_f32 v41, v34, v35
    v_cvt_pk_bf16_f32 v42, v36, v37
    v_cvt_pk_bf16_f32 v43, v38, v39
    buffer_store_dwordx4 v[40:43], v26, s[28:31], s40 offen
K2_DONE:
    s_endpgm
K2F_RARE0:
    v_xor_b32 v218, 32, v2
    v_lshlrev_b32 v218, 2, v218
    ds_bpermute_b32 v219, v218, v217
    s_waitcnt lgkmcnt(0)
    v_max_f32 v217, v217, v219
    v_cmp_lt_f32 vcc, s46, v217
    s_nop 1
    v_cndmask_b32 v217, 0, v217, vcc
    v_add_f32 v217, v216, v217
    v_sub_f32 v218, 0, v217
    v_cvt_pk_bf16_f32 v219, v218, v218
    v_lshlrev_b32 v220, 16, v219
    v_sub_f32 v221, v218, v220
    v_cvt_pk_bf16_f32 v221, v221, v221
    v_lshlrev_b32 v222, 16, v221
    v_add_f32 v220, v220, v222
    v_and_b32 v219, 0xffff, v219
    v_lshl_or_b32 v219, v221, 16, v219
    v_cndmask_b32 v22, v22, v219, s[42:43]
    v_add_f32 v221, v216, v220
    v_sub_f32 v216, 0, v220
    v_add_f32 v24, v24, v221
    v_add_f32 v25, v25, v221
    v_add_f32 v26, v26, v221
    v_add_f32 v27, v27, v221
    v_add_f32 v28, v28, v221
    v_add_f32 v29, v29, v221
    v_add_f32 v30, v30, v221
    v_add_f32 v31, v31, v221
    v_add_f32 v32, v32, v221
    v_add_f32 v33, v33, v221
    v_add_f32 v34, v34, v221
    v_add_f32 v35, v35, v221
    v_add_f32 v36, v36, v221
    v_add_f32 v37, v37, v221
    v_add_f32 v38, v38, v221
    v_add_f32 v39, v39, v221
    s_mov_b32 s46, 0x41000000
    s_nop 1
    s_branch K2F_BACK0
K2S_RARE0:
    v_xor_b32 v218, 32, v2
    v_lshlrev_b32 v218, 2, v218
    ds_bpermute_b32 v219, v218, v217
    s_waitcnt lgkmcnt(0)
    v_max_f32 v217, v217, v219
    v_cmp_lt_f32 vcc, s46, v217
    s_nop 1
    v_cndmask_b32 v217, 0, v217, vcc
    v_add_f32 v217, v216, v217
    v_sub_f32 v218, 0, v217
    v_cvt_pk_bf16_f32 v219, v218, v218
    v_lshlrev_b32 v220, 16, v219
    v_sub_f32 v221, v218, v220
    v_cvt_pk_bf16_f32 v221, v221, v221
    v_lshlrev_b32 v222, 16, v221
    v_add_f32 v220, v220, v222
    v_and_b32 v219, 0xffff, v219
    v_lshl_or_b32 v219, v221, 16, v219
    v_cndmask_b32 v22, v22, v219, s[42:43]
    v_add_f32 v221, v216, v220
    v_sub_f32 v216, 0, v220
    v_add_f32 v24, v24, v221
    v_add_f32 v25, v25, v221
    v_add_f32 v26, v26, v221
    v_add_f32 v27, v27, v221
    v_add_f32 v28, v28, v221
    v_add_f32 v29, v29, v221
    v_add_f32 v30, v30, v221
    v_add_f32 v31, v31, v221
    v_add_f32 v32, v32, v221
    v_add_f32 v33, v33, v221
    v_add_f32 v34, v34, v221
    v_add_f32 v35, v35, v221
    v_add_f32 v36, v36, v221
    v_add_f32 v37, v37, v221
    v_add_f32 v38, v38, v221
    v_add_f32 v39, v39, v221
    s_nop 7
    v_add_f32 v40, v40, v221
    v_add_f32 v41, v41, v221
    v_add_f32 v42, v42, v221
    v_add_f32 v43, v43, v221
    v_add_f32 v44, v44, v221
    v_add_f32 v45, v45, v221
    v_add_f32 v46, v46, v221
    v_add_f32 v47, v47, v221
    v_add_f32 v48, v48, v221
    v_add_f32 v49, v49, v221
    v_add_f32 v50, v50, v221
    v_add_f32 v51, v51, v221
    v_add_f32 v52, v52, v221
    v_add_f32 v53, v53, v221
    v_add_f32 v54, v54, v221
    v_add_f32 v55, v55, v221
    s_mov_b32 s46, 0x41000000
    s_nop 1
    s_branch K2S_BACK0
K2S_RARE1:
    v_xor_b32 v218, 32, v2
    v_lshlrev_b32 v218, 2, v218
    ds_bpermute_b32 v219, v218, v217
    s_waitcnt lgkmcnt(0)
    v_max_f32 v217, v217, v219
    v_cmp_lt_f32 vcc, s46, v217
    s_nop 1
    v_cndmask_b32 v217, 0, v217, vcc
    v_add_f32 v217, v216, v217
    v_sub_f32 v218, 0, v217
    v_cvt_pk_bf16_f32 v219, v218, v218
    v_lshlrev_b32 v220, 16, v219
    v_sub_f32 v221, v218, v220
    v_cvt_pk_bf16_f32 v221, v221, v221
    v_lshlrev_b32 v222, 16, v221
    v_add_f32 v220, v220, v222
    v_and_b32 v219, 0xffff, v219
    v_lshl_or_b32 v219, v221, 16, v219
    v_cndmask_b32 v22, v22, v219, s[42:43]
    v_add_f32 v221, v216, v220
    v_sub_f32 v216, 0, v220
    v_add_f32 v40, v40, v221
    v_add_f32 v41, v41, v221
    v_add_f32 v42, v42, v221
    v_add_f32 v43, v43, v221
    v_add_f32 v44, v44, v221
    v_add_f32 v45, v45, v221
    v_add_f32 v46, v46, v221
    v_add_f32 v47, v47, v221
    v_add_f32 v48, v48, v221
    v_add_f32 v49, v49, v221
    v_add_f32 v50, v50, v221
    v_add_f32 v51, v51, v221
    v_add_f32 v52, v52, v221
    v_add_f32 v53, v53, v221
    v_add_f32 v54, v54, v221
    v_add_f32 v55, v55, v221
    s_nop 7
    v_add_f32 v24, v24, v221
    v_add_f32 v25, v25, v221
    v_add_f32 v26, v26, v221
    v_add_f32 v27, v27, v221
    v_add_f32 v28, v28, v221
    v_add_f32 v29, v29, v221
    v_add_f32 v30, v30, v221
    v_add_f32 v31, v31, v221
    v_add_f32 v32, v32, v221
    v_add_f32 v33, v33, v221
    v_add_f32 v34, v34, v221
    v_add_f32 v35, v35, v221
    v_add_f32 v36, v36, v221
    v_add_f32 v37, v37, v221
    v_add_f32 v38, v38, v221
    v_add_f32 v39, v39, v221
    v_exp_f32 v221, v221
    s_nop 7
    s_nop 7
    v_mul_f32 v64, v64, v221
    v_mul_f32 v65, v65, v221
    v_mul_f32 v66, v66, v221
    v_mul_f32 v67, v67, v221
    v_mul_f32 v68, v68, v221
    v_mul_f32 v69, v69, v221
    v_mul_f32 v70, v70, v221
    v_mul_f32 v71, v71, v221
    v_mul_f32 v72, v72, v221
    v_mul_f32 v73, v73, v221
    v_mul_f32 v74, v74, v221
    v_mul_f32 v75, v75, v221
    v_mul_f32 v76, v76, v221
    v_mul_f32 v77, v77, v221
    v_mul_f32 v78, v78, v221
    v_mul_f32 v79, v79, v221
    s_mov_b32 s46, 0x41000000
    s_nop 1
    s_branch K2S_BACK1
K2S_RARE2:
    v_xor_b32 v218, 32, v2
    v_lshlrev_b32 v218, 2, v218
    ds_bpermute_b32 v219, v218, v217
    s_waitcnt lgkmcnt(0)
    v_max_f32 v217, v217, v219
    v_cmp_lt_f32 vcc, s46, v217
    s_nop 1
    v_cndmask_b32 v217, 0, v217, vcc
    v_add_f32 v217, v216, v217
    v_sub_f32 v218, 0, v217
    v_cvt_pk_bf16_f32 v219, v218, v218
    v_lshlrev_b32 v220, 16, v219
    v_sub_f32 v221, v218, v220
    v_cvt_pk_bf16_f32 v221, v221, v221
    v_lshlrev_b32 v222, 16, v221
    v_add_f32 v220, v220, v222
    v_and_b32 v219, 0xffff, v219
    v_lshl_or_b32 v219, v221, 16, v219
    v_cndmask_b32 v22, v22, v219, s[42:43]
    v_add_f32 v221, v216, v220
    v_sub_f32 v216, 0, v220
    v_add_f32 v24, v24, v221
    v_add_f32 v25, v25, v221
    v_add_f32 v26, v26, v221
    v_add_f32 v27, v27, v221
    v_add_f32 v28, v28, v221
    v_add_f32 v29, v29, v221
    v_add_f32 v30, v30, v221
    v_add_f32 v31, v31, v221
    v_add_f32 v32, v32, v221
    v_add_f32 v33, v33, v221
    v_add_f32 v34, v34, v221
    v_add_f32 v35, v35, v221
    v_add_f32 v36, v36, v221
    v_add_f32 v37, v37, v221
    v_add_f32 v38, v38, v221
    v_add_f32 v39, v39, v221
    s_nop 7
    v_add_f32 v40, v40, v221
    v_add_f32 v41, v41, v221
    v_add_f32 v42, v42, v221
    v_add_f32 v43, v43, v221
    v_add_f32 v44, v44, v221
    v_add_f32 v45, v45, v221
    v_add_f32 v46, v46, v221
    v_add_f32 v47, v47, v221
    v_add_f32 v48, v48, v221
    v_add_f32 v49, v49, v221
    v_add_f32 v50, v50, v221
    v_add_f32 v51, v51, v221
    v_add_f32 v52, v52, v221
    v_add_f32 v53, v53, v221
    v_add_f32 v54, v54, v221
    v_add_f32 v55, v55, v221
    v_exp_f32 v221, v221
    s_nop 7
    s_nop 7
    v_mul_f32 v64, v64, v221
    v_mul_f32 v65, v65, v221
    v_mul_f32 v66, v66, v221
    v_mul_f32 v67, v67, v221
    v_mul_f32 v68, v68, v221
    v_mul_f32 v69, v69, v221
    v_mul_f32 v70, v70, v221
    v_mul_f32 v71, v71, v221
    v_mul_f32 v72, v72, v221
    v_mul_f32 v73, v73, v221
    v_mul_f32 v74, v74, v221
    v_mul_f32 v75, v75, v221
    v_mul_f32 v76, v76, v221
    v_mul_f32 v77, v77, v221
    v_mul_f32 v78, v78, v221
    v_mul_f32 v79, v79, v221
    s_mov_b32 s46, 0x41000000
    s_nop 1
    s_branch K2S_BACK2
K2S_RARE3:
    v_xor_b32 v218, 32, v2
    v_lshlrev_b32 v218, 2, v218
    ds_bpermute_b32 v219, v218, v217
    s_waitcnt lgkmcnt(0)
    v_max_f32 v217, v217, v219
    v_cmp_lt_f32 vcc, s46, v217
    s_nop 1
    v_cndmask_b32 v217, 0, v217, vcc
    v_add_f32 v217, v216, v217
    v_sub_f32 v218, 0, v217
    v_cvt_pk_bf16_f32 v219, v218, v218
    v_lshlrev_b32 v220, 16, v219
    v_sub_f32 v221, v218, v220
    v_cvt_pk_bf16_f32 v221, v221, v221
    v_lshlrev_b32 v222, 16, v221
    v_add_f32 v220, v220, v222
    v_and_b32 v219, 0xffff, v219
    v_lshl_or_b32 v219, v221, 16, v219
    v_cndmask_b32 v22, v22, v219, s[42:43]
    v_add_f32 v221, v216, v220
    v_sub_f32 v216, 0, v220
    v_add_f32 v40, v40, v221
    v_add_f32 v41, v41, v221
    v_add_f32 v42, v42, v221
    v_add_f32 v43, v43, v221
    v_add_f32 v44, v44, v221
    v_add_f32 v45, v45, v221
    v_add_f32 v46, v46, v221
    v_add_f32 v47, v47, v221
    v_add_f32 v48, v48, v221
    v_add_f32 v49, v49, v221
    v_add_f32 v50, v50, v221
    v_add_f32 v51, v51, v221
    v_add_f32 v52, v52, v221
    v_add_f32 v53, v53, v221
    v_add_f32 v54, v54, v221
    v_add_f32 v55, v55, v221
    s_nop 7
    v_add_f32 v24, v24, v221
    v_add_f32 v25, v25, v221
    v_add_f32 v26, v26, v221
    v_add_f32 v27, v27, v221
    v_add_f32 v28, v28, v221
    v_add_f32 v29, v29, v221
    v_add_f32 v30, v30, v221
    v_add_f32 v31, v31, v221
    v_add_f32 v32, v32, v221
    v_add_f32 v33, v33, v221
    v_add_f32 v34, v34, v221
    v_add_f32 v35, v35, v221
    v_add_f32 v36, v36, v221
    v_add_f32 v37, v37, v221
    v_add_f32 v38, v38, v221
    v_add_f32 v39, v39, v221
    v_exp_f32 v221, v221
    s_nop 7
    s_nop 7
    v_mul_f32 v64, v64, v221
    v_mul_f32 v65, v65, v221
    v_mul_f32 v66, v66, v221
    v_mul_f32 v67, v67, v221
    v_mul_f32 v68, v68, v221
    v_mul_f32 v69, v69, v221
    v_mul_f32 v70, v70, v221
    v_mul_f32 v71, v71, v221
    v_mul_f32 v72, v72, v221
    v_mul_f32 v73, v73, v221
    v_mul_f32 v74, v74, v221
    v_mul_f32 v75, v75, v221
    v_mul_f32 v76, v76, v221
    v_mul_f32 v77, v77, v221
    v_mul_f32 v78, v78, v221
    v_mul_f32 v79, v79, v221
    s_mov_b32 s46, 0x41000000
    s_nop 1
    s_branch K2S_BACK3
K2S_RARE4:
    v_xor_b32 v218, 32, v2
    v_lshlrev_b32 v218, 2, v218
    ds_bpermute_b32 v219, v218, v217
    s_waitcnt lgkmcnt(0)
    v_max_f32 v217, v217, v219
    v_cmp_lt_f32 vcc, s46, v217
    s_nop 1
    v_cndmask_b32 v217, 0, v217, vcc
    v_add_f32 v217, v216, v217
    v_sub_f32 v218, 0, v217
    v_cvt_pk_bf16_f32 v219, v218, v218
    v_lshlrev_b32 v220, 16, v219
    v_sub_f32 v221, v218, v220
    v_cvt_pk_bf16_f32 v221, v221, v221
    v_lshlrev_b32 v222, 16, v221
    v_add_f32 v220, v220, v222
    v_and_b32 v219, 0xffff, v219
    v_lshl_or_b32 v219, v221, 16, v219
    v_cndmask_b32 v22, v22, v219, s[42:43]
    v_add_f32 v221, v216, v220
    v_sub_f32 v216, 0, v220
    v_add_f32 v24, v24, v221
    v_add_f32 v25, v25, v221
    v_add_f32 v26, v26, v221
    v_add_f32 v27, v27, v221
    v_add_f32 v28, v28, v221
    v_add_f32 v29, v29, v221
    v_add_f32 v30, v30, v221
    v_add_f32 v31, v31, v221
    v_add_f32 v32, v32, v221
    v_add_f32 v33, v33, v221
    v_add_f32 v34, v34, v221
    v_add_f32 v35, v35, v221
    v_add_f32 v36, v36, v221
    v_add_f32 v37, v37, v221
    v_add_f32 v38, v38, v221
    v_add_f32 v39, v39, v221
    s_nop 7
    v_add_f32 v40, v40, v221
    v_add_f32 v41, v41, v221
    v_add_f32 v42, v42, v221
    v_add_f32 v43, v43, v221
    v_add_f32 v44, v44, v221
    v_add_f32 v45, v45, v221
    v_add_f32 v46, v46, v221
    v_add_f32 v47, v47, v221
    v_add_f32 v48, v48, v221
    v_add_f32 v49, v49, v221
    v_add_f32 v50, v50, v221
    v_add_f32 v51, v51, v221
    v_add_f32 v52, v52, v221
    v_add_f32 v53, v53, v221
    v_add_f32 v54, v54, v221
    v_add_f32 v55, v55, v221
    v_exp_f32 v221, v221
    s_nop 7
    s_nop 7
    v_mul_f32 v64, v64, v221
    v_mul_f32 v65, v65, v221
    v_mul_f32 v66, v66, v221
    v_mul_f32 v67, v67, v221
    v_mul_f32 v68, v68, v221
    v_mul_f32 v69, v69, v221
    v_mul_f32 v70, v70, v221
    v_mul_f32 v71, v71, v221
    v_mul_f32 v72, v72, v221
    v_mul_f32 v73, v73, v221
    v_mul_f32 v74, v74, v221
    v_mul_f32 v75, v75, v221
    v_mul_f32 v76, v76, v221
    v_mul_f32 v77, v77, v221
    v_mul_f32 v78, v78, v221
    v_mul_f32 v79, v79, v221
    s_mov_b32 s46, 0x41000000
    s_nop 1
    s_branch K2S_BACK4
K2S_RARE5:
    v_xor_b32 v218, 32, v2
    v_lshlrev_b32 v218, 2, v218
    ds_bpermute_b32 v219, v218, v217
    s_waitcnt lgkmcnt(0)
    v_max_f32 v217, v217, v219
    v_cmp_lt_f32 vcc, s46, v217
    s_nop 1
    v_cndmask_b32 v217, 0, v217, vcc
    v_add_f32 v217, v216, v217
    v_sub_f32 v218, 0, v217
    v_cvt_pk_bf16_f32 v219, v218, v218
    v_lshlrev_b32 v220, 16, v219
    v_sub_f32 v221, v218, v220
    v_cvt_pk_bf16_f32 v221, v221, v221
    v_lshlrev_b32 v222, 16, v221
    v_add_f32 v220, v220, v222
    v_and_b32 v219, 0xffff, v219
    v_lshl_or_b32 v219, v221, 16, v219
    v_cndmask_b32 v22, v22, v219, s[42:43]
    v_add_f32 v221, v216, v220
    v_sub_f32 v216, 0, v220
    v_add_f32 v40, v40, v221
    v_add_f32 v41, v41, v221
    v_add_f32 v42, v42, v221
    v_add_f32 v43, v43, v221
    v_add_f32 v44, v44, v221
    v_add_f32 v45, v45, v221
    v_add_f32 v46, v46, v221
    v_add_f32 v47, v47, v221
    v_add_f32 v48, v48, v221
    v_add_f32 v49, v49, v221
    v_add_f32 v50, v50, v221
    v_add_f32 v51, v51, v221
    v_add_f32 v52, v52, v221
    v_add_f32 v53, v53, v221
    v_add_f32 v54, v54, v221
    v_add_f32 v55, v55, v221
    s_nop 7
    v_add_f32 v24, v24, v221
    v_add_f32 v25, v25, v221
    v_add_f32 v26, v26, v221
    v_add_f32 v27, v27, v221
    v_add_f32 v28, v28, v221
    v_add_f32 v29, v29, v221
    v_add_f32 v30, v30, v221
    v_add_f32 v31, v31, v221
    v_add_f32 v32, v32, v221
    v_add_f32 v33, v33, v221
    v_add_f32 v34, v34, v221
    v_add_f32 v35, v35, v221
    v_add_f32 v36, v36, v221
    v_add_f32 v37, v37, v221
    v_add_f32 v38, v38, v221
    v_add_f32 v39, v39, v221
    v_exp_f32 v221, v221
    s_nop 7
    s_nop 7
    v_mul_f32 v64, v64, v221
    v_mul_f32 v65, v65, v221
    v_mul_f32 v66, v66, v221
    v_mul_f32 v67, v67, v221
    v_mul_f32 v68, v68, v221
    v_mul_f32 v69, v69, v221
    v_mul_f32 v70, v70, v221
    v_mul_f32 v71, v71, v221
    v_mul_f32 v72, v72, v221
    v_mul_f32 v73, v73, v221
    v_mul_f32 v74, v74, v221
    v_mul_f32 v75, v75, v221
    v_mul_f32 v76, v76, v221
    v_mul_f32 v77, v77, v221
    v_mul_f32 v78, v78, v221
    v_mul_f32 v79, v79, v221
    s_mov_b32 s46, 0x41000000
    s_nop 1
    s_branch K2S_BACK5
K2S_RARE6:
    v_xor_b32 v218, 32, v2
    v_lshlrev_b32 v218, 2, v218
    ds_bpermute_b32 v219, v218, v217
    s_waitcnt lgkmcnt(0)
    v_max_f32 v217, v217, v219
    v_cmp_lt_f32 vcc, s46, v217
    s_nop 1
    v_cndmask_b32 v217, 0, v217, vcc
    v_add_f32 v217, v216, v217
    v_sub_f32 v218, 0, v217
    v_cvt_pk_bf16_f32 v219, v218, v218
    v_lshlrev_b32 v220, 16, v219
    v_sub_f32 v221, v218, v220
    v_cvt_pk_bf16_f32 v221, v221, v221
    v_lshlrev_b32 v222, 16, v221
    v_add_f32 v220, v220, v222
    v_and_b32 v219, 0xffff, v219
    v_lshl_or_b32 v219, v221, 16, v219
    v_cndmask_b32 v22, v22, v219, s[42:43]
    v_add_f32 v221, v216, v220
    v_sub_f32 v216, 0, v220
    v_add_f32 v24, v24, v221
    v_add_f32 v25, v25, v221
    v_add_f32 v26, v26, v221
    v_add_f32 v27, v27, v221
    v_add_f32 v28, v28, v221
    v_add_f32 v29, v29, v221
    v_add_f32 v30, v30, v221
    v_add_f32 v31, v31, v221
    v_add_f32 v32, v32, v221
    v_add_f32 v33, v33, v221
    v_add_f32 v34, v34, v221
    v_add_f32 v35, v35, v221
    v_add_f32 v36, v36, v221
    v_add_f32 v37, v37, v221
    v_add_f32 v38, v38, v221
    v_add_f32 v39, v39, v221
    s_nop 7
    v_add_f32 v40, v40, v221
    v_add_f32 v41, v41, v221
    v_add_f32 v42, v42, v221
    v_add_f32 v43, v43, v221
    v_add_f32 v44, v44, v221
    v_add_f32 v45, v45, v221
    v_add_f32 v46, v46, v221
    v_add_f32 v47, v47, v221
    v_add_f32 v48, v48, v221
    v_add_f32 v49, v49, v221
    v_add_f32 v50, v50, v221
    v_add_f32 v51, v51, v221
    v_add_f32 v52, v52, v221
    v_add_f32 v53, v53, v221
    v_add_f32 v54, v54, v221
    v_add_f32 v55, v55, v221
    v_exp_f32 v221, v221
    s_nop 7
    s_nop 7
    v_mul_f32 v64, v64, v221
    v_mul_f32 v65, v65, v221
    v_mul_f32 v66, v66, v221
    v_mul_f32 v67, v67, v221
    v_mul_f32 v68, v68, v221
    v_mul_f32 v69, v69, v221
    v_mul_f32 v70, v70, v221
    v_mul_f32 v71, v71, v221
    v_mul_f32 v72, v72, v221
    v_mul_f32 v73, v73, v221
    v_mul_f32 v74, v74, v221
    v_mul_f32 v75, v75, v221
    v_mul_f32 v76, v76, v221
    v_mul_f32 v77, v77, v221
    v_mul_f32 v78, v78, v221
    v_mul_f32 v79, v79, v221
    s_mov_b32 s46, 0x41000000
    s_nop 1
    s_branch K2S_BACK6
K2S_RARE7:
    v_xor_b32 v218, 32, v2
    v_lshlrev_b32 v218, 2, v218
    ds_bpermute_b32 v219, v218, v217
    s_waitcnt lgkmcnt(0)
    v_max_f32 v217, v217, v219
    v_cmp_lt_f32 vcc, s46, v217
    s_nop 1
    v_cndmask_b32 v217, 0, v217, vcc
    v_add_f32 v217, v216, v217
    v_sub_f32 v218, 0, v217
    v_cvt_pk_bf16_f32 v219, v218, v218
    v_lshlrev_b32 v220, 16, v219
    v_sub_f32 v221, v218, v220
    v_cvt_pk_bf16_f32 v221, v221, v221
    v_lshlrev_b32 v222, 16, v221
    v_add_f32 v220, v220, v222
    v_and_b32 v219, 0xffff, v219
    v_lshl_or_b32 v219, v221, 16, v219
    v_cndmask_b32 v22, v22, v219, s[42:43]
    v_add_f32 v221, v216, v220
    v_sub_f32 v216, 0, v220
    v_add_f32 v40, v40, v221
    v_add_f32 v41, v41, v221
    v_add_f32 v42, v42, v221
    v_add_f32 v43, v43, v221
    v_add_f32 v44, v44, v221
    v_add_f32 v45, v45, v221
    v_add_f32 v46, v46, v221
    v_add_f32 v47, v47, v221
    v_add_f32 v48, v48, v221
    v_add_f32 v49, v49, v221
    v_add_f32 v50, v50, v221
    v_add_f32 v51, v51, v221
    v_add_f32 v52, v52, v221
    v_add_f32 v53, v53, v221
    v_add_f32 v54, v54, v221
    v_add_f32 v55, v55, v221
    s_nop 7
    v_add_f32 v24, v24, v221
    v_add_f32 v25, v25, v221
    v_add_f32 v26, v26, v221
    v_add_f32 v27, v27, v221
    v_add_f32 v28, v28, v221
    v_add_f32 v29, v29, v221
    v_add_f32 v30, v30, v221
    v_add_f32 v31, v31, v221
    v_add_f32 v32, v32, v221
    v_add_f32 v33, v33, v221
    v_add_f32 v34, v34, v221
    v_add_f32 v35, v35, v221
    v_add_f32 v36, v36, v221
    v_add_f32 v37, v37, v221
    v_add_f32 v38, v38, v221
    v_add_f32 v39, v39, v221
    v_exp_f32 v221, v221
    s_nop 7
    s_nop 7
    v_mul_f32 v64, v64, v221
    v_mul_f32 v65, v65, v221
    v_mul_f32 v66, v66, v221
    v_mul_f32 v67, v67, v221
    v_mul_f32 v68, v68, v221
    v_mul_f32 v69, v69, v221
    v_mul_f32 v70, v70, v221
    v_mul_f32 v71, v71, v221
    v_mul_f32 v72, v72, v221
    v_mul_f32 v73, v73, v221
    v_mul_f32 v74, v74, v221
    v_mul_f32 v75, v75, v221
    v_mul_f32 v76, v76, v221
    v_mul_f32 v77, v77, v221
    v_mul_f32 v78, v78, v221
    v_mul_f32 v79, v79, v221
    s_mov_b32 s46, 0x41000000
    s_nop 1
    s_branch K2S_BACK7
K2S_RARE8:
    v_xor_b32 v218, 32, v2
    v_lshlrev_b32 v218, 2, v218
    ds_bpermute_b32 v219, v218, v217
    s_waitcnt lgkmcnt(0)
    v_max_f32 v217, v217, v219
    v_cmp_lt_f32 vcc, s46, v217
    s_nop 1
    v_cndmask_b32 v217, 0, v217, vcc
    v_add_f32 v217, v216, v217
    v_sub_f32 v218, 0, v217
    v_cvt_pk_bf16_f32 v219, v218, v218
    v_lshlrev_b32 v220, 16, v219
    v_sub_f32 v221, v218, v220
    v_cvt_pk_bf16_f32 v221, v221, v221
    v_lshlrev_b32 v222, 16, v221
    v_add_f32 v220, v220, v222
    v_and_b32 v219, 0xffff, v219
    v_lshl_or_b32 v219, v221, 16, v219
    v_cndmask_b32 v22, v22, v219, s[42:43]
    v_add_f32 v221, v216, v220
    v_sub_f32 v216, 0, v220
    v_add_f32 v24, v24, v221
    v_add_f32 v25, v25, v221
    v_add_f32 v26, v26, v221
    v_add_f32 v27, v27, v221
    v_add_f32 v28, v28, v221
    v_add_f32 v29, v29, v221
    v_add_f32 v30, v30, v221
    v_add_f32 v31, v31, v221
    v_add_f32 v32, v32, v221
    v_add_f32 v33, v33, v221
    v_add_f32 v34, v34, v221
    v_add_f32 v35, v35, v221
    v_add_f32 v36, v36, v221
    v_add_f32 v37, v37, v221
    v_add_f32 v38, v38, v221
    v_add_f32 v39, v39, v221
    s_nop 7
    v_add_f32 v40, v40, v221
    v_add_f32 v41, v41, v221
    v_add_f32 v42, v42, v221
    v_add_f32 v43, v43, v221
    v_add_f32 v44, v44, v221
    v_add_f32 v45, v45, v221
    v_add_f32 v46, v46, v221
    v_add_f32 v47, v47, v221
    v_add_f32 v48, v48, v221
    v_add_f32 v49, v49, v221
    v_add_f32 v50, v50, v221
    v_add_f32 v51, v51, v221
    v_add_f32 v52, v52, v221
    v_add_f32 v53, v53, v221
    v_add_f32 v54, v54, v221
    v_add_f32 v55, v55, v221
    v_exp_f32 v221, v221
    s_nop 7
    s_nop 7
    v_mul_f32 v64, v64, v221
    v_mul_f32 v65, v65, v221
    v_mul_f32 v66, v66, v221
    v_mul_f32 v67, v67, v221
    v_mul_f32 v68, v68, v221
    v_mul_f32 v69, v69, v221
    v_mul_f32 v70, v70, v221
    v_mul_f32 v71, v71, v221
    v_mul_f32 v72, v72, v221
    v_mul_f32 v73, v73, v221
    v_mul_f32 v74, v74, v221
    v_mul_f32 v75, v75, v221
    v_mul_f32 v76, v76, v221
    v_mul_f32 v77, v77, v221
    v_mul_f32 v78, v78, v221
    v_mul_f32 v79, v79, v221
    s_mov_b32 s46, 0x41000000
    s_nop 1
    s_branch K2S_BACK8
K2S_RARE9:
    v_xor_b32 v218, 32, v2
    v_lshlrev_b32 v218, 2, v218
    ds_bpermute_b32 v219, v218, v217
    s_waitcnt lgkmcnt(0)
    v_max_f32 v217, v217, v219
    v_cmp_lt_f32 vcc, s46, v217
    s_nop 1
    v_cndmask_b32 v217, 0, v217, vcc
    v_add_f32 v217, v216, v217
    v_sub_f32 v218, 0, v217
    v_cvt_pk_bf16_f32 v219, v218, v218
    v_lshlrev_b32 v220, 16, v219
    v_sub_f32 v221, v218, v220
    v_cvt_pk_bf16_f32 v221, v221, v221
    v_lshlrev_b32 v222, 16, v221
    v_add_f32 v220, v220, v222
    v_and_b32 v219, 0xffff, v219
    v_lshl_or_b32 v219, v221, 16, v219
    v_cndmask_b32 v22, v22, v219, s[42:43]
    v_add_f32 v221, v216, v220
    v_sub_f32 v216, 0, v220
    v_add_f32 v40, v40, v221
    v_add_f32 v41, v41, v221
    v_add_f32 v42, v42, v221
    v_add_f32 v43, v43, v221
    v_add_f32 v44, v44, v221
    v_add_f32 v45, v45, v221
    v_add_f32 v46, v46, v221
    v_add_f32 v47, v47, v221
    v_add_f32 v48, v48, v221
    v_add_f32 v49, v49, v221
    v_add_f32 v50, v50, v221
    v_add_f32 v51, v51, v221
    v_add_f32 v52, v52, v221
    v_add_f32 v53, v53, v221
    v_add_f32 v54, v54, v221
    v_add_f32 v55, v55, v221
    s_nop 7
    v_add_f32 v24, v24, v221
    v_add_f32 v25, v25, v221
    v_add_f32 v26, v26, v221
    v_add_f32 v27, v27, v221
    v_add_f32 v28, v28, v221
    v_add_f32 v29, v29, v221
    v_add_f32 v30, v30, v221
    v_add_f32 v31, v31, v221
    v_add_f32 v32, v32, v221
    v_add_f32 v33, v33, v221
    v_add_f32 v34, v34, v221
    v_add_f32 v35, v35, v221
    v_add_f32 v36, v36, v221
    v_add_f32 v37, v37, v221
    v_add_f32 v38, v38, v221
    v_add_f32 v39, v39, v221
    v_exp_f32 v221, v221
    s_nop 7
    s_nop 7
    v_mul_f32 v64, v64, v221
    v_mul_f32 v65, v65, v221
    v_mul_f32 v66, v66, v221
    v_mul_f32 v67, v67, v221
    v_mul_f32 v68, v68, v221
    v_mul_f32 v69, v69, v221
    v_mul_f32 v70, v70, v221
    v_mul_f32 v71, v71, v221
    v_mul_f32 v72, v72, v221
    v_mul_f32 v73, v73, v221
    v_mul_f32 v74, v74, v221
    v_mul_f32 v75, v75, v221
    v_mul_f32 v76, v76, v221
    v_mul_f32 v77, v77, v221
    v_mul_f32 v78, v78, v221
    v_mul_f32 v79, v79, v221
    s_mov_b32 s46, 0x41000000
    s_nop 1
    s_branch K2S_BACK9
K2S_RARE10:
    v_xor_b32 v218, 32, v2
    v_lshlrev_b32 v218, 2, v218
    ds_bpermute_b32 v219, v218, v217
    s_waitcnt lgkmcnt(0)
    v_max_f32 v217, v217, v219
    v_cmp_lt_f32 vcc, s46, v217
    s_nop 1
    v_cndmask_b32 v217, 0, v217, vcc
    v_add_f32 v217, v216, v217
    v_sub_f32 v218, 0, v217
    v_cvt_pk_bf16_f32 v219, v218, v218
    v_lshlrev_b32 v220, 16, v219
    v_sub_f32 v221, v218, v220
    v_cvt_pk_bf16_f32 v221, v221, v221
    v_lshlrev_b32 v222, 16, v221
    v_add_f32 v220, v220, v222
    v_and_b32 v219, 0xffff, v219
    v_lshl_or_b32 v219, v221, 16, v219
    v_cndmask_b32 v22, v22, v219, s[42:43]
    v_add_f32 v221, v216, v220
    v_sub_f32 v216, 0, v220
    v_add_f32 v24, v24, v221
    v_add_f32 v25, v25, v221
    v_add_f32 v26, v26, v221
    v_add_f32 v27, v27, v221
    v_add_f32 v28, v28, v221
    v_add_f32 v29, v29, v221
    v_add_f32 v30, v30, v221
    v_add_f32 v31, v31, v221
    v_add_f32 v32, v32, v221
    v_add_f32 v33, v33, v221
    v_add_f32 v34, v34, v221
    v_add_f32 v35, v35, v221
    v_add_f32 v36, v36, v221
    v_add_f32 v37, v37, v221
    v_add_f32 v38, v38, v221
    v_add_f32 v39, v39, v221
    s_nop 7
    v_add_f32 v40, v40, v221
    v_add_f32 v41, v41, v221
    v_add_f32 v42, v42, v221
    v_add_f32 v43, v43, v221
    v_add_f32 v44, v44, v221
    v_add_f32 v45, v45, v221
    v_add_f32 v46, v46, v221
    v_add_f32 v47, v47, v221
    v_add_f32 v48, v48, v221
    v_add_f32 v49, v49, v221
    v_add_f32 v50, v50, v221
    v_add_f32 v51, v51, v221
    v_add_f32 v52, v52, v221
    v_add_f32 v53, v53, v221
    v_add_f32 v54, v54, v221
    v_add_f32 v55, v55, v221
    v_exp_f32 v221, v221
    s_nop 7
    s_nop 7
    v_mul_f32 v64, v64, v221
    v_mul_f32 v65, v65, v221
    v_mul_f32 v66, v66, v221
    v_mul_f32 v67, v67, v221
    v_mul_f32 v68, v68, v221
    v_mul_f32 v69, v69, v221
    v_mul_f32 v70, v70, v221
    v_mul_f32 v71, v71, v221
    v_mul_f32 v72, v72, v221
    v_mul_f32 v73, v73, v221
    v_mul_f32 v74, v74, v221
    v_mul_f32 v75, v75, v221
    v_mul_f32 v76, v76, v221
    v_mul_f32 v77, v77, v221
    v_mul_f32 v78, v78, v221
    v_mul_f32 v79, v79, v221
    s_mov_b32 s46, 0x41000000
    s_nop 1
    s_branch K2S_BACK10
K2S_RARE11:
    v_xor_b32 v218, 32, v2
    v_lshlrev_b32 v218, 2, v218
    ds_bpermute_b32 v219, v218, v217
    s_waitcnt lgkmcnt(0)
    v_max_f32 v217, v217, v219
    v_cmp_lt_f32 vcc, s46, v217
    s_nop 1
    v_cndmask_b32 v217, 0, v217, vcc
    v_add_f32 v217, v216, v217
    v_sub_f32 v218, 0, v217
    v_cvt_pk_bf16_f32 v219, v218, v218
    v_lshlrev_b32 v220, 16, v219
    v_sub_f32 v221, v218, v220
    v_cvt_pk_bf16_f32 v221, v221, v221
    v_lshlrev_b32 v222, 16, v221
    v_add_f32 v220, v220, v222
    v_and_b32 v219, 0xffff, v219
    v_lshl_or_b32 v219, v221, 16, v219
    v_cndmask_b32 v22, v22, v219, s[42:43]
    v_add_f32 v221, v216, v220
    v_sub_f32 v216, 0, v220
    v_add_f32 v40, v40, v221
    v_add_f32 v41, v41, v221
    v_add_f32 v42, v42, v221
    v_add_f32 v43, v43, v221
    v_add_f32 v44, v44, v221
    v_add_f32 v45, v45, v221
    v_add_f32 v46, v46, v221
    v_add_f32 v47, v47, v221
    v_add_f32 v48, v48, v221
    v_add_f32 v49, v49, v221
    v_add_f32 v50, v50, v221
    v_add_f32 v51, v51, v221
    v_add_f32 v52, v52, v221
    v_add_f32 v53, v53, v221
    v_add_f32 v54, v54, v221
    v_add_f32 v55, v55, v221
    s_nop 7
    v_add_f32 v24, v24, v221
    v_add_f32 v25, v25, v221
    v_add_f32 v26, v26, v221
    v_add_f32 v27, v27, v221
    v_add_f32 v28, v28, v221
    v_add_f32 v29, v29, v221
    v_add_f32 v30, v30, v221
    v_add_f32 v31, v31, v221
    v_add_f32 v32, v32, v221
    v_add_f32 v33, v33, v221
    v_add_f32 v34, v34, v221
    v_add_f32 v35, v35, v221
    v_add_f32 v36, v36, v221
    v_add_f32 v37, v37, v221
    v_add_f32 v38, v38, v221
    v_add_f32 v39, v39, v221
    v_exp_f32 v221, v221
    s_nop 7
    s_nop 7
    v_mul_f32 v64, v64, v221
    v_mul_f32 v65, v65, v221
    v_mul_f32 v66, v66, v221
    v_mul_f32 v67, v67, v221
    v_mul_f32 v68, v68, v221
    v_mul_f32 v69, v69, v221
    v_mul_f32 v70, v70, v221
    v_mul_f32 v71, v71, v221
    v_mul_f32 v72, v72, v221
    v_mul_f32 v73, v73, v221
    v_mul_f32 v74, v74, v221
    v_mul_f32 v75, v75, v221
    v_mul_f32 v76, v76, v221
    v_mul_f32 v77, v77, v221
    v_mul_f32 v78, v78, v221
    v_mul_f32 v79, v79, v221
    s_mov_b32 s46, 0x41000000
    s_nop 1
    s_branch K2S_BACK11
K2S_RARE12:
    v_xor_b32 v218, 32, v2
    v_lshlrev_b32 v218, 2, v218
    ds_bpermute_b32 v219, v218, v217
    s_waitcnt lgkmcnt(0)
    v_max_f32 v217, v217, v219
    v_cmp_lt_f32 vcc, s46, v217
    s_nop 1
    v_cndmask_b32 v217, 0, v217, vcc
    v_add_f32 v217, v216, v217
    v_sub_f32 v218, 0, v217
    v_cvt_pk_bf16_f32 v219, v218, v218
    v_lshlrev_b32 v220, 16, v219
    v_sub_f32 v221, v218, v220
    v_cvt_pk_bf16_f32 v221, v221, v221
    v_lshlrev_b32 v222, 16, v221
    v_add_f32 v220, v220, v222
    v_and_b32 v219, 0xffff, v219
    v_lshl_or_b32 v219, v221, 16, v219
    v_cndmask_b32 v22, v22, v219, s[42:43]
    v_add_f32 v221, v216, v220
    v_sub_f32 v216, 0, v220
    v_add_f32 v24, v24, v221
    v_add_f32 v25, v25, v221
    v_add_f32 v26, v26, v221
    v_add_f32 v27, v27, v221
    v_add_f32 v28, v28, v221
    v_add_f32 v29, v29, v221
    v_add_f32 v30, v30, v221
    v_add_f32 v31, v31, v221
    v_add_f32 v32, v32, v221
    v_add_f32 v33, v33, v221
    v_add_f32 v34, v34, v221
    v_add_f32 v35, v35, v221
    v_add_f32 v36, v36, v221
    v_add_f32 v37, v37, v221
    v_add_f32 v38, v38, v221
    v_add_f32 v39, v39, v221
    s_nop 7
    v_add_f32 v40, v40, v221
    v_add_f32 v41, v41, v221
    v_add_f32 v42, v42, v221
    v_add_f32 v43, v43, v221
    v_add_f32 v44, v44, v221
    v_add_f32 v45, v45, v221
    v_add_f32 v46, v46, v221
    v_add_f32 v47, v47, v221
    v_add_f32 v48, v48, v221
    v_add_f32 v49, v49, v221
    v_add_f32 v50, v50, v221
    v_add_f32 v51, v51, v221
    v_add_f32 v52, v52, v221
    v_add_f32 v53, v53, v221
    v_add_f32 v54, v54, v221
    v_add_f32 v55, v55, v221
    v_exp_f32 v221, v221
    s_nop 7
    s_nop 7
    v_mul_f32 v64, v64, v221
    v_mul_f32 v65, v65, v221
    v_mul_f32 v66, v66, v221
    v_mul_f32 v67, v67, v221
    v_mul_f32 v68, v68, v221
    v_mul_f32 v69, v69, v221
    v_mul_f32 v70, v70, v221
    v_mul_f32 v71, v71, v221
    v_mul_f32 v72, v72, v221
    v_mul_f32 v73, v73, v221
    v_mul_f32 v74, v74, v221
    v_mul_f32 v75, v75, v221
    v_mul_f32 v76, v76, v221
    v_mul_f32 v77, v77, v221
    v_mul_f32 v78, v78, v221
    v_mul_f32 v79, v79, v221
    s_mov_b32 s46, 0x41000000
    s_nop 1
    s_branch K2S_BACK12
K2S_RARE13:
    v_xor_b32 v218, 32, v2
    v_lshlrev_b32 v218, 2, v218
    ds_bpermute_b32 v219, v218, v217
    s_waitcnt lgkmcnt(0)
    v_max_f32 v217, v217, v219
    v_cmp_lt_f32 vcc, s46, v217
    s_nop 1
    v_cndmask_b32 v217, 0, v217, vcc
    v_add_f32 v217, v216, v217
    v_sub_f32 v218, 0, v217
    v_cvt_pk_bf16_f32 v219, v218, v218
    v_lshlrev_b32 v220, 16, v219
    v_sub_f32 v221, v218, v220
    v_cvt_pk_bf16_f32 v221, v221, v221
    v_lshlrev_b32 v222, 16, v221
    v_add_f32 v220, v220, v222
    v_and_b32 v219, 0xffff, v219
    v_lshl_or_b32 v219, v221, 16, v219
    v_cndmask_b32 v22, v22, v219, s[42:43]
    v_add_f32 v221, v216, v220
    v_sub_f32 v216, 0, v220
    v_add_f32 v40, v40, v221
    v_add_f32 v41, v41, v221
    v_add_f32 v42, v42, v221
    v_add_f32 v43, v43, v221
    v_add_f32 v44, v44, v221
    v_add_f32 v45, v45, v221
    v_add_f32 v46, v46, v221
    v_add_f32 v47, v47, v221
    v_add_f32 v48, v48, v221
    v_add_f32 v49, v49, v221
    v_add_f32 v50, v50, v221
    v_add_f32 v51, v51, v221
    v_add_f32 v52, v52, v221
    v_add_f32 v53, v53, v221
    v_add_f32 v54, v54, v221
    v_add_f32 v55, v55, v221
    s_nop 7
    v_add_f32 v24, v24, v221
    v_add_f32 v25, v25, v221
    v_add_f32 v26, v26, v221
    v_add_f32 v27, v27, v221
    v_add_f32 v28, v28, v221
    v_add_f32 v29, v29, v221
    v_add_f32 v30, v30, v221
    v_add_f32 v31, v31, v221
    v_add_f32 v32, v32, v221
    v_add_f32 v33, v33, v221
    v_add_f32 v34, v34, v221
    v_add_f32 v35, v35, v221
    v_add_f32 v36, v36, v221
    v_add_f32 v37, v37, v221
    v_add_f32 v38, v38, v221
    v_add_f32 v39, v39, v221
    v_exp_f32 v221, v221
    s_nop 7
    s_nop 7
    v_mul_f32 v64, v64, v221
    v_mul_f32 v65, v65, v221
    v_mul_f32 v66, v66, v221
    v_mul_f32 v67, v67, v221
    v_mul_f32 v68, v68, v221
    v_mul_f32 v69, v69, v221
    v_mul_f32 v70, v70, v221
    v_mul_f32 v71, v71, v221
    v_mul_f32 v72, v72, v221
    v_mul_f32 v73, v73, v221
    v_mul_f32 v74, v74, v221
    v_mul_f32 v75, v75, v221
    v_mul_f32 v76, v76, v221
    v_mul_f32 v77, v77, v221
    v_mul_f32 v78, v78, v221
    v_mul_f32 v79, v79, v221
    s_mov_b32 s46, 0x41000000
    s_nop 1
    s_branch K2S_BACK13
K2S_RARE14:
    v_xor_b32 v218, 32, v2
    v_lshlrev_b32 v218, 2, v218
    ds_bpermute_b32 v219, v218, v217
    s_waitcnt lgkmcnt(0)
    v_max_f32 v217, v217, v219
    v_cmp_lt_f32 vcc, s46, v217
    s_nop 1
    v_cndmask_b32 v217, 0, v217, vcc
    v_add_f32 v217, v216, v217
    v_sub_f32 v218, 0, v217
    v_cvt_pk_bf16_f32 v219, v218, v218
    v_lshlrev_b32 v220, 16, v219
    v_sub_f32 v221, v218, v220
    v_cvt_pk_bf16_f32 v221, v221, v221
    v_lshlrev_b32 v222, 16, v221
    v_add_f32 v220, v220, v222
    v_and_b32 v219, 0xffff, v219
    v_lshl_or_b32 v219, v221, 16, v219
    v_cndmask_b32 v22, v22, v219, s[42:43]
    v_add_f32 v221, v216, v220
    v_sub_f32 v216, 0, v220
    v_add_f32 v24, v24, v221
    v_add_f32 v25, v25, v221
    v_add_f32 v26, v26, v221
    v_add_f32 v27, v27, v221
    v_add_f32 v28, v28, v221
    v_add_f32 v29, v29, v221
    v_add_f32 v30, v30, v221
    v_add_f32 v31, v31, v221
    v_add_f32 v32, v32, v221
    v_add_f32 v33, v33, v221
    v_add_f32 v34, v34, v221
    v_add_f32 v35, v35, v221
    v_add_f32 v36, v36, v221
    v_add_f32 v37, v37, v221
    v_add_f32 v38, v38, v221
    v_add_f32 v39, v39, v221
    s_nop 7
    v_add_f32 v40, v40, v221
    v_add_f32 v41, v41, v221
    v_add_f32 v42, v42, v221
    v_add_f32 v43, v43, v221
    v_add_f32 v44, v44, v221
    v_add_f32 v45, v45, v221
    v_add_f32 v46, v46, v221
    v_add_f32 v47, v47, v221
    v_add_f32 v48, v48, v221
    v_add_f32 v49, v49, v221
    v_add_f32 v50, v50, v221
    v_add_f32 v51, v51, v221
    v_add_f32 v52, v52, v221
    v_add_f32 v53, v53, v221
    v_add_f32 v54, v54, v221
    v_add_f32 v55, v55, v221
    v_exp_f32 v221, v221
    s_nop 7
    s_nop 7
    v_mul_f32 v64, v64, v221
    v_mul_f32 v65, v65, v221
    v_mul_f32 v66, v66, v221
    v_mul_f32 v67, v67, v221
    v_mul_f32 v68, v68, v221
    v_mul_f32 v69, v69, v221
    v_mul_f32 v70, v70, v221
    v_mul_f32 v71, v71, v221
    v_mul_f32 v72, v72, v221
    v_mul_f32 v73, v73, v221
    v_mul_f32 v74, v74, v221
    v_mul_f32 v75, v75, v221
    v_mul_f32 v76, v76, v221
    v_mul_f32 v77, v77, v221
    v_mul_f32 v78, v78, v221
    v_mul_f32 v79, v79, v221
    s_mov_b32 s46, 0x41000000
    s_nop 1
    s_branch K2S_BACK14
K2S_RARE15:
    v_xor_b32 v218, 32, v2
    v_lshlrev_b32 v218, 2, v218
    ds_bpermute_b32 v219, v218, v217
    s_waitcnt lgkmcnt(0)
    v_max_f32 v217, v217, v219
    v_cmp_lt_f32 vcc, s46, v217
    s_nop 1
    v_cndmask_b32 v217, 0, v217, vcc
    v_add_f32 v217, v216, v217
    v_sub_f32 v218, 0, v217
    v_cvt_pk_bf16_f32 v219, v218, v218
    v_lshlrev_b32 v220, 16, v219
    v_sub_f32 v221, v218, v220
    v_cvt_pk_bf16_f32 v221, v221, v221
    v_lshlrev_b32 v222, 16, v221
    v_add_f32 v220, v220, v222
    v_and_b32 v219, 0xffff, v219
    v_lshl_or_b32 v219, v221, 16, v219
    v_cndmask_b32 v22, v22, v219, s[42:43]
    v_add_f32 v221, v216, v220
    v_sub_f32 v216, 0, v220
    v_add_f32 v40, v40, v221
    v_add_f32 v41, v41, v221
    v_add_f32 v42, v42, v221
    v_add_f32 v43, v43, v221
    v_add_f32 v44, v44, v221
    v_add_f32 v45, v45, v221
    v_add_f32 v46, v46, v221
    v_add_f32 v47, v47, v221
    v_add_f32 v48, v48, v221
    v_add_f32 v49, v49, v221
    v_add_f32 v50, v50, v221
    v_add_f32 v51, v51, v221
    v_add_f32 v52, v52, v221
    v_add_f32 v53, v53, v221
    v_add_f32 v54, v54, v221
    v_add_f32 v55, v55, v221
    s_nop 7
    v_add_f32 v24, v24, v221
    v_add_f32 v25, v25, v221
    v_add_f32 v26, v26, v221
    v_add_f32 v27, v27, v221
    v_add_f32 v28, v28, v221
    v_add_f32 v29, v29, v221
    v_add_f32 v30, v30, v221
    v_add_f32 v31, v31, v221
    v_add_f32 v32, v32, v221
    v_add_f32 v33, v33, v221
    v_add_f32 v34, v34, v221
    v_add_f32 v35, v35, v221
    v_add_f32 v36, v36, v221
    v_add_f32 v37, v37, v221
    v_add_f32 v38, v38, v221
    v_add_f32 v39, v39, v221
    v_exp_f32 v221, v221
    s_nop 7
    s_nop 7
    v_mul_f32 v64, v64, v221
    v_mul_f32 v65, v65, v221
    v_mul_f32 v66, v66, v221
    v_mul_f32 v67, v67, v221
    v_mul_f32 v68, v68, v221
    v_mul_f32 v69, v69, v221
    v_mul_f32 v70, v70, v221
    v_mul_f32 v71, v71, v221
    v_mul_f32 v72, v72, v221
    v_mul_f32 v73, v73, v221
    v_mul_f32 v74, v74, v221
    v_mul_f32 v75, v75, v221
    v_mul_f32 v76, v76, v221
    v_mul_f32 v77, v77, v221
    v_mul_f32 v78, v78, v221
    v_mul_f32 v79, v79, v221
    s_mov_b32 s46, 0x41000000
    s_nop 1
    s_branch K2S_BACK15
K2S_RARE16:
    v_xor_b32 v218, 32, v2
    v_lshlrev_b32 v218, 2, v218
    ds_bpermute_b32 v219, v218, v217
    s_waitcnt lgkmcnt(0)
    v_max_f32 v217, v217, v219
    v_cmp_lt_f32 vcc, s46, v217
    s_nop 1
    v_cndmask_b32 v217, 0, v217, vcc
    v_add_f32 v217, v216, v217
    v_sub_f32 v218, 0, v217
    v_cvt_pk_bf16_f32 v219, v218, v218
    v_lshlrev_b32 v220, 16, v219
    v_sub_f32 v221, v218, v220
    v_cvt_pk_bf16_f32 v221, v221, v221
    v_lshlrev_b32 v222, 16, v221
    v_add_f32 v220, v220, v222
    v_and_b32 v219, 0xffff, v219
    v_lshl_or_b32 v219, v221, 16, v219
    v_cndmask_b32 v22, v22, v219, s[42:43]
    v_add_f32 v221, v216, v220
    v_sub_f32 v216, 0, v220
    v_add_f32 v24, v24, v221
    v_add_f32 v25, v25, v221
    v_add_f32 v26, v26, v221
    v_add_f32 v27, v27, v221
    v_add_f32 v28, v28, v221
    v_add_f32 v29, v29, v221
    v_add_f32 v30, v30, v221
    v_add_f32 v31, v31, v221
    v_add_f32 v32, v32, v221
    v_add_f32 v33, v33, v221
    v_add_f32 v34, v34, v221
    v_add_f32 v35, v35, v221
    v_add_f32 v36, v36, v221
    v_add_f32 v37, v37, v221
    v_add_f32 v38, v38, v221
    v_add_f32 v39, v39, v221
    s_nop 7
    v_add_f32 v40, v40, v221
    v_add_f32 v41, v41, v221
    v_add_f32 v42, v42, v221
    v_add_f32 v43, v43, v221
    v_add_f32 v44, v44, v221
    v_add_f32 v45, v45, v221
    v_add_f32 v46, v46, v221
    v_add_f32 v47, v47, v221
    v_add_f32 v48, v48, v221
    v_add_f32 v49, v49, v221
    v_add_f32 v50, v50, v221
    v_add_f32 v51, v51, v221
    v_add_f32 v52, v52, v221
    v_add_f32 v53, v53, v221
    v_add_f32 v54, v54, v221
    v_add_f32 v55, v55, v221
    v_exp_f32 v221, v221
    s_nop 7
    s_nop 7
    v_mul_f32 v64, v64, v221
    v_mul_f32 v65, v65, v221
    v_mul_f32 v66, v66, v221
    v_mul_f32 v67, v67, v221
    v_mul_f32 v68, v68, v221
    v_mul_f32 v69, v69, v221
    v_mul_f32 v70, v70, v221
    v_mul_f32 v71, v71, v221
    v_mul_f32 v72, v72, v221
    v_mul_f32 v73, v73, v221
    v_mul_f32 v74, v74, v221
    v_mul_f32 v75, v75, v221
    v_mul_f32 v76, v76, v221
    v_mul_f32 v77, v77, v221
    v_mul_f32 v78, v78, v221
    v_mul_f32 v79, v79, v221
    s_mov_b32 s46, 0x41000000
    s_nop 1
    s_branch K2S_BACK16
K2S_RARE17:
    v_xor_b32 v218, 32, v2
    v_lshlrev_b32 v218, 2, v218
    ds_bpermute_b32 v219, v218, v217
    s_waitcnt lgkmcnt(0)
    v_max_f32 v217, v217, v219
    v_cmp_lt_f32 vcc, s46, v217
    s_nop 1
    v_cndmask_b32 v217, 0, v217, vcc
    v_add_f32 v217, v216, v217
    v_sub_f32 v218, 0, v217
    v_cvt_pk_bf16_f32 v219, v218, v218
    v_lshlrev_b32 v220, 16, v219
    v_sub_f32 v221, v218, v220
    v_cvt_pk_bf16_f32 v221, v221, v221
    v_lshlrev_b32 v222, 16, v221
    v_add_f32 v220, v220, v222
    v_and_b32 v219, 0xffff, v219
    v_lshl_or_b32 v219, v221, 16, v219
    v_cndmask_b32 v22, v22, v219, s[42:43]
    v_add_f32 v221, v216, v220
    v_sub_f32 v216, 0, v220
    v_add_f32 v40, v40, v221
    v_add_f32 v41, v41, v221
    v_add_f32 v42, v42, v221
    v_add_f32 v43, v43, v221
    v_add_f32 v44, v44, v221
    v_add_f32 v45, v45, v221
    v_add_f32 v46, v46, v221
    v_add_f32 v47, v47, v221
    v_add_f32 v48, v48, v221
    v_add_f32 v49, v49, v221
    v_add_f32 v50, v50, v221
    v_add_f32 v51, v51, v221
    v_add_f32 v52, v52, v221
    v_add_f32 v53, v53, v221
    v_add_f32 v54, v54, v221
    v_add_f32 v55, v55, v221
    s_nop 7
    v_add_f32 v24, v24, v221
    v_add_f32 v25, v25, v221
    v_add_f32 v26, v26, v221
    v_add_f32 v27, v27, v221
    v_add_f32 v28, v28, v221
    v_add_f32 v29, v29, v221
    v_add_f32 v30, v30, v221
    v_add_f32 v31, v31, v221
    v_add_f32 v32, v32, v221
    v_add_f32 v33, v33, v221
    v_add_f32 v34, v34, v221
    v_add_f32 v35, v35, v221
    v_add_f32 v36, v36, v221
    v_add_f32 v37, v37, v221
    v_add_f32 v38, v38, v221
    v_add_f32 v39, v39, v221
    v_exp_f32 v221, v221
    s_nop 7
    s_nop 7
    v_mul_f32 v64, v64, v221
    v_mul_f32 v65, v65, v221
    v_mul_f32 v66, v66, v221
    v_mul_f32 v67, v67, v221
    v_mul_f32 v68, v68, v221
    v_mul_f32 v69, v69, v221
    v_mul_f32 v70, v70, v221
    v_mul_f32 v71, v71, v221
    v_mul_f32 v72, v72, v221
    v_mul_f32 v73, v73, v221
    v_mul_f32 v74, v74, v221
    v_mul_f32 v75, v75, v221
    v_mul_f32 v76, v76, v221
    v_mul_f32 v77, v77, v221
    v_mul_f32 v78, v78, v221
    v_mul_f32 v79, v79, v221
    s_mov_b32 s46, 0x41000000
    s_nop 1
    s_branch K2S_BACK17
K2S_RARE18:
    v_xor_b32 v218, 32, v2
    v_lshlrev_b32 v218, 2, v218
    ds_bpermute_b32 v219, v218, v217
    s_waitcnt lgkmcnt(0)
    v_max_f32 v217, v217, v219
    v_cmp_lt_f32 vcc, s46, v217
    s_nop 1
    v_cndmask_b32 v217, 0, v217, vcc
    v_add_f32 v217, v216, v217
    v_sub_f32 v218, 0, v217
    v_cvt_pk_bf16_f32 v219, v218, v218
    v_lshlrev_b32 v220, 16, v219
    v_sub_f32 v221, v218, v220
    v_cvt_pk_bf16_f32 v221, v221, v221
    v_lshlrev_b32 v222, 16, v221
    v_add_f32 v220, v220, v222
    v_and_b32 v219, 0xffff, v219
    v_lshl_or_b32 v219, v221, 16, v219
    v_cndmask_b32 v22, v22, v219, s[42:43]
    v_add_f32 v221, v216, v220
    v_sub_f32 v216, 0, v220
    v_add_f32 v24, v24, v221
    v_add_f32 v25, v25, v221
    v_add_f32 v26, v26, v221
    v_add_f32 v27, v27, v221
    v_add_f32 v28, v28, v221
    v_add_f32 v29, v29, v221
    v_add_f32 v30, v30, v221
    v_add_f32 v31, v31, v221
    v_add_f32 v32, v32, v221
    v_add_f32 v33, v33, v221
    v_add_f32 v34, v34, v221
    v_add_f32 v35, v35, v221
    v_add_f32 v36, v36, v221
    v_add_f32 v37, v37, v221
    v_add_f32 v38, v38, v221
    v_add_f32 v39, v39, v221
    s_nop 7
    v_add_f32 v40, v40, v221
    v_add_f32 v41, v41, v221
    v_add_f32 v42, v42, v221
    v_add_f32 v43, v43, v221
    v_add_f32 v44, v44, v221
    v_add_f32 v45, v45, v221
    v_add_f32 v46, v46, v221
    v_add_f32 v47, v47, v221
    v_add_f32 v48, v48, v221
    v_add_f32 v49, v49, v221
    v_add_f32 v50, v50, v221
    v_add_f32 v51, v51, v221
    v_add_f32 v52, v52, v221
    v_add_f32 v53, v53, v221
    v_add_f32 v54, v54, v221
    v_add_f32 v55, v55, v221
    v_exp_f32 v221, v221
    s_nop 7
    s_nop 7
    v_mul_f32 v64, v64, v221
    v_mul_f32 v65, v65, v221
    v_mul_f32 v66, v66, v221
    v_mul_f32 v67, v67, v221
    v_mul_f32 v68, v68, v221
    v_mul_f32 v69, v69, v221
    v_mul_f32 v70, v70, v221
    v_mul_f32 v71, v71, v221
    v_mul_f32 v72, v72, v221
    v_mul_f32 v73, v73, v221
    v_mul_f32 v74, v74, v221
    v_mul_f32 v75, v75, v221
    v_mul_f32 v76, v76, v221
    v_mul_f32 v77, v77, v221
    v_mul_f32 v78, v78, v221
    v_mul_f32 v79, v79, v221
    s_mov_b32 s46, 0x41000000
    s_nop 1
    s_branch K2S_BACK18
K2S_RARE19:
    v_xor_b32 v218, 32, v2
    v_lshlrev_b32 v218, 2, v218
    ds_bpermute_b32 v219, v218, v217
    s_waitcnt lgkmcnt(0)
    v_max_f32 v217, v217, v219
    v_cmp_lt_f32 vcc, s46, v217
    s_nop 1
    v_cndmask_b32 v217, 0, v217, vcc
    v_add_f32 v217, v216, v217
    v_sub_f32 v218, 0, v217
    v_cvt_pk_bf16_f32 v219, v218, v218
    v_lshlrev_b32 v220, 16, v219
    v_sub_f32 v221, v218, v220
    v_cvt_pk_bf16_f32 v221, v221, v221
    v_lshlrev_b32 v222, 16, v221
    v_add_f32 v220, v220, v222
    v_and_b32 v219, 0xffff, v219
    v_lshl_or_b32 v219, v221, 16, v219
    v_cndmask_b32 v22, v22, v219, s[42:43]
    v_add_f32 v221, v216, v220
    v_sub_f32 v216, 0, v220
    v_add_f32 v40, v40, v221
    v_add_f32 v41, v41, v221
    v_add_f32 v42, v42, v221
    v_add_f32 v43, v43, v221
    v_add_f32 v44, v44, v221
    v_add_f32 v45, v45, v221
    v_add_f32 v46, v46, v221
    v_add_f32 v47, v47, v221
    v_add_f32 v48, v48, v221
    v_add_f32 v49, v49, v221
    v_add_f32 v50, v50, v221
    v_add_f32 v51, v51, v221
    v_add_f32 v52, v52, v221
    v_add_f32 v53, v53, v221
    v_add_f32 v54, v54, v221
    v_add_f32 v55, v55, v221
    s_nop 7
    v_add_f32 v24, v24, v221
    v_add_f32 v25, v25, v221
    v_add_f32 v26, v26, v221
    v_add_f32 v27, v27, v221
    v_add_f32 v28, v28, v221
    v_add_f32 v29, v29, v221
    v_add_f32 v30, v30, v221
    v_add_f32 v31, v31, v221
    v_add_f32 v32, v32, v221
    v_add_f32 v33, v33, v221
    v_add_f32 v34, v34, v221
    v_add_f32 v35, v35, v221
    v_add_f32 v36, v36, v221
    v_add_f32 v37, v37, v221
    v_add_f32 v38, v38, v221
    v_add_f32 v39, v39, v221
    v_exp_f32 v221, v221
    s_nop 7
    s_nop 7
    v_mul_f32 v64, v64, v221
    v_mul_f32 v65, v65, v221
    v_mul_f32 v66, v66, v221
    v_mul_f32 v67, v67, v221
    v_mul_f32 v68, v68, v221
    v_mul_f32 v69, v69, v221
    v_mul_f32 v70, v70, v221
    v_mul_f32 v71, v71, v221
    v_mul_f32 v72, v72, v221
    v_mul_f32 v73, v73, v221
    v_mul_f32 v74, v74, v221
    v_mul_f32 v75, v75, v221
    v_mul_f32 v76, v76, v221
    v_mul_f32 v77, v77, v221
    v_mul_f32 v78, v78, v221
    v_mul_f32 v79, v79, v221
    s_mov_b32 s46, 0x41000000
    s_nop 1
    s_branch K2S_BACK19
K2S_RARE20:
    v_xor_b32 v218, 32, v2
    v_lshlrev_b32 v218, 2, v218
    ds_bpermute_b32 v219, v218, v217
    s_waitcnt lgkmcnt(0)
    v_max_f32 v217, v217, v219
    v_cmp_lt_f32 vcc, s46, v217
    s_nop 1
    v_cndmask_b32 v217, 0, v217, vcc
    v_add_f32 v217, v216, v217
    v_sub_f32 v218, 0, v217
    v_cvt_pk_bf16_f32 v219, v218, v218
    v_lshlrev_b32 v220, 16, v219
    v_sub_f32 v221, v218, v220
    v_cvt_pk_bf16_f32 v221, v221, v221
    v_lshlrev_b32 v222, 16, v221
    v_add_f32 v220, v220, v222
    v_and_b32 v219, 0xffff, v219
    v_lshl_or_b32 v219, v221, 16, v219
    v_cndmask_b32 v22, v22, v219, s[42:43]
    v_add_f32 v221, v216, v220
    v_sub_f32 v216, 0, v220
    v_add_f32 v24, v24, v221
    v_add_f32 v25, v25, v221
    v_add_f32 v26, v26, v221
    v_add_f32 v27, v27, v221
    v_add_f32 v28, v28, v221
    v_add_f32 v29, v29, v221
    v_add_f32 v30, v30, v221
    v_add_f32 v31, v31, v221
    v_add_f32 v32, v32, v221
    v_add_f32 v33, v33, v221
    v_add_f32 v34, v34, v221
    v_add_f32 v35, v35, v221
    v_add_f32 v36, v36, v221
    v_add_f32 v37, v37, v221
    v_add_f32 v38, v38, v221
    v_add_f32 v39, v39, v221
    s_nop 7
    v_add_f32 v40, v40, v221
    v_add_f32 v41, v41, v221
    v_add_f32 v42, v42, v221
    v_add_f32 v43, v43, v221
    v_add_f32 v44, v44, v221
    v_add_f32 v45, v45, v221
    v_add_f32 v46, v46, v221
    v_add_f32 v47, v47, v221
    v_add_f32 v48, v48, v221
    v_add_f32 v49, v49, v221
    v_add_f32 v50, v50, v221
    v_add_f32 v51, v51, v221
    v_add_f32 v52, v52, v221
    v_add_f32 v53, v53, v221
    v_add_f32 v54, v54, v221
    v_add_f32 v55, v55, v221
    v_exp_f32 v221, v221
    s_nop 7
    s_nop 7
    v_mul_f32 v64, v64, v221
    v_mul_f32 v65, v65, v221
    v_mul_f32 v66, v66, v221
    v_mul_f32 v67, v67, v221
    v_mul_f32 v68, v68, v221
    v_mul_f32 v69, v69, v221
    v_mul_f32 v70, v70, v221
    v_mul_f32 v71, v71, v221
    v_mul_f32 v72, v72, v221
    v_mul_f32 v73, v73, v221
    v_mul_f32 v74, v74, v221
    v_mul_f32 v75, v75, v221
    v_mul_f32 v76, v76, v221
    v_mul_f32 v77, v77, v221
    v_mul_f32 v78, v78, v221
    v_mul_f32 v79, v79, v221
    s_mov_b32 s46, 0x41000000
    s_nop 1
    s_branch K2S_BACK20
K2S_RARE21:
    v_xor_b32 v218, 32, v2
    v_lshlrev_b32 v218, 2, v218
    ds_bpermute_b32 v219, v218, v217
    s_waitcnt lgkmcnt(0)
    v_max_f32 v217, v217, v219
    v_cmp_lt_f32 vcc, s46, v217
    s_nop 1
    v_cndmask_b32 v217, 0, v217, vcc
    v_add_f32 v217, v216, v217
    v_sub_f32 v218, 0, v217
    v_cvt_pk_bf16_f32 v219, v218, v218
    v_lshlrev_b32 v220, 16, v219
    v_sub_f32 v221, v218, v220
    v_cvt_pk_bf16_f32 v221, v221, v221
    v_lshlrev_b32 v222, 16, v221
    v_add_f32 v220, v220, v222
    v_and_b32 v219, 0xffff, v219
    v_lshl_or_b32 v219, v221, 16, v219
    v_cndmask_b32 v22, v22, v219, s[42:43]
    v_add_f32 v221, v216, v220
    v_sub_f32 v216, 0, v220
    v_add_f32 v40, v40, v221
    v_add_f32 v41, v41, v221
    v_add_f32 v42, v42, v221
    v_add_f32 v43, v43, v221
    v_add_f32 v44, v44, v221
    v_add_f32 v45, v45, v221
    v_add_f32 v46, v46, v221
    v_add_f32 v47, v47, v221
    v_add_f32 v48, v48, v221
    v_add_f32 v49, v49, v221
    v_add_f32 v50, v50, v221
    v_add_f32 v51, v51, v221
    v_add_f32 v52, v52, v221
    v_add_f32 v53, v53, v221
    v_add_f32 v54, v54, v221
    v_add_f32 v55, v55, v221
    s_nop 7
    v_add_f32 v24, v24, v221
    v_add_f32 v25, v25, v221
    v_add_f32 v26, v26, v221
    v_add_f32 v27, v27, v221
    v_add_f32 v28, v28, v221
    v_add_f32 v29, v29, v221
    v_add_f32 v30, v30, v221
    v_add_f32 v31, v31, v221
    v_add_f32 v32, v32, v221
    v_add_f32 v33, v33, v221
    v_add_f32 v34, v34, v221
    v_add_f32 v35, v35, v221
    v_add_f32 v36, v36, v221
    v_add_f32 v37, v37, v221
    v_add_f32 v38, v38, v221
    v_add_f32 v39, v39, v221
    v_exp_f32 v221, v221
    s_nop 7
    s_nop 7
    v_mul_f32 v64, v64, v221
    v_mul_f32 v65, v65, v221
    v_mul_f32 v66, v66, v221
    v_mul_f32 v67, v67, v221
    v_mul_f32 v68, v68, v221
    v_mul_f32 v69, v69, v221
    v_mul_f32 v70, v70, v221
    v_mul_f32 v71, v71, v221
    v_mul_f32 v72, v72, v221
    v_mul_f32 v73, v73, v221
    v_mul_f32 v74, v74, v221
    v_mul_f32 v75, v75, v221
    v_mul_f32 v76, v76, v221
    v_mul_f32 v77, v77, v221
    v_mul_f32 v78, v78, v221
    v_mul_f32 v79, v79, v221
    s_mov_b32 s46, 0x41000000
    s_nop 1
    s_branch K2S_BACK21
K2S_RARE22:
    v_xor_b32 v218, 32, v2
    v_lshlrev_b32 v218, 2, v218
    ds_bpermute_b32 v219, v218, v217
    s_waitcnt lgkmcnt(0)
    v_max_f32 v217, v217, v219
    v_cmp_lt_f32 vcc, s46, v217
    s_nop 1
    v_cndmask_b32 v217, 0, v217, vcc
    v_add_f32 v217, v216, v217
    v_sub_f32 v218, 0, v217
    v_cvt_pk_bf16_f32 v219, v218, v218
    v_lshlrev_b32 v220, 16, v219
    v_sub_f32 v221, v218, v220
    v_cvt_pk_bf16_f32 v221, v221, v221
    v_lshlrev_b32 v222, 16, v221
    v_add_f32 v220, v220, v222
    v_and_b32 v219, 0xffff, v219
    v_lshl_or_b32 v219, v221, 16, v219
    v_cndmask_b32 v22, v22, v219, s[42:43]
    v_add_f32 v221, v216, v220
    v_sub_f32 v216, 0, v220
    v_add_f32 v24, v24, v221
    v_add_f32 v25, v25, v221
    v_add_f32 v26, v26, v221
    v_add_f32 v27, v27, v221
    v_add_f32 v28, v28, v221
    v_add_f32 v29, v29, v221
    v_add_f32 v30, v30, v221
    v_add_f32 v31, v31, v221
    v_add_f32 v32, v32, v221
    v_add_f32 v33, v33, v221
    v_add_f32 v34, v34, v221
    v_add_f32 v35, v35, v221
    v_add_f32 v36, v36, v221
    v_add_f32 v37, v37, v221
    v_add_f32 v38, v38, v221
    v_add_f32 v39, v39, v221
    s_nop 7
    v_add_f32 v40, v40, v221
    v_add_f32 v41, v41, v221
    v_add_f32 v42, v42, v221
    v_add_f32 v43, v43, v221
    v_add_f32 v44, v44, v221
    v_add_f32 v45, v45, v221
    v_add_f32 v46, v46, v221
    v_add_f32 v47, v47, v221
    v_add_f32 v48, v48, v221
    v_add_f32 v49, v49, v221
    v_add_f32 v50, v50, v221
    v_add_f32 v51, v51, v221
    v_add_f32 v52, v52, v221
    v_add_f32 v53, v53, v221
    v_add_f32 v54, v54, v221
    v_add_f32 v55, v55, v221
    v_exp_f32 v221, v221
    s_nop 7
    s_nop 7
    v_mul_f32 v64, v64, v221
    v_mul_f32 v65, v65, v221
    v_mul_f32 v66, v66, v221
    v_mul_f32 v67, v67, v221
    v_mul_f32 v68, v68, v221
    v_mul_f32 v69, v69, v221
    v_mul_f32 v70, v70, v221
    v_mul_f32 v71, v71, v221
    v_mul_f32 v72, v72, v221
    v_mul_f32 v73, v73, v221
    v_mul_f32 v74, v74, v221
    v_mul_f32 v75, v75, v221
    v_mul_f32 v76, v76, v221
    v_mul_f32 v77, v77, v221
    v_mul_f32 v78, v78, v221
    v_mul_f32 v79, v79, v221
    s_mov_b32 s46, 0x41000000
    s_nop 1
    s_branch K2S_BACK22
K2S_RARE23:
    v_xor_b32 v218, 32, v2
    v_lshlrev_b32 v218, 2, v218
    ds_bpermute_b32 v219, v218, v217
    s_waitcnt lgkmcnt(0)
    v_max_f32 v217, v217, v219
    v_cmp_lt_f32 vcc, s46, v217
    s_nop 1
    v_cndmask_b32 v217, 0, v217, vcc
    v_add_f32 v217, v216, v217
    v_sub_f32 v218, 0, v217
    v_cvt_pk_bf16_f32 v219, v218, v218
    v_lshlrev_b32 v220, 16, v219
    v_sub_f32 v221, v218, v220
    v_cvt_pk_bf16_f32 v221, v221, v221
    v_lshlrev_b32 v222, 16, v221
    v_add_f32 v220, v220, v222
    v_and_b32 v219, 0xffff, v219
    v_lshl_or_b32 v219, v221, 16, v219
    v_cndmask_b32 v22, v22, v219, s[42:43]
    v_add_f32 v221, v216, v220
    v_sub_f32 v216, 0, v220
    v_add_f32 v40, v40, v221
    v_add_f32 v41, v41, v221
    v_add_f32 v42, v42, v221
    v_add_f32 v43, v43, v221
    v_add_f32 v44, v44, v221
    v_add_f32 v45, v45, v221
    v_add_f32 v46, v46, v221
    v_add_f32 v47, v47, v221
    v_add_f32 v48, v48, v221
    v_add_f32 v49, v49, v221
    v_add_f32 v50, v50, v221
    v_add_f32 v51, v51, v221
    v_add_f32 v52, v52, v221
    v_add_f32 v53, v53, v221
    v_add_f32 v54, v54, v221
    v_add_f32 v55, v55, v221
    s_nop 7
    v_add_f32 v24, v24, v221
    v_add_f32 v25, v25, v221
    v_add_f32 v26, v26, v221
    v_add_f32 v27, v27, v221
    v_add_f32 v28, v28, v221
    v_add_f32 v29, v29, v221
    v_add_f32 v30, v30, v221
    v_add_f32 v31, v31, v221
    v_add_f32 v32, v32, v221
    v_add_f32 v33, v33, v221
    v_add_f32 v34, v34, v221
    v_add_f32 v35, v35, v221
    v_add_f32 v36, v36, v221
    v_add_f32 v37, v37, v221
    v_add_f32 v38, v38, v221
    v_add_f32 v39, v39, v221
    v_exp_f32 v221, v221
    s_nop 7
    s_nop 7
    v_mul_f32 v64, v64, v221
    v_mul_f32 v65, v65, v221
    v_mul_f32 v66, v66, v221
    v_mul_f32 v67, v67, v221
    v_mul_f32 v68, v68, v221
    v_mul_f32 v69, v69, v221
    v_mul_f32 v70, v70, v221
    v_mul_f32 v71, v71, v221
    v_mul_f32 v72, v72, v221
    v_mul_f32 v73, v73, v221
    v_mul_f32 v74, v74, v221
    v_mul_f32 v75, v75, v221
    v_mul_f32 v76, v76, v221
    v_mul_f32 v77, v77, v221
    v_mul_f32 v78, v78, v221
    v_mul_f32 v79, v79, v221
    s_mov_b32 s46, 0x41000000
    s_nop 1
    s_branch K2S_BACK23
K2S_RARE24:
    v_xor_b32 v218, 32, v2
    v_lshlrev_b32 v218, 2, v218
    ds_bpermute_b32 v219, v218, v217
    s_waitcnt lgkmcnt(0)
    v_max_f32 v217, v217, v219
    v_cmp_lt_f32 vcc, s46, v217
    s_nop 1
    v_cndmask_b32 v217, 0, v217, vcc
    v_add_f32 v217, v216, v217
    v_sub_f32 v218, 0, v217
    v_cvt_pk_bf16_f32 v219, v218, v218
    v_lshlrev_b32 v220, 16, v219
    v_sub_f32 v221, v218, v220
    v_cvt_pk_bf16_f32 v221, v221, v221
    v_lshlrev_b32 v222, 16, v221
    v_add_f32 v220, v220, v222
    v_and_b32 v219, 0xffff, v219
    v_lshl_or_b32 v219, v221, 16, v219
    v_cndmask_b32 v22, v22, v219, s[42:43]
    v_add_f32 v221, v216, v220
    v_sub_f32 v216, 0, v220
    v_add_f32 v24, v24, v221
    v_add_f32 v25, v25, v221
    v_add_f32 v26, v26, v221
    v_add_f32 v27, v27, v221
    v_add_f32 v28, v28, v221
    v_add_f32 v29, v29, v221
    v_add_f32 v30, v30, v221
    v_add_f32 v31, v31, v221
    v_add_f32 v32, v32, v221
    v_add_f32 v33, v33, v221
    v_add_f32 v34, v34, v221
    v_add_f32 v35, v35, v221
    v_add_f32 v36, v36, v221
    v_add_f32 v37, v37, v221
    v_add_f32 v38, v38, v221
    v_add_f32 v39, v39, v221
    s_nop 7
    v_add_f32 v40, v40, v221
    v_add_f32 v41, v41, v221
    v_add_f32 v42, v42, v221
    v_add_f32 v43, v43, v221
    v_add_f32 v44, v44, v221
    v_add_f32 v45, v45, v221
    v_add_f32 v46, v46, v221
    v_add_f32 v47, v47, v221
    v_add_f32 v48, v48, v221
    v_add_f32 v49, v49, v221
    v_add_f32 v50, v50, v221
    v_add_f32 v51, v51, v221
    v_add_f32 v52, v52, v221
    v_add_f32 v53, v53, v221
    v_add_f32 v54, v54, v221
    v_add_f32 v55, v55, v221
    v_exp_f32 v221, v221
    s_nop 7
    s_nop 7
    v_mul_f32 v64, v64, v221
    v_mul_f32 v65, v65, v221
    v_mul_f32 v66, v66, v221
    v_mul_f32 v67, v67, v221
    v_mul_f32 v68, v68, v221
    v_mul_f32 v69, v69, v221
    v_mul_f32 v70, v70, v221
    v_mul_f32 v71, v71, v221
    v_mul_f32 v72, v72, v221
    v_mul_f32 v73, v73, v221
    v_mul_f32 v74, v74, v221
    v_mul_f32 v75, v75, v221
    v_mul_f32 v76, v76, v221
    v_mul_f32 v77, v77, v221
    v_mul_f32 v78, v78, v221
    v_mul_f32 v79, v79, v221
    s_mov_b32 s46, 0x41000000
    s_nop 1
    s_branch K2S_BACK24
K2S_RARE25:
    v_xor_b32 v218, 32, v2
    v_lshlrev_b32 v218, 2, v218
    ds_bpermute_b32 v219, v218, v217
    s_waitcnt lgkmcnt(0)
    v_max_f32 v217, v217, v219
    v_cmp_lt_f32 vcc, s46, v217
    s_nop 1
    v_cndmask_b32 v217, 0, v217, vcc
    v_add_f32 v217, v216, v217
    v_sub_f32 v218, 0, v217
    v_cvt_pk_bf16_f32 v219, v218, v218
    v_lshlrev_b32 v220, 16, v219
    v_sub_f32 v221, v218, v220
    v_cvt_pk_bf16_f32 v221, v221, v221
    v_lshlrev_b32 v222, 16, v221
    v_add_f32 v220, v220, v222
    v_and_b32 v219, 0xffff, v219
    v_lshl_or_b32 v219, v221, 16, v219
    v_cndmask_b32 v22, v22, v219, s[42:43]
    v_add_f32 v221, v216, v220
    v_sub_f32 v216, 0, v220
    v_add_f32 v40, v40, v221
    v_add_f32 v41, v41, v221
    v_add_f32 v42, v42, v221
    v_add_f32 v43, v43, v221
    v_add_f32 v44, v44, v221
    v_add_f32 v45, v45, v221
    v_add_f32 v46, v46, v221
    v_add_f32 v47, v47, v221
    v_add_f32 v48, v48, v221
    v_add_f32 v49, v49, v221
    v_add_f32 v50, v50, v221
    v_add_f32 v51, v51, v221
    v_add_f32 v52, v52, v221
    v_add_f32 v53, v53, v221
    v_add_f32 v54, v54, v221
    v_add_f32 v55, v55, v221
    s_nop 7
    v_add_f32 v24, v24, v221
    v_add_f32 v25, v25, v221
    v_add_f32 v26, v26, v221
    v_add_f32 v27, v27, v221
    v_add_f32 v28, v28, v221
    v_add_f32 v29, v29, v221
    v_add_f32 v30, v30, v221
    v_add_f32 v31, v31, v221
    v_add_f32 v32, v32, v221
    v_add_f32 v33, v33, v221
    v_add_f32 v34, v34, v221
    v_add_f32 v35, v35, v221
    v_add_f32 v36, v36, v221
    v_add_f32 v37, v37, v221
    v_add_f32 v38, v38, v221
    v_add_f32 v39, v39, v221
    v_exp_f32 v221, v221
    s_nop 7
    s_nop 7
    v_mul_f32 v64, v64, v221
    v_mul_f32 v65, v65, v221
    v_mul_f32 v66, v66, v221
    v_mul_f32 v67, v67, v221
    v_mul_f32 v68, v68, v221
    v_mul_f32 v69, v69, v221
    v_mul_f32 v70, v70, v221
    v_mul_f32 v71, v71, v221
    v_mul_f32 v72, v72, v221
    v_mul_f32 v73, v73, v221
    v_mul_f32 v74, v74, v221
    v_mul_f32 v75, v75, v221
    v_mul_f32 v76, v76, v221
    v_mul_f32 v77, v77, v221
    v_mul_f32 v78, v78, v221
    v_mul_f32 v79, v79, v221
    s_mov_b32 s46, 0x41000000
    s_nop 1
    s_branch K2S_BACK25
K2S_RARE26:
    v_xor_b32 v218, 32, v2
    v_lshlrev_b32 v218, 2, v218
    ds_bpermute_b32 v219, v218, v217
    s_waitcnt lgkmcnt(0)
    v_max_f32 v217, v217, v219
    v_cmp_lt_f32 vcc, s46, v217
    s_nop 1
    v_cndmask_b32 v217, 0, v217, vcc
    v_add_f32 v217, v216, v217
    v_sub_f32 v218, 0, v217
    v_cvt_pk_bf16_f32 v219, v218, v218
    v_lshlrev_b32 v220, 16, v219
    v_sub_f32 v221, v218, v220
    v_cvt_pk_bf16_f32 v221, v221, v221
    v_lshlrev_b32 v222, 16, v221
    v_add_f32 v220, v220, v222
    v_and_b32 v219, 0xffff, v219
    v_lshl_or_b32 v219, v221, 16, v219
    v_cndmask_b32 v22, v22, v219, s[42:43]
    v_add_f32 v221, v216, v220
    v_sub_f32 v216, 0, v220
    v_add_f32 v24, v24, v221
    v_add_f32 v25, v25, v221
    v_add_f32 v26, v26, v221
    v_add_f32 v27, v27, v221
    v_add_f32 v28, v28, v221
    v_add_f32 v29, v29, v221
    v_add_f32 v30, v30, v221
    v_add_f32 v31, v31, v221
    v_add_f32 v32, v32, v221
    v_add_f32 v33, v33, v221
    v_add_f32 v34, v34, v221
    v_add_f32 v35, v35, v221
    v_add_f32 v36, v36, v221
    v_add_f32 v37, v37, v221
    v_add_f32 v38, v38, v221
    v_add_f32 v39, v39, v221
    s_nop 7
    v_add_f32 v40, v40, v221
    v_add_f32 v41, v41, v221
    v_add_f32 v42, v42, v221
    v_add_f32 v43, v43, v221
    v_add_f32 v44, v44, v221
    v_add_f32 v45, v45, v221
    v_add_f32 v46, v46, v221
    v_add_f32 v47, v47, v221
    v_add_f32 v48, v48, v221
    v_add_f32 v49, v49, v221
    v_add_f32 v50, v50, v221
    v_add_f32 v51, v51, v221
    v_add_f32 v52, v52, v221
    v_add_f32 v53, v53, v221
    v_add_f32 v54, v54, v221
    v_add_f32 v55, v55, v221
    v_exp_f32 v221, v221
    s_nop 7
    s_nop 7
    v_mul_f32 v64, v64, v221
    v_mul_f32 v65, v65, v221
    v_mul_f32 v66, v66, v221
    v_mul_f32 v67, v67, v221
    v_mul_f32 v68, v68, v221
    v_mul_f32 v69, v69, v221
    v_mul_f32 v70, v70, v221
    v_mul_f32 v71, v71, v221
    v_mul_f32 v72, v72, v221
    v_mul_f32 v73, v73, v221
    v_mul_f32 v74, v74, v221
    v_mul_f32 v75, v75, v221
    v_mul_f32 v76, v76, v221
    v_mul_f32 v77, v77, v221
    v_mul_f32 v78, v78, v221
    v_mul_f32 v79, v79, v221
    s_mov_b32 s46, 0x41000000
    s_nop 1
    s_branch K2S_BACK26
K2S_RARE27:
    v_xor_b32 v218, 32, v2
    v_lshlrev_b32 v218, 2, v218
    ds_bpermute_b32 v219, v218, v217
    s_waitcnt lgkmcnt(0)
    v_max_f32 v217, v217, v219
    v_cmp_lt_f32 vcc, s46, v217
    s_nop 1
    v_cndmask_b32 v217, 0, v217, vcc
    v_add_f32 v217, v216, v217
    v_sub_f32 v218, 0, v217
    v_cvt_pk_bf16_f32 v219, v218, v218
    v_lshlrev_b32 v220, 16, v219
    v_sub_f32 v221, v218, v220
    v_cvt_pk_bf16_f32 v221, v221, v221
    v_lshlrev_b32 v222, 16, v221
    v_add_f32 v220, v220, v222
    v_and_b32 v219, 0xffff, v219
    v_lshl_or_b32 v219, v221, 16, v219
    v_cndmask_b32 v22, v22, v219, s[42:43]
    v_add_f32 v221, v216, v220
    v_sub_f32 v216, 0, v220
    v_add_f32 v40, v40, v221
    v_add_f32 v41, v41, v221
    v_add_f32 v42, v42, v221
    v_add_f32 v43, v43, v221
    v_add_f32 v44, v44, v221
    v_add_f32 v45, v45, v221
    v_add_f32 v46, v46, v221
    v_add_f32 v47, v47, v221
    v_add_f32 v48, v48, v221
    v_add_f32 v49, v49, v221
    v_add_f32 v50, v50, v221
    v_add_f32 v51, v51, v221
    v_add_f32 v52, v52, v221
    v_add_f32 v53, v53, v221
    v_add_f32 v54, v54, v221
    v_add_f32 v55, v55, v221
    s_nop 7
    v_add_f32 v24, v24, v221
    v_add_f32 v25, v25, v221
    v_add_f32 v26, v26, v221
    v_add_f32 v27, v27, v221
    v_add_f32 v28, v28, v221
    v_add_f32 v29, v29, v221
    v_add_f32 v30, v30, v221
    v_add_f32 v31, v31, v221
    v_add_f32 v32, v32, v221
    v_add_f32 v33, v33, v221
    v_add_f32 v34, v34, v221
    v_add_f32 v35, v35, v221
    v_add_f32 v36, v36, v221
    v_add_f32 v37, v37, v221
    v_add_f32 v38, v38, v221
    v_add_f32 v39, v39, v221
    v_exp_f32 v221, v221
    s_nop 7
    s_nop 7
    v_mul_f32 v64, v64, v221
    v_mul_f32 v65, v65, v221
    v_mul_f32 v66, v66, v221
    v_mul_f32 v67, v67, v221
    v_mul_f32 v68, v68, v221
    v_mul_f32 v69, v69, v221
    v_mul_f32 v70, v70, v221
    v_mul_f32 v71, v71, v221
    v_mul_f32 v72, v72, v221
    v_mul_f32 v73, v73, v221
    v_mul_f32 v74, v74, v221
    v_mul_f32 v75, v75, v221
    v_mul_f32 v76, v76, v221
    v_mul_f32 v77, v77, v221
    v_mul_f32 v78, v78, v221
    v_mul_f32 v79, v79, v221
    s_mov_b32 s46, 0x41000000
    s_nop 1
    s_branch K2S_BACK27
K2S_RARE28:
    v_xor_b32 v218, 32, v2
    v_lshlrev_b32 v218, 2, v218
    ds_bpermute_b32 v219, v218, v217
    s_waitcnt lgkmcnt(0)
    v_max_f32 v217, v217, v219
    v_cmp_lt_f32 vcc, s46, v217
    s_nop 1
    v_cndmask_b32 v217, 0, v217, vcc
    v_add_f32 v217, v216, v217
    v_sub_f32 v218, 0, v217
    v_cvt_pk_bf16_f32 v219, v218, v218
    v_lshlrev_b32 v220, 16, v219
    v_sub_f32 v221, v218, v220
    v_cvt_pk_bf16_f32 v221, v221, v221
    v_lshlrev_b32 v222, 16, v221
    v_add_f32 v220, v220, v222
    v_and_b32 v219, 0xffff, v219
    v_lshl_or_b32 v219, v221, 16, v219
    v_cndmask_b32 v22, v22, v219, s[42:43]
    v_add_f32 v221, v216, v220
    v_sub_f32 v216, 0, v220
    v_add_f32 v24, v24, v221
    v_add_f32 v25, v25, v221
    v_add_f32 v26, v26, v221
    v_add_f32 v27, v27, v221
    v_add_f32 v28, v28, v221
    v_add_f32 v29, v29, v221
    v_add_f32 v30, v30, v221
    v_add_f32 v31, v31, v221
    v_add_f32 v32, v32, v221
    v_add_f32 v33, v33, v221
    v_add_f32 v34, v34, v221
    v_add_f32 v35, v35, v221
    v_add_f32 v36, v36, v221
    v_add_f32 v37, v37, v221
    v_add_f32 v38, v38, v221
    v_add_f32 v39, v39, v221
    s_nop 7
    v_add_f32 v40, v40, v221
    v_add_f32 v41, v41, v221
    v_add_f32 v42, v42, v221
    v_add_f32 v43, v43, v221
    v_add_f32 v44, v44, v221
    v_add_f32 v45, v45, v221
    v_add_f32 v46, v46, v221
    v_add_f32 v47, v47, v221
    v_add_f32 v48, v48, v221
    v_add_f32 v49, v49, v221
    v_add_f32 v50, v50, v221
    v_add_f32 v51, v51, v221
    v_add_f32 v52, v52, v221
    v_add_f32 v53, v53, v221
    v_add_f32 v54, v54, v221
    v_add_f32 v55, v55, v221
    v_exp_f32 v221, v221
    s_nop 7
    s_nop 7
    v_mul_f32 v64, v64, v221
    v_mul_f32 v65, v65, v221
    v_mul_f32 v66, v66, v221
    v_mul_f32 v67, v67, v221
    v_mul_f32 v68, v68, v221
    v_mul_f32 v69, v69, v221
    v_mul_f32 v70, v70, v221
    v_mul_f32 v71, v71, v221
    v_mul_f32 v72, v72, v221
    v_mul_f32 v73, v73, v221
    v_mul_f32 v74, v74, v221
    v_mul_f32 v75, v75, v221
    v_mul_f32 v76, v76, v221
    v_mul_f32 v77, v77, v221
    v_mul_f32 v78, v78, v221
    v_mul_f32 v79, v79, v221
    s_mov_b32 s46, 0x41000000
    s_nop 1
    s_branch K2S_BACK28
K2S_RARE29:
    v_xor_b32 v218, 32, v2
    v_lshlrev_b32 v218, 2, v218
    ds_bpermute_b32 v219, v218, v217
    s_waitcnt lgkmcnt(0)
    v_max_f32 v217, v217, v219
    v_cmp_lt_f32 vcc, s46, v217
    s_nop 1
    v_cndmask_b32 v217, 0, v217, vcc
    v_add_f32 v217, v216, v217
    v_sub_f32 v218, 0, v217
    v_cvt_pk_bf16_f32 v219, v218, v218
    v_lshlrev_b32 v220, 16, v219
    v_sub_f32 v221, v218, v220
    v_cvt_pk_bf16_f32 v221, v221, v221
    v_lshlrev_b32 v222, 16, v221
    v_add_f32 v220, v220, v222
    v_and_b32 v219, 0xffff, v219
    v_lshl_or_b32 v219, v221, 16, v219
    v_cndmask_b32 v22, v22, v219, s[42:43]
    v_add_f32 v221, v216, v220
    v_sub_f32 v216, 0, v220
    v_add_f32 v40, v40, v221
    v_add_f32 v41, v41, v221
    v_add_f32 v42, v42, v221
    v_add_f32 v43, v43, v221
    v_add_f32 v44, v44, v221
    v_add_f32 v45, v45, v221
    v_add_f32 v46, v46, v221
    v_add_f32 v47, v47, v221
    v_add_f32 v48, v48, v221
    v_add_f32 v49, v49, v221
    v_add_f32 v50, v50, v221
    v_add_f32 v51, v51, v221
    v_add_f32 v52, v52, v221
    v_add_f32 v53, v53, v221
    v_add_f32 v54, v54, v221
    v_add_f32 v55, v55, v221
    s_nop 7
    v_add_f32 v24, v24, v221
    v_add_f32 v25, v25, v221
    v_add_f32 v26, v26, v221
    v_add_f32 v27, v27, v221
    v_add_f32 v28, v28, v221
    v_add_f32 v29, v29, v221
    v_add_f32 v30, v30, v221
    v_add_f32 v31, v31, v221
    v_add_f32 v32, v32, v221
    v_add_f32 v33, v33, v221
    v_add_f32 v34, v34, v221
    v_add_f32 v35, v35, v221
    v_add_f32 v36, v36, v221
    v_add_f32 v37, v37, v221
    v_add_f32 v38, v38, v221
    v_add_f32 v39, v39, v221
    v_exp_f32 v221, v221
    s_nop 7
    s_nop 7
    v_mul_f32 v64, v64, v221
    v_mul_f32 v65, v65, v221
    v_mul_f32 v66, v66, v221
    v_mul_f32 v67, v67, v221
    v_mul_f32 v68, v68, v221
    v_mul_f32 v69, v69, v221
    v_mul_f32 v70, v70, v221
    v_mul_f32 v71, v71, v221
    v_mul_f32 v72, v72, v221
    v_mul_f32 v73, v73, v221
    v_mul_f32 v74, v74, v221
    v_mul_f32 v75, v75, v221
    v_mul_f32 v76, v76, v221
    v_mul_f32 v77, v77, v221
    v_mul_f32 v78, v78, v221
    v_mul_f32 v79, v79, v221
    s_mov_b32 s46, 0x41000000
    s_nop 1
    s_branch K2S_BACK29
K2S_RARE30:
    v_xor_b32 v218, 32, v2
    v_lshlrev_b32 v218, 2, v218
    ds_bpermute_b32 v219, v218, v217
    s_waitcnt lgkmcnt(0)
    v_max_f32 v217, v217, v219
    v_cmp_lt_f32 vcc, s46, v217
    s_nop 1
    v_cndmask_b32 v217, 0, v217, vcc
    v_add_f32 v217, v216, v217
    v_sub_f32 v218, 0, v217
    v_cvt_pk_bf16_f32 v219, v218, v218
    v_lshlrev_b32 v220, 16, v219
    v_sub_f32 v221, v218, v220
    v_cvt_pk_bf16_f32 v221, v221, v221
    v_lshlrev_b32 v222, 16, v221
    v_add_f32 v220, v220, v222
    v_and_b32 v219, 0xffff, v219
    v_lshl_or_b32 v219, v221, 16, v219
    v_cndmask_b32 v22, v22, v219, s[42:43]
    v_add_f32 v221, v216, v220
    v_sub_f32 v216, 0, v220
    v_add_f32 v24, v24, v221
    v_add_f32 v25, v25, v221
    v_add_f32 v26, v26, v221
    v_add_f32 v27, v27, v221
    v_add_f32 v28, v28, v221
    v_add_f32 v29, v29, v221
    v_add_f32 v30, v30, v221
    v_add_f32 v31, v31, v221
    v_add_f32 v32, v32, v221
    v_add_f32 v33, v33, v221
    v_add_f32 v34, v34, v221
    v_add_f32 v35, v35, v221
    v_add_f32 v36, v36, v221
    v_add_f32 v37, v37, v221
    v_add_f32 v38, v38, v221
    v_add_f32 v39, v39, v221
    s_nop 7
    v_add_f32 v40, v40, v221
    v_add_f32 v41, v41, v221
    v_add_f32 v42, v42, v221
    v_add_f32 v43, v43, v221
    v_add_f32 v44, v44, v221
    v_add_f32 v45, v45, v221
    v_add_f32 v46, v46, v221
    v_add_f32 v47, v47, v221
    v_add_f32 v48, v48, v221
    v_add_f32 v49, v49, v221
    v_add_f32 v50, v50, v221
    v_add_f32 v51, v51, v221
    v_add_f32 v52, v52, v221
    v_add_f32 v53, v53, v221
    v_add_f32 v54, v54, v221
    v_add_f32 v55, v55, v221
    v_exp_f32 v221, v221
    s_nop 7
    s_nop 7
    v_mul_f32 v64, v64, v221
    v_mul_f32 v65, v65, v221
    v_mul_f32 v66, v66, v221
    v_mul_f32 v67, v67, v221
    v_mul_f32 v68, v68, v221
    v_mul_f32 v69, v69, v221
    v_mul_f32 v70, v70, v221
    v_mul_f32 v71, v71, v221
    v_mul_f32 v72, v72, v221
    v_mul_f32 v73, v73, v221
    v_mul_f32 v74, v74, v221
    v_mul_f32 v75, v75, v221
    v_mul_f32 v76, v76, v221
    v_mul_f32 v77, v77, v221
    v_mul_f32 v78, v78, v221
    v_mul_f32 v79, v79, v221
    s_mov_b32 s46, 0x41000000
    s_nop 1
    s_branch K2S_BACK30
K2S_RARE31:
    v_xor_b32 v218, 32, v2
    v_lshlrev_b32 v218, 2, v218
    ds_bpermute_b32 v219, v218, v217
    s_waitcnt lgkmcnt(0)
    v_max_f32 v217, v217, v219
    v_cmp_lt_f32 vcc, s46, v217
    s_nop 1
    v_cndmask_b32 v217, 0, v217, vcc
    v_add_f32 v217, v216, v217
    v_sub_f32 v218, 0, v217
    v_cvt_pk_bf16_f32 v219, v218, v218
    v_lshlrev_b32 v220, 16, v219
    v_sub_f32 v221, v218, v220
    v_cvt_pk_bf16_f32 v221, v221, v221
    v_lshlrev_b32 v222, 16, v221
    v_add_f32 v220, v220, v222
    v_and_b32 v219, 0xffff, v219
    v_lshl_or_b32 v219, v221, 16, v219
    v_cndmask_b32 v22, v22, v219, s[42:43]
    v_add_f32 v221, v216, v220
    v_sub_f32 v216, 0, v220
    v_add_f32 v40, v40, v221
    v_add_f32 v41, v41, v221
    v_add_f32 v42, v42, v221
    v_add_f32 v43, v43, v221
    v_add_f32 v44, v44, v221
    v_add_f32 v45, v45, v221
    v_add_f32 v46, v46, v221
    v_add_f32 v47, v47, v221
    v_add_f32 v48, v48, v221
    v_add_f32 v49, v49, v221
    v_add_f32 v50, v50, v221
    v_add_f32 v51, v51, v221
    v_add_f32 v52, v52, v221
    v_add_f32 v53, v53, v221
    v_add_f32 v54, v54, v221
    v_add_f32 v55, v55, v221
    v_exp_f32 v221, v221
    s_nop 7
    s_nop 7
    v_mul_f32 v64, v64, v221
    v_mul_f32 v65, v65, v221
    v_mul_f32 v66, v66, v221
    v_mul_f32 v67, v67, v221
    v_mul_f32 v68, v68, v221
    v_mul_f32 v69, v69, v221
    v_mul_f32 v70, v70, v221
    v_mul_f32 v71, v71, v221
    v_mul_f32 v72, v72, v221
    v_mul_f32 v73, v73, v221
    v_mul_f32 v74, v74, v221
    v_mul_f32 v75, v75, v221
    v_mul_f32 v76, v76, v221
    v_mul_f32 v77, v77, v221
    v_mul_f32 v78, v78, v221
    v_mul_f32 v79, v79, v221
    s_mov_b32 s46, 0x41000000
    s_nop 1
    s_branch K2S_BACK31
.section .rodata,"a"
.p2align 6
.amdhsa_kernel k2_attn_kernel
  .amdhsa_next_free_vgpr 256
  .amdhsa_next_free_sgpr 102
  .amdhsa_accum_offset 256
  .amdhsa_group_segment_fixed_size 0
  .amdhsa_kernarg_size 104
  .amdhsa_user_sgpr_count 2
  .amdhsa_user_sgpr_kernarg_segment_ptr 1
  .amdhsa_system_sgpr_workgroup_id_x 1
.end_amdhsa_kernel
.text
.globl k3_gemm_kernel
.p2align 8
.type k3_gemm_kernel,@function
k3_gemm_kernel:
    s_cmp_ge_u32 s2, 224
    s_cbranch_scc1 K3_DONE
    s_and_b32 s33, s2, 7
    s_lshr_b32 s34, s2, 3
    s_mul_i32 s35, s34, 37
    s_lshr_b32 s35, s35, 8
    s_mul_i32 s36, s35, 7
    s_sub_u32 s36, s34, s36
    s_lshl_b32 s35, s35, 3
    s_add_u32 s35, s35, s33
    s_cmp_ge_u32 s35, 28
    s_cbranch_scc1 K3_DONE
    s_load_dwordx2 s[4:5], s[0:1], 48
    s_load_dwordx2 s[6:7], s[0:1], 56
    s_load_dwordx2 s[8:9], s[0:1], 80
    s_load_dwordx2 s[12:13], s[0:1], 96
    v_lshrrev_b32 v1, 6, v0
    v_and_b32 v2, 63, v0
    s_nop 0
    v_readfirstlane_b32 s32, v1
    s_waitcnt lgkmcnt(0)
    s_and_b32 s60, s32, 3
    s_lshr_b32 s61, s32, 2
    s_mov_b32 s32, s60
    s_mov_b32 s16, s4
    s_and_b32 s17, s5, 0xffff
    s_mov_b32 s18, 0x700000
    s_mov_b32 s19, 0x00020000
    s_mov_b32 s20, s6
    s_and_b32 s21, s7, 0xffff
    s_mov_b32 s22, 0xe00
    s_mov_b32 s23, 0x00020000
    s_mov_b32 s24, s8
    s_and_b32 s25, s9, 0xffff
    s_mov_b32 s26, 0x1c0000
    s_mov_b32 s27, 0x00020000
    s_mov_b32 s28, s12
    s_and_b32 s29, s13, 0xffff
    s_mov_b32 s30, 0x10000000
    s_mov_b32 s31, 0x00020000
    v_lshrrev_b32 v3, 3, v2
    s_lshl_b32 s37, s32, 3
    v_add_u32 v3, s37, v3
    v_and_b32 v4, 7, v2
    v_lshlrev_b32 v6, 4, v2
    s_lshl_b32 s38, s32, 10
    v_add_u32 v6, s38, v6
    v_add_u32 v7, 4096, v6
    v_bfe_u32 v5, v3, 1, 1
    v_lshlrev_b32 v5, 2, v5
    v_xor_b32 v5, v5, v4
    s_mov_b32 s38, 3584
    v_mul_lo_u32 v8, v3, s38
    v_lshl_add_u32 v8, v5, 4, v8
    v_add_u32 v9, 114688, v8
    s_mul_i32 s40, s36, 262144
    s_add_u32 s40, s40, 5242880
    s_lshl_b32 s41, s35, 7
    s_lshl_b32 s42, s32, 10
    s_cmp_eq_u32 s61, 0
    s_cbranch_scc1 K3_COMPUTE
    s_add_u32 s43, s42, 0
    s_mov_b32 m0, s43
    s_add_u32 s43, s43, 4096
    buffer_load_dwordx4 v6, s[28:31], s40 offen lds
    s_mov_b32 m0, s43
    s_add_u32 s43, s43, 4096
    buffer_load_dwordx4 v7, s[28:31], s40 offen lds
    s_mov_b32 m0, s43
    s_add_u32 s43, s43, 4096
    buffer_load_dwordx4 v8, s[16:19], s41 offen lds
    s_mov_b32 m0, s43
    s_add_u32 s40, s40, 8192
    buffer_load_dwordx4 v9, s[16:19], s41 offen lds
    s_add_u32 s41, s41, 229376
    s_add_u32 s43, s42, 16384
    s_mov_b32 m0, s43
    s_add_u32 s43, s43, 4096
    buffer_load_dwordx4 v6, s[28:31], s40 offen lds
    s_mov_b32 m0, s43
    s_add_u32 s43, s43, 4096
    buffer_load_dwordx4 v7, s[28:31], s40 offen lds
    s_mov_b32 m0, s43
    s_add_u32 s43, s43, 4096
    buffer_load_dwordx4 v8, s[16:19], s41 offen lds
    s_mov_b32 m0, s43
    s_add_u32 s40, s40, 8192
    buffer_load_dwordx4 v9, s[16:19], s41 offen lds
    s_add_u32 s41, s41, 229376
    s_add_u32 s43, s42, 32768
    s_mov_b32 m0, s43
    s_add_u32 s43, s43, 4096
    buffer_load_dwordx4 v6, s[28:31], s40 offen lds
    s_mov_b32 m0, s43
    s_add_u32 s43, s43, 4096
    buffer_load_dwordx4 v7, s[28:31], s40 offen lds
    s_mov_b32 m0, s43
    s_add_u32 s43, s43, 4096
    buffer_load_dwordx4 v8, s[16:19], s41 offen lds
    s_mov_b32 m0, s43
    s_add_u32 s40, s40, 8192
    buffer_load_dwordx4 v9, s[16:19], s41 offen lds
    s_add_u32 s41, s41, 229376
    s_add_u32 s43, s42, 49152
    s_mov_b32 m0, s43
    s_add_u32 s43, s43, 4096
    buffer_load_dwordx4 v6, s[28:31], s40 offen lds
    s_mov_b32 m0, s43
    s_add_u32 s43, s43, 4096
    buffer_load_dwordx4 v7, s[28:31], s40 offen lds
    s_mov_b32 m0, s43
    s_add_u32 s43, s43, 4096
    buffer_load_dwordx4 v8, s[16:19], s41 offen lds
    s_mov_b32 m0, s43
    s_add_u32 s40, s40, 8192
    buffer_load_dwordx4 v9, s[16:19], s41 offen lds
    s_add_u32 s41, s41, 229376
    s_add_u32 s43, s42, 65536
    s_mov_b32 m0, s43
    s_add_u32 s43, s43, 4096
    buffer_load_dwordx4 v6, s[28:31], s40 offen lds
    s_mov_b32 m0, s43
    s_add_u32 s43, s43, 4096
    buffer_load_dwordx4 v7, s[28:31], s40 offen lds
    s_mov_b32 m0, s43
    s_add_u32 s43, s43, 4096
    buffer_load_dwordx4 v8, s[16:19], s41 offen lds
    s_mov_b32 m0, s43
    s_add_u32 s40, s40, 8192
    buffer_load_dwordx4 v9, s[16:19], s41 offen lds
    s_add_u32 s41, s41, 229376
    s_add_u32 s43, s42, 81920
    s_mov_b32 m0, s43
    s_add_u32 s43, s43, 4096
    buffer_load_dwordx4 v6, s[28:31], s40 offen lds
    s_mov_b32 m0, s43
    s_add_u32 s43, s43, 4096
    buffer_load_dwordx4 v7, s[28:31], s40 offen lds
    s_mov_b32 m0, s43
    s_add_u32 s43, s43, 4096
    buffer_load_dwordx4 v8, s[16:19], s41 offen lds
    s_mov_b32 m0, s43
    s_add_u32 s40, s40, 8192
    buffer_load_dwordx4 v9, s[16:19], s41 offen lds
    s_add_u32 s41, s41, 229376
    s_add_u32 s43, s42, 98304
    s_mov_b32 m0, s43
    s_add_u32 s43, s43, 4096
    buffer_load_dwordx4 v6, s[28:31], s40 offen lds
    s_mov_b32 m0, s43
    s_add_u32 s43, s43, 4096
    buffer_load_dwordx4 v7, s[28:31], s40 offen lds
    s_mov_b32 m0, s43
    s_add_u32 s43, s43, 4096
    buffer_load_dwordx4 v8, s[16:19], s41 offen lds
    s_mov_b32 m0, s43
    s_add_u32 s40, s40, 8192
    buffer_load_dwordx4 v9, s[16:19], s41 offen lds
    s_add_u32 s41, s41, 229376
    s_waitcnt vmcnt(24)
    s_barrier
    s_mov_b32 s62, 4
K3_LLOOP:
    s_waitcnt vmcnt(20)
    s_barrier
    s_add_u32 s43, s42, 114688
    s_mov_b32 m0, s43
    s_add_u32 s43, s43, 4096
    buffer_load_dwordx4 v6, s[28:31], s40 offen lds
    s_mov_b32 m0, s43
    s_add_u32 s43, s43, 4096
    buffer_load_dwordx4 v7, s[28:31], s40 offen lds
    s_mov_b32 m0, s43
    s_add_u32 s43, s43, 4096
    buffer_load_dwordx4 v8, s[16:19], s41 offen lds
    s_mov_b32 m0, s43
    s_add_u32 s40, s40, 8192
    buffer_load_dwordx4 v9, s[16:19], s41 offen lds
    s_add_u32 s41, s41, 229376
    s_waitcnt vmcnt(20)
    s_barrier
    s_add_u32 s43, s42, 0
    s_mov_b32 m0, s43
    s_add_u32 s43, s43, 4096
    buffer_load_dwordx4 v6, s[28:31], s40 offen lds
    s_mov_b32 m0, s43
    s_add_u32 s43, s43, 4096
    buffer_load_dwordx4 v7, s[28:31], s40 offen lds
    s_mov_b32 m0, s43
    s_add_u32 s43, s43, 4096
    buffer_load_dwordx4 v8, s[16:19], s41 offen lds
    s_mov_b32 m0, s43
    s_add_u32 s40, s40, 8192
    buffer_load_dwordx4 v9, s[16:19], s41 offen lds
    s_add_u32 s41, s41, 229376
    s_waitcnt vmcnt(20)
    s_barrier
    s_add_u32 s43, s42, 16384
    s_mov_b32 m0, s43
    s_add_u32 s43, s43, 4096
    buffer_load_dwordx4 v6, s[28:31], s40 offen lds
    s_mov_b32 m0, s43
    s_add_u32 s43, s43, 4096
    buffer_load_dwordx4 v7, s[28:31], s40 offen lds
    s_mov_b32 m0, s43
    s_add_u32 s43, s43, 4096
    buffer_load_dwordx4 v8, s[16:19], s41 offen lds
    s_mov_b32 m0, s43
    s_add_u32 s40, s40, 8192
    buffer_load_dwordx4 v9, s[16:19], s41 offen lds
    s_add_u32 s41, s41, 229376
    s_waitcnt vmcnt(20)
    s_barrier
    s_add_u32 s43, s42, 32768
    s_mov_b32 m0, s43
    s_add_u32 s43, s43, 4096
    buffer_load_dwordx4 v6, s[28:31], s40 offen lds
    s_mov_b32 m0, s43
    s_add_u32 s43, s43, 4096
    buffer_load_dwordx4 v7, s[28:31], s40 offen lds
    s_mov_b32 m0, s43
    s_add_u32 s43, s43, 4096
    buffer_load_dwordx4 v8, s[16:19], s41 offen lds
    s_mov_b32 m0, s43
    s_add_u32 s40, s40, 8192
    buffer_load_dwordx4 v9, s[16:19], s41 offen lds
    s_add_u32 s41, s41, 229376
    s_waitcnt vmcnt(20)
    s_barrier
    s_add_u32 s43, s42, 49152
    s_mov_b32 m0, s43
    s_add_u32 s43, s43, 4096
    buffer_load_dwordx4 v6, s[28:31], s40 offen lds
    s_mov_b32 m0, s43
    s_add_u32 s43, s43, 4096
    buffer_load_dwordx4 v7, s[28:31], s40 offen lds
    s_mov_b32 m0, s43
    s_add_u32 s43, s43, 4096
    buffer_load_dwordx4 v8, s[16:19], s41 offen lds
    s_mov_b32 m0, s43
    s_add_u32 s40, s40, 8192
    buffer_load_dwordx4 v9, s[16:19], s41 offen lds
    s_add_u32 s41, s41, 229376
    s_waitcnt vmcnt(20)
    s_barrier
    s_add_u32 s43, s42, 65536
    s_mov_b32 m0, s43
    s_add_u32 s43, s43, 4096
    buffer_load_dwordx4 v6, s[28:31], s40 offen lds
    s_mov_b32 m0, s43
    s_add_u32 s43, s43, 4096
    buffer_load_dwordx4 v7, s[28:31], s40 offen lds
    s_mov_b32 m0, s43
    s_add_u32 s43, s43, 4096
    buffer_load_dwordx4 v8, s[16:19], s41 offen lds
    s_mov_b32 m0, s43
    s_add_u32 s40, s40, 8192
    buffer_load_dwordx4 v9, s[16:19], s41 offen lds
    s_add_u32 s41, s41, 229376
    s_waitcnt vmcnt(20)
    s_barrier
    s_add_u32 s43, s42, 81920
    s_mov_b32 m0, s43
    s_add_u32 s43, s43, 4096
    buffer_load_dwordx4 v6, s[28:31], s40 offen lds
    s_mov_b32 m0, s43
    s_add_u32 s43, s43, 4096
    buffer_load_dwordx4 v7, s[28:31], s40 offen lds
    s_mov_b32 m0, s43
    s_add_u32 s43, s43, 4096
    buffer_load_dwordx4 v8, s[16:19], s41 offen lds
    s_mov_b32 m0, s43
    s_add_u32 s40, s40, 8192
    buffer_load_dwordx4 v9, s[16:19], s41 offen lds
    s_add_u32 s41, s41, 229376
    s_waitcnt vmcnt(20)
    s_barrier
    s_add_u32 s43, s42, 98304
    s_mov_b32 m0, s43
    s_add_u32 s43, s43, 4096
    buffer_load_dwordx4 v6, s[28:31], s40 offen lds
    s_mov_b32 m0, s43
    s_add_u32 s43, s43, 4096
    buffer_load_dwordx4 v7, s[28:31], s40 offen lds
    s_mov_b32 m0, s43
    s_add_u32 s43, s43, 4096
    buffer_load_dwordx4 v8, s[16:19], s41 offen lds
    s_mov_b32 m0, s43
    s_add_u32 s40, s40, 8192
    buffer_load_dwordx4 v9, s[16:19], s41 offen lds
    s_add_u32 s41, s41, 229376
    s_sub_u32 s62, s62, 1
    s_cmp_lg_u32 s62, 0
    s_cbranch_scc1 K3_LLOOP
    s_endpgm
K3_COMPUTE:
    s_and_b32 s44, s32, 1
    s_lshr_b32 s45, s32, 1
    v_and_b32 v10, 31, v2
    s_lshl_b32 s46, s44, 5
    v_add_u32 v10, s46, v10
    v_lshrrev_b32 v11, 5, v2
    v_bfe_u32 v12, v10, 1, 3
    v_xor_b32 v12, v12, v11
    v_lshlrev_b32 v12, 4, v12
    v_lshl_add_u32 v12, v10, 7, v12
    v_xor_b32 v13, 32, v12
    v_xor_b32 v14, 64, v12
    v_xor_b32 v15, 96, v12
    v_bfe_u32 v16, v2, 2, 2
    v_lshl_add_u32 v16, v11, 3, v16
    v_lshlrev_b32 v16, 7, v16
    v_bfe_u32 v17, v2, 4, 1
    v_and_b32 v18, 3, v2
    v_lshlrev_b32 v18, 3, v18
    v_lshl_add_u32 v17, v17, 5, v18
    s_lshl_b32 s46, s45, 6
    v_add_u32 v17, s46, v17
    v_bfe_u32 v18, v2, 3, 1
    v_lshlrev_b32 v18, 6, v18
    v_xor_b32 v17, v17, v18
    v_add_u32 v16, v16, v17
    v_add_u32 v16, 8192, v16
    v_add_u32 v24, 0x10000, v16
    v_add_u32 v25, 0x10000, v12
    v_add_u32 v26, 0x10000, v13
    v_add_u32 v27, 0x10000, v14
    v_add_u32 v28, 0x10000, v15
    v_lshlrev_b32 v19, 3, v11
    s_lshl_b32 s46, s35, 7
    s_lshl_b32 s47, s45, 6
    s_add_u32 s46, s46, s47
    buffer_load_dwordx2 v[160:161], v19, s[20:23], s46 offen offset:0
    buffer_load_dwordx2 v[162:163], v19, s[20:23], s46 offen offset:16
    buffer_load_dwordx2 v[164:165], v19, s[20:23], s46 offen offset:32
    buffer_load_dwordx2 v[166:167], v19, s[20:23], s46 offen offset:48
    s_barrier
    ds_read_b64_tr_b16 v[96:97], v16 offset:0
    ds_read_b64_tr_b16 v[98:99], v16 offset:512
    ds_read_b128 v[100:103], v12 offset:0
    ds_read_b64_tr_b16 v[104:105], v16 offset:2048
    ds_read_b64_tr_b16 v[106:107], v16 offset:2560
    ds_read_b128 v[108:111], v13 offset:0
    ds_read_b64_tr_b16 v[112:113], v16 offset:4096
    ds_read_b64_tr_b16 v[114:115], v16 offset:4608
    ds_read_b128 v[116:119], v14 offset:0
    ds_read_b64_tr_b16 v[120:121], v16 offset:6144
    ds_read_b64_tr_b16 v[122:123], v16 offset:6656
    ds_read_b128 v[124:127], v15 offset:0
    v_mov_b32 v64, 0
    v_mov_b32 v65, 0
    v_mov_b32 v66, 0
    v_mov_b32 v67, 0
    v_mov_b32 v68, 0
    v_mov_b32 v69, 0
    v_mov_b32 v70, 0
    v_mov_b32 v71, 0
    v_mov_b32 v72, 0
    v_mov_b32 v73, 0
    v_mov_b32 v74, 0
    v_mov_b32 v75, 0
    v_mov_b32 v76, 0
    v_mov_b32 v77, 0
    v_mov_b32 v78, 0
    v_mov_b32 v79, 0
    s_mov_b32 s62, 4
K3_CLOOP:
    s_waitcnt lgkmcnt(0)
    s_barrier
    ds_read_b64_tr_b16 v[128:129], v16 offset:16384
    ds_read_b64_tr_b16 v[130:131], v16 offset:16896
    ds_read_b128 v[132:135], v12 offset:16384
    ds_read_b64_tr_b16 v[136:137], v16 offset:18432
    ds_read_b64_tr_b16 v[138:139], v16 offset:18944
    ds_read_b128 v[140:143], v13 offset:16384
    ds_read_b64_tr_b16 v[144:145], v16 offset:20480
    ds_read_b64_tr_b16 v[146:147], v16 offset:20992
    ds_read_b128 v[148:151], v14 offset:16384
    ds_read_b64_tr_b16 v[152:153], v16 offset:22528
    ds_read_b64_tr_b16 v[154:155], v16 offset:23040
    ds_read_b128 v[156:159], v15 offset:16384
    v_mfma_f32_32x32x16_bf16 v[64:79], v[96:99], v[100:103], v[64:79]
    v_mfma_f32_32x32x16_bf16 v[64:79], v[104:107], v[108:111], v[64:79]
    v_mfma_f32_32x32x16_bf16 v[64:79], v[112:115], v[116:119], v[64:79]
    v_mfma_f32_32x32x16_bf16 v[64:79], v[120:123], v[124:127], v[64:79]
    s_waitcnt lgkmcnt(0)
    s_barrier
    ds_read_b64_tr_b16 v[96:97], v16 offset:32768
    ds_read_b64_tr_b16 v[98:99], v16 offset:33280
    ds_read_b128 v[100:103], v12 offset:32768
    ds_read_b64_tr_b16 v[104:105], v16 offset:34816
    ds_read_b64_tr_b16 v[106:107], v16 offset:35328
    ds_read_b128 v[108:111], v13 offset:32768
    ds_read_b64_tr_b16 v[112:113], v16 offset:36864
    ds_read_b64_tr_b16 v[114:115], v16 offset:37376
    ds_read_b128 v[116:119], v14 offset:32768
    ds_read_b64_tr_b16 v[120:121], v16 offset:38912
    ds_read_b64_tr_b16 v[122:123], v16 offset:39424
    ds_read_b128 v[124:127], v15 offset:32768
    v_mfma_f32_32x32x16_bf16 v[64:79], v[128:131], v[132:135], v[64:79]
    v_mfma_f32_32x32x16_bf16 v[64:79], v[136:139], v[140:143], v[64:79]
    v_mfma_f32_32x32x16_bf16 v[64:79], v[144:147], v[148:151], v[64:79]
    v_mfma_f32_32x32x16_bf16 v[64:79], v[152:155], v[156:159], v[64:79]
    s_waitcnt lgkmcnt(0)
    s_barrier
    ds_read_b64_tr_b16 v[128:129], v16 offset:49152
    ds_read_b64_tr_b16 v[130:131], v16 offset:49664
    ds_read_b128 v[132:135], v12 offset:49152
    ds_read_b64_tr_b16 v[136:137], v16 offset:51200
    ds_read_b64_tr_b16 v[138:139], v16 offset:51712
    ds_read_b128 v[140:143], v13 offset:49152
    ds_read_b64_tr_b16 v[144:145], v16 offset:53248
    ds_read_b64_tr_b16 v[146:147], v16 offset:53760
    ds_read_b128 v[148:151], v14 offset:49152
    ds_read_b64_tr_b16 v[152:153], v16 offset:55296
    ds_read_b64_tr_b16 v[154:155], v16 offset:55808
    ds_read_b128 v[156:159], v15 offset:49152
    v_mfma_f32_32x32x16_bf16 v[64:79], v[96:99], v[100:103], v[64:79]
    v_mfma_f32_32x32x16_bf16 v[64:79], v[104:107], v[108:111], v[64:79]
    v_mfma_f32_32x32x16_bf16 v[64:79], v[112:115], v[116:119], v[64:79]
    v_mfma_f32_32x32x16_bf16 v[64:79], v[120:123], v[124:127], v[64:79]
    s_waitcnt lgkmcnt(0)
    s_barrier
    ds_read_b64_tr_b16 v[96:97], v24 offset:0
    ds_read_b64_tr_b16 v[98:99], v24 offset:512
    ds_read_b128 v[100:103], v25 offset:0
    ds_read_b64_tr_b16 v[104:105], v24 offset:2048
    ds_read_b64_tr_b16 v[106:107], v24 offset:2560
    ds_read_b128 v[108:111], v26 offset:0
    ds_read_b64_tr_b16 v[112:113], v24 offset:4096
    ds_read_b64_tr_b16 v[114:115], v24 offset:4608
    ds_read_b128 v[116:119], v27 offset:0
    ds_read_b64_tr_b16 v[120:121], v24 offset:6144
    ds_read_b64_tr_b16 v[122:123], v24 offset:6656
    ds_read_b128 v[124:127], v28 offset:0
    v_mfma_f32_32x32x16_bf16 v[64:79], v[128:131], v[132:135], v[64:79]
    v_mfma_f32_32x32x16_bf16 v[64:79], v[136:139], v[140:143], v[64:79]
    v_mfma_f32_32x32x16_bf16 v[64:79], v[144:147], v[148:151], v[64:79]
    v_mfma_f32_32x32x16_bf16 v[64:79], v[152:155], v[156:159], v[64:79]
    s_waitcnt lgkmcnt(0)
    s_barrier
    ds_read_b64_tr_b16 v[128:129], v24 offset:16384
    ds_read_b64_tr_b16 v[130:131], v24 offset:16896
    ds_read_b128 v[132:135], v25 offset:16384
    ds_read_b64_tr_b16 v[136:137], v24 offset:18432
    ds_read_b64_tr_b16 v[138:139], v24 offset:18944
    ds_read_b128 v[140:143], v26 offset:16384
    ds_read_b64_tr_b16 v[144:145], v24 offset:20480
    ds_read_b64_tr_b16 v[146:147], v24 offset:20992
    ds_read_b128 v[148:151], v27 offset:16384
    ds_read_b64_tr_b16 v[152:153], v24 offset:22528
    ds_read_b64_tr_b16 v[154:155], v24 offset:23040
    ds_read_b128 v[156:159], v28 offset:16384
    v_mfma_f32_32x32x16_bf16 v[64:79], v[96:99], v[100:103], v[64:79]
    v_mfma_f32_32x32x16_bf16 v[64:79], v[104:107], v[108:111], v[64:79]
    v_mfma_f32_32x32x16_bf16 v[64:79], v[112:115], v[116:119], v[64:79]
    v_mfma_f32_32x32x16_bf16 v[64:79], v[120:123], v[124:127], v[64:79]
    s_waitcnt lgkmcnt(0)
    s_barrier
    ds_read_b64_tr_b16 v[96:97], v24 offset:32768
    ds_read_b64_tr_b16 v[98:99], v24 offset:33280
    ds_read_b128 v[100:103], v25 offset:32768
    ds_read_b64_tr_b16 v[104:105], v24 offset:34816
    ds_read_b64_tr_b16 v[106:107], v24 offset:35328
    ds_read_b128 v[108:111], v26 offset:32768
    ds_read_b64_tr_b16 v[112:113], v24 offset:36864
    ds_read_b64_tr_b16 v[114:115], v24 offset:37376
    ds_read_b128 v[116:119], v27 offset:32768
    ds_read_b64_tr_b16 v[120:121], v24 offset:38912
    ds_read_b64_tr_b16 v[122:123], v24 offset:39424
    ds_read_b128 v[124:127], v28 offset:32768
    v_mfma_f32_32x32x16_bf16 v[64:79], v[128:131], v[132:135], v[64:79]
    v_mfma_f32_32x32x16_bf16 v[64:79], v[136:139], v[140:143], v[64:79]
    v_mfma_f32_32x32x16_bf16 v[64:79], v[144:147], v[148:151], v[64:79]
    v_mfma_f32_32x32x16_bf16 v[64:79], v[152:155], v[156:159], v[64:79]
    s_waitcnt lgkmcnt(0)
    s_barrier
    ds_read_b64_tr_b16 v[128:129], v24 offset:49152
    ds_read_b64_tr_b16 v[130:131], v24 offset:49664
    ds_read_b128 v[132:135], v25 offset:49152
    ds_read_b64_tr_b16 v[136:137], v24 offset:51200
    ds_read_b64_tr_b16 v[138:139], v24 offset:51712
    ds_read_b128 v[140:143], v26 offset:49152
    ds_read_b64_tr_b16 v[144:145], v24 offset:53248
    ds_read_b64_tr_b16 v[146:147], v24 offset:53760
    ds_read_b128 v[148:151], v27 offset:49152
    ds_read_b64_tr_b16 v[152:153], v24 offset:55296
    ds_read_b64_tr_b16 v[154:155], v24 offset:55808
    ds_read_b128 v[156:159], v28 offset:49152
    v_mfma_f32_32x32x16_bf16 v[64:79], v[96:99], v[100:103], v[64:79]
    v_mfma_f32_32x32x16_bf16 v[64:79], v[104:107], v[108:111], v[64:79]
    v_mfma_f32_32x32x16_bf16 v[64:79], v[112:115], v[116:119], v[64:79]
    v_mfma_f32_32x32x16_bf16 v[64:79], v[120:123], v[124:127], v[64:79]
    s_waitcnt lgkmcnt(0)
    s_barrier
    ds_read_b64_tr_b16 v[96:97], v16 offset:0
    ds_read_b64_tr_b16 v[98:99], v16 offset:512
    ds_read_b128 v[100:103], v12 offset:0
    ds_read_b64_tr_b16 v[104:105], v16 offset:2048
    ds_read_b64_tr_b16 v[106:107], v16 offset:2560
    ds_read_b128 v[108:111], v13 offset:0
    ds_read_b64_tr_b16 v[112:113], v16 offset:4096
    ds_read_b64_tr_b16 v[114:115], v16 offset:4608
    ds_read_b128 v[116:119], v14 offset:0
    ds_read_b64_tr_b16 v[120:121], v16 offset:6144
    ds_read_b64_tr_b16 v[122:123], v16 offset:6656
    ds_read_b128 v[124:127], v15 offset:0
    v_mfma_f32_32x32x16_bf16 v[64:79], v[128:131], v[132:135], v[64:79]
    v_mfma_f32_32x32x16_bf16 v[64:79], v[136:139], v[140:143], v[64:79]
    v_mfma_f32_32x32x16_bf16 v[64:79], v[144:147], v[148:151], v[64:79]
    v_mfma_f32_32x32x16_bf16 v[64:79], v[152:155], v[156:159], v[64:79]
    s_sub_u32 s62, s62, 1
    s_cmp_lg_u32 s62, 0
    s_cbranch_scc1 K3_CLOOP
    s_waitcnt lgkmcnt(0)
    v_and_b32 v10, 31, v2
    s_lshl_b32 s47, s44, 5
    v_add_u32 v20, s47, v10
    v_bfe_u32 v21, v20, 1, 3
    s_lshl_b32 s47, s45, 2
    v_xor_b32 v21, s47, v21
    v_lshlrev_b32 v20, 7, v20
    v_lshl_add_u32 v20, v21, 4, v20
    v_lshl_add_u32 v20, v11, 3, v20
    s_mul_i32 s47, s36, 28
    s_add_u32 s47, s47, s35
    s_lshl_b32 s47, s47, 13
    s_add_u32 s47, s47, 7340032
    s_waitcnt vmcnt(0)
    s_nop 7
    v_cvt_pk_bf16_f32 v40, v64, v65
    v_cvt_pk_bf16_f32 v41, v66, v67
    v_lshlrev_b32 v42, 16, v40
    v_and_b32 v43, 0xffff0000, v40
    v_lshlrev_b32 v44, 16, v41
    v_and_b32 v45, 0xffff0000, v41
    v_lshlrev_b32 v46, 16, v160
    v_and_b32 v47, 0xffff0000, v160
    v_lshlrev_b32 v48, 16, v161
    v_and_b32 v49, 0xffff0000, v161
    v_add_f32 v42, v42, v46
    v_add_f32 v43, v43, v47
    v_add_f32 v44, v44, v48
    v_add_f32 v45, v45, v49
    v_cvt_pk_bf16_f32 v40, v42, v43
    v_cvt_pk_bf16_f32 v41, v44, v45
    v_lshlrev_b32 v42, 16, v40
    v_and_b32 v43, 0xffff0000, v40
    v_lshlrev_b32 v44, 16, v41
    v_and_b32 v45, 0xffff0000, v41
    v_mul_f32 v46, v42, v42
    v_mul_f32 v47, v43, v43
    v_mul_f32 v48, v44, v44
    v_mul_f32 v49, v45, v45
    v_mov_b32 v50, 0x40135761
    v_fmac_f32 v50, 0x3dd2d3e8, v46
    v_mov_b32 v51, 0x40135761
    v_fmac_f32 v51, 0x3dd2d3e8, v47
    v_mov_b32 v52, 0x40135761
    v_fmac_f32 v52, 0x3dd2d3e8, v48
    v_mov_b32 v53, 0x40135761
    v_fmac_f32 v53, 0x3dd2d3e8, v49
    v_mul_f32 v50, v50, v42
    v_mul_f32 v51, v51, v43
    v_mul_f32 v52, v52, v44
    v_mul_f32 v53, v53, v45
    v_exp_f32 v50, -v50
    v_exp_f32 v51, -v51
    v_exp_f32 v52, -v52
    v_exp_f32 v53, -v53
    s_nop 0
    v_add_f32 v50, 1.0, v50
    v_add_f32 v51, 1.0, v51
    v_add_f32 v52, 1.0, v52
    v_add_f32 v53, 1.0, v53
    v_rcp_f32 v50, v50
    v_rcp_f32 v51, v51
    v_rcp_f32 v52, v52
    v_rcp_f32 v53, v53
    s_nop 0
    v_mul_f32 v42, v42, v50
    v_mul_f32 v43, v43, v51
    v_mul_f32 v44, v44, v52
    v_mul_f32 v45, v45, v53
    v_cvt_pk_bf16_f32 v54, v42, v43
    v_cvt_pk_bf16_f32 v55, v44, v45
    v_xor_b32 v21, 0, v20
    buffer_store_dwordx2 v[54:55], v21, s[28:31], s47 offen
    s_nop 1
    v_cvt_pk_bf16_f32 v40, v68, v69
    v_cvt_pk_bf16_f32 v41, v70, v71
    v_lshlrev_b32 v42, 16, v40
    v_and_b32 v43, 0xffff0000, v40
    v_lshlrev_b32 v44, 16, v41
    v_and_b32 v45, 0xffff0000, v41
    v_lshlrev_b32 v46, 16, v162
    v_and_b32 v47, 0xffff0000, v162
    v_lshlrev_b32 v48, 16, v163
    v_and_b32 v49, 0xffff0000, v163
    v_add_f32 v42, v42, v46
    v_add_f32 v43, v43, v47
    v_add_f32 v44, v44, v48
    v_add_f32 v45, v45, v49
    v_cvt_pk_bf16_f32 v40, v42, v43
    v_cvt_pk_bf16_f32 v41, v44, v45
    v_lshlrev_b32 v42, 16, v40
    v_and_b32 v43, 0xffff0000, v40
    v_lshlrev_b32 v44, 16, v41
    v_and_b32 v45, 0xffff0000, v41
    v_mul_f32 v46, v42, v42
    v_mul_f32 v47, v43, v43
    v_mul_f32 v48, v44, v44
    v_mul_f32 v49, v45, v45
    v_mov_b32 v50, 0x40135761
    v_fmac_f32 v50, 0x3dd2d3e8, v46
    v_mov_b32 v51, 0x40135761
    v_fmac_f32 v51, 0x3dd2d3e8, v47
    v_mov_b32 v52, 0x40135761
    v_fmac_f32 v52, 0x3dd2d3e8, v48
    v_mov_b32 v53, 0x40135761
    v_fmac_f32 v53, 0x3dd2d3e8, v49
    v_mul_f32 v50, v50, v42
    v_mul_f32 v51, v51, v43
    v_mul_f32 v52, v52, v44
    v_mul_f32 v53, v53, v45
    v_exp_f32 v50, -v50
    v_exp_f32 v51, -v51
    v_exp_f32 v52, -v52
    v_exp_f32 v53, -v53
    s_nop 0
    v_add_f32 v50, 1.0, v50
    v_add_f32 v51, 1.0, v51
    v_add_f32 v52, 1.0, v52
    v_add_f32 v53, 1.0, v53
    v_rcp_f32 v50, v50
    v_rcp_f32 v51, v51
    v_rcp_f32 v52, v52
    v_rcp_f32 v53, v53
    s_nop 0
    v_mul_f32 v42, v42, v50
    v_mul_f32 v43, v43, v51
    v_mul_f32 v44, v44, v52
    v_mul_f32 v45, v45, v53
    v_cvt_pk_bf16_f32 v54, v42, v43
    v_cvt_pk_bf16_f32 v55, v44, v45
    v_xor_b32 v21, 16, v20
    buffer_store_dwordx2 v[54:55], v21, s[28:31], s47 offen
    s_nop 1
    v_cvt_pk_bf16_f32 v40, v72, v73
    v_cvt_pk_bf16_f32 v41, v74, v75
    v_lshlrev_b32 v42, 16, v40
    v_and_b32 v43, 0xffff0000, v40
    v_lshlrev_b32 v44, 16, v41
    v_and_b32 v45, 0xffff0000, v41
    v_lshlrev_b32 v46, 16, v164
    v_and_b32 v47, 0xffff0000, v164
    v_lshlrev_b32 v48, 16, v165
    v_and_b32 v49, 0xffff0000, v165
    v_add_f32 v42, v42, v46
    v_add_f32 v43, v43, v47
    v_add_f32 v44, v44, v48
    v_add_f32 v45, v45, v49
    v_cvt_pk_bf16_f32 v40, v42, v43
    v_cvt_pk_bf16_f32 v41, v44, v45
    v_lshlrev_b32 v42, 16, v40
    v_and_b32 v43, 0xffff0000, v40
    v_lshlrev_b32 v44, 16, v41
    v_and_b32 v45, 0xffff0000, v41
    v_mul_f32 v46, v42, v42
    v_mul_f32 v47, v43, v43
    v_mul_f32 v48, v44, v44
    v_mul_f32 v49, v45, v45
    v_mov_b32 v50, 0x40135761
    v_fmac_f32 v50, 0x3dd2d3e8, v46
    v_mov_b32 v51, 0x40135761
    v_fmac_f32 v51, 0x3dd2d3e8, v47
    v_mov_b32 v52, 0x40135761
    v_fmac_f32 v52, 0x3dd2d3e8, v48
    v_mov_b32 v53, 0x40135761
    v_fmac_f32 v53, 0x3dd2d3e8, v49
    v_mul_f32 v50, v50, v42
    v_mul_f32 v51, v51, v43
    v_mul_f32 v52, v52, v44
    v_mul_f32 v53, v53, v45
    v_exp_f32 v50, -v50
    v_exp_f32 v51, -v51
    v_exp_f32 v52, -v52
    v_exp_f32 v53, -v53
    s_nop 0
    v_add_f32 v50, 1.0, v50
    v_add_f32 v51, 1.0, v51
    v_add_f32 v52, 1.0, v52
    v_add_f32 v53, 1.0, v53
    v_rcp_f32 v50, v50
    v_rcp_f32 v51, v51
    v_rcp_f32 v52, v52
    v_rcp_f32 v53, v53
    s_nop 0
    v_mul_f32 v42, v42, v50
    v_mul_f32 v43, v43, v51
    v_mul_f32 v44, v44, v52
    v_mul_f32 v45, v45, v53
    v_cvt_pk_bf16_f32 v54, v42, v43
    v_cvt_pk_bf16_f32 v55, v44, v45
    v_xor_b32 v21, 32, v20
    buffer_store_dwordx2 v[54:55], v21, s[28:31], s47 offen
    s_nop 1
    v_cvt_pk_bf16_f32 v40, v76, v77
    v_cvt_pk_bf16_f32 v41, v78, v79
    v_lshlrev_b32 v42, 16, v40
    v_and_b32 v43, 0xffff0000, v40
    v_lshlrev_b32 v44, 16, v41
    v_and_b32 v45, 0xffff0000, v41
    v_lshlrev_b32 v46, 16, v166
    v_and_b32 v47, 0xffff0000, v166
    v_lshlrev_b32 v48, 16, v167
    v_and_b32 v49, 0xffff0000, v167
    v_add_f32 v42, v42, v46
    v_add_f32 v43, v43, v47
    v_add_f32 v44, v44, v48
    v_add_f32 v45, v45, v49
    v_cvt_pk_bf16_f32 v40, v42, v43
    v_cvt_pk_bf16_f32 v41, v44, v45
    v_lshlrev_b32 v42, 16, v40
    v_and_b32 v43, 0xffff0000, v40
    v_lshlrev_b32 v44, 16, v41
    v_and_b32 v45, 0xffff0000, v41
    v_mul_f32 v46, v42, v42
    v_mul_f32 v47, v43, v43
    v_mul_f32 v48, v44, v44
    v_mul_f32 v49, v45, v45
    v_mov_b32 v50, 0x40135761
    v_fmac_f32 v50, 0x3dd2d3e8, v46
    v_mov_b32 v51, 0x40135761
    v_fmac_f32 v51, 0x3dd2d3e8, v47
    v_mov_b32 v52, 0x40135761
    v_fmac_f32 v52, 0x3dd2d3e8, v48
    v_mov_b32 v53, 0x40135761
    v_fmac_f32 v53, 0x3dd2d3e8, v49
    v_mul_f32 v50, v50, v42
    v_mul_f32 v51, v51, v43
    v_mul_f32 v52, v52, v44
    v_mul_f32 v53, v53, v45
    v_exp_f32 v50, -v50
    v_exp_f32 v51, -v51
    v_exp_f32 v52, -v52
    v_exp_f32 v53, -v53
    s_nop 0
    v_add_f32 v50, 1.0, v50
    v_add_f32 v51, 1.0, v51
    v_add_f32 v52, 1.0, v52
    v_add_f32 v53, 1.0, v53
    v_rcp_f32 v50, v50
    v_rcp_f32 v51, v51
    v_rcp_f32 v52, v52
    v_rcp_f32 v53, v53
    s_nop 0
    v_mul_f32 v42, v42, v50
    v_mul_f32 v43, v43, v51
    v_mul_f32 v44, v44, v52
    v_mul_f32 v45, v45, v53
    v_cvt_pk_bf16_f32 v54, v42, v43
    v_cvt_pk_bf16_f32 v55, v44, v45
    v_xor_b32 v21, 48, v20
    buffer_store_dwordx2 v[54:55], v21, s[28:31], s47 offen
    s_nop 1
K3_DONE:
    s_endpgm
.section .rodata,"a"
.p2align 6
.amdhsa_kernel k3_gemm_kernel
  .amdhsa_next_free_vgpr 168
  .amdhsa_next_free_sgpr 102
  .amdhsa_accum_offset 168
  .amdhsa_group_segment_fixed_size 0
  .amdhsa_kernarg_size 104
  .amdhsa_user_sgpr_count 2
  .amdhsa_user_sgpr_kernarg_segment_ptr 1
  .amdhsa_system_sgpr_workgroup_id_x 1
.end_amdhsa_kernel
.text
.globl k4_gemm_kernel
.p2align 8
.type k4_gemm_kernel,@function
k4_gemm_kernel:
    s_cmp_ge_u32 s2, 224
    s_cbranch_scc1 K4_DONE
    s_and_b32 s33, s2, 7
    s_lshr_b32 s34, s2, 3
    s_mul_i32 s35, s34, 37
    s_lshr_b32 s35, s35, 8
    s_mul_i32 s36, s35, 7
    s_sub_u32 s36, s34, s36
    s_lshl_b32 s35, s35, 3
    s_add_u32 s35, s35, s33
    s_cmp_ge_u32 s35, 32
    s_cbranch_scc1 K4_DONE
    s_load_dwordx2 s[4:5], s[0:1], 64
    s_load_dwordx2 s[6:7], s[0:1], 72
    s_load_dwordx2 s[8:9], s[0:1], 80
    s_load_dwordx2 s[12:13], s[0:1], 96
    v_lshrrev_b32 v1, 6, v0
    v_and_b32 v2, 63, v0
    s_nop 0
    v_readfirstlane_b32 s32, v1
    s_waitcnt lgkmcnt(0)
    s_and_b32 s60, s32, 3
    s_lshr_b32 s61, s32, 2
    s_mov_b32 s32, s60
    s_mov_b32 s16, s4
    s_and_b32 s17, s5, 0xffff
    s_mov_b32 s18, 0x700000
    s_mov_b32 s19, 0x00020000
    s_mov_b32 s20, s6
    s_and_b32 s21, s7, 0xffff
    s_mov_b32 s22, 0x1000
    s_mov_b32 s23, 0x00020000
    s_mov_b32 s24, s8
    s_and_b32 s25, s9, 0xffff
    s_mov_b32 s26, 0x1c0000
    s_mov_b32 s27, 0x00020000
    s_mov_b32 s28, s12
    s_and_b32 s29, s13, 0xffff
    s_mov_b32 s30, 0x10000000
    s_mov_b32 s31, 0x00020000
    v_lshrrev_b32 v3, 3, v2
    s_lshl_b32 s37, s32, 3
    v_add_u32 v3, s37, v3
    v_and_b32 v4, 7, v2
    v_lshlrev_b32 v6, 4, v2
    s_lshl_b32 s38, s32, 10
    v_add_u32 v6, s38, v6
    v_add_u32 v7, 4096, v6
    v_bfe_u32 v5, v3, 1, 1
    v_lshlrev_b32 v5, 2, v5
    v_xor_b32 v5, v5, v4
    s_mov_b32 s38, 4096
    v_mul_lo_u32 v8, v3, s38
    v_lshl_add_u32 v8, v5, 4, v8
    v_add_u32 v9, 131072, v8
    s_mul_i32 s40, s36, 229376
    s_add_u32 s40, s40, 7340032
    s_lshl_b32 s41, s35, 7
    s_lshl_b32 s42, s32, 10
    s_cmp_eq_u32 s61, 0
    s_cbranch_scc1 K4_COMPUTE
    s_add_u32 s43, s42, 0
    s_mov_b32 m0, s43
    s_add_u32 s43, s43, 4096
    buffer_load_dwordx4 v6, s[28:31], s40 offen lds
    s_mov_b32 m0, s43
    s_add_u32 s43, s43, 4096
    buffer_load_dwordx4 v7, s[28:31], s40 offen lds
    s_mov_b32 m0, s43
    s_add_u32 s43, s43, 4096
    buffer_load_dwordx4 v8, s[16:19], s41 offen lds
    s_mov_b32 m0, s43
    s_add_u32 s40, s40, 8192
    buffer_load_dwordx4 v9, s[16:19], s41 offen lds
    s_add_u32 s41, s41, 262144
    s_add_u32 s43, s42, 16384
    s_mov_b32 m0, s43
    s_add_u32 s43, s43, 4096
    buffer_load_dwordx4 v6, s[28:31], s40 offen lds
    s_mov_b32 m0, s43
    s_add_u32 s43, s43, 4096
    buffer_load_dwordx4 v7, s[28:31], s40 offen lds
    s_mov_b32 m0, s43
    s_add_u32 s43, s43, 4096
    buffer_load_dwordx4 v8, s[16:19], s41 offen lds
    s_mov_b32 m0, s43
    s_add_u32 s40, s40, 8192
    buffer_load_dwordx4 v9, s[16:19], s41 offen lds
    s_add_u32 s41, s41, 262144
    s_add_u32 s43, s42, 32768
    s_mov_b32 m0, s43
    s_add_u32 s43, s43, 4096
    buffer_load_dwordx4 v6, s[28:31], s40 offen lds
    s_mov_b32 m0, s43
    s_add_u32 s43, s43, 4096
    buffer_load_dwordx4 v7, s[28:31], s40 offen lds
    s_mov_b32 m0, s43
    s_add_u32 s43, s43, 4096
    buffer_load_dwordx4 v8, s[16:19], s41 offen lds
    s_mov_b32 m0, s43
    s_add_u32 s40, s40, 8192
    buffer_load_dwordx4 v9, s[16:19], s41 offen lds
    s_add_u32 s41, s41, 262144
    s_add_u32 s43, s42, 49152
    s_mov_b32 m0, s43
    s_add_u32 s43, s43, 4096
    buffer_load_dwordx4 v6, s[28:31], s40 offen lds
    s_mov_b32 m0, s43
    s_add_u32 s43, s43, 4096
    buffer_load_dwordx4 v7, s[28:31], s40 offen lds
    s_mov_b32 m0, s43
    s_add_u32 s43, s43, 4096
    buffer_load_dwordx4 v8, s[16:19], s41 offen lds
    s_mov_b32 m0, s43
    s_add_u32 s40, s40, 8192
    buffer_load_dwordx4 v9, s[16:19], s41 offen lds
    s_add_u32 s41, s41, 262144
    s_add_u32 s43, s42, 65536
    s_mov_b32 m0, s43
    s_add_u32 s43, s43, 4096
    buffer_load_dwordx4 v6, s[28:31], s40 offen lds
    s_mov_b32 m0, s43
    s_add_u32 s43, s43, 4096
    buffer_load_dwordx4 v7, s[28:31], s40 offen lds
    s_mov_b32 m0, s43
    s_add_u32 s43, s43, 4096
    buffer_load_dwordx4 v8, s[16:19], s41 offen lds
    s_mov_b32 m0, s43
    s_add_u32 s40, s40, 8192
    buffer_load_dwordx4 v9, s[16:19], s41 offen lds
    s_add_u32 s41, s41, 262144
    s_add_u32 s43, s42, 81920
    s_mov_b32 m0, s43
    s_add_u32 s43, s43, 4096
    buffer_load_dwordx4 v6, s[28:31], s40 offen lds
    s_mov_b32 m0, s43
    s_add_u32 s43, s43, 4096
    buffer_load_dwordx4 v7, s[28:31], s40 offen lds
    s_mov_b32 m0, s43
    s_add_u32 s43, s43, 4096
    buffer_load_dwordx4 v8, s[16:19], s41 offen lds
    s_mov_b32 m0, s43
    s_add_u32 s40, s40, 8192
    buffer_load_dwordx4 v9, s[16:19], s41 offen lds
    s_add_u32 s41, s41, 262144
    s_waitcnt vmcnt(20)
    s_barrier
    s_mov_b32 s62, 2
K4_LLOOP:
    s_waitcnt vmcnt(16)
    s_barrier
    s_add_u32 s43, s42, 98304
    s_mov_b32 m0, s43
    s_add_u32 s43, s43, 4096
    buffer_load_dwordx4 v6, s[28:31], s40 offen lds
    s_mov_b32 m0, s43
    s_add_u32 s43, s43, 4096
    buffer_load_dwordx4 v7, s[28:31], s40 offen lds
    s_mov_b32 m0, s43
    s_add_u32 s43, s43, 4096
    buffer_load_dwordx4 v8, s[16:19], s41 offen lds
    s_mov_b32 m0, s43
    s_add_u32 s40, s40, 8192
    buffer_load_dwordx4 v9, s[16:19], s41 offen lds
    s_add_u32 s41, s41, 262144
    s_waitcnt vmcnt(16)
    s_barrier
    s_add_u32 s43, s42, 0
    s_mov_b32 m0, s43
    s_add_u32 s43, s43, 4096
    buffer_load_dwordx4 v6, s[28:31], s40 offen lds
    s_mov_b32 m0, s43
    s_add_u32 s43, s43, 4096
    buffer_load_dwordx4 v7, s[28:31], s40 offen lds
    s_mov_b32 m0, s43
    s_add_u32 s43, s43, 4096
    buffer_load_dwordx4 v8, s[16:19], s41 offen lds
    s_mov_b32 m0, s43
    s_add_u32 s40, s40, 8192
    buffer_load_dwordx4 v9, s[16:19], s41 offen lds
    s_add_u32 s41, s41, 262144
    s_waitcnt vmcnt(16)
    s_barrier
    s_add_u32 s43, s42, 16384
    s_mov_b32 m0, s43
    s_add_u32 s43, s43, 4096
    buffer_load_dwordx4 v6, s[28:31], s40 offen lds
    s_mov_b32 m0, s43
    s_add_u32 s43, s43, 4096
    buffer_load_dwordx4 v7, s[28:31], s40 offen lds
    s_mov_b32 m0, s43
    s_add_u32 s43, s43, 4096
    buffer_load_dwordx4 v8, s[16:19], s41 offen lds
    s_mov_b32 m0, s43
    s_add_u32 s40, s40, 8192
    buffer_load_dwordx4 v9, s[16:19], s41 offen lds
    s_add_u32 s41, s41, 262144
    s_waitcnt vmcnt(16)
    s_barrier
    s_add_u32 s43, s42, 32768
    s_mov_b32 m0, s43
    s_add_u32 s43, s43, 4096
    buffer_load_dwordx4 v6, s[28:31], s40 offen lds
    s_mov_b32 m0, s43
    s_add_u32 s43, s43, 4096
    buffer_load_dwordx4 v7, s[28:31], s40 offen lds
    s_mov_b32 m0, s43
    s_add_u32 s43, s43, 4096
    buffer_load_dwordx4 v8, s[16:19], s41 offen lds
    s_mov_b32 m0, s43
    s_add_u32 s40, s40, 8192
    buffer_load_dwordx4 v9, s[16:19], s41 offen lds
    s_add_u32 s41, s41, 262144
    s_waitcnt vmcnt(16)
    s_barrier
    s_add_u32 s43, s42, 49152
    s_mov_b32 m0, s43
    s_add_u32 s43, s43, 4096
    buffer_load_dwordx4 v6, s[28:31], s40 offen lds
    s_mov_b32 m0, s43
    s_add_u32 s43, s43, 4096
    buffer_load_dwordx4 v7, s[28:31], s40 offen lds
    s_mov_b32 m0, s43
    s_add_u32 s43, s43, 4096
    buffer_load_dwordx4 v8, s[16:19], s41 offen lds
    s_mov_b32 m0, s43
    s_add_u32 s40, s40, 8192
    buffer_load_dwordx4 v9, s[16:19], s41 offen lds
    s_add_u32 s41, s41, 262144
    s_waitcnt vmcnt(16)
    s_barrier
    s_add_u32 s43, s42, 65536
    s_mov_b32 m0, s43
    s_add_u32 s43, s43, 4096
    buffer_load_dwordx4 v6, s[28:31], s40 offen lds
    s_mov_b32 m0, s43
    s_add_u32 s43, s43, 4096
    buffer_load_dwordx4 v7, s[28:31], s40 offen lds
    s_mov_b32 m0, s43
    s_add_u32 s43, s43, 4096
    buffer_load_dwordx4 v8, s[16:19], s41 offen lds
    s_mov_b32 m0, s43
    s_add_u32 s40, s40, 8192
    buffer_load_dwordx4 v9, s[16:19], s41 offen lds
    s_add_u32 s41, s41, 262144
    s_waitcnt vmcnt(16)
    s_barrier
    s_add_u32 s43, s42, 81920
    s_mov_b32 m0, s43
    s_add_u32 s43, s43, 4096
    buffer_load_dwordx4 v6, s[28:31], s40 offen lds
    s_mov_b32 m0, s43
    s_add_u32 s43, s43, 4096
    buffer_load_dwordx4 v7, s[28:31], s40 offen lds
    s_mov_b32 m0, s43
    s_add_u32 s43, s43, 4096
    buffer_load_dwordx4 v8, s[16:19], s41 offen lds
    s_mov_b32 m0, s43
    s_add_u32 s40, s40, 8192
    buffer_load_dwordx4 v9, s[16:19], s41 offen lds
    s_add_u32 s41, s41, 262144
    s_waitcnt vmcnt(16)
    s_barrier
    s_add_u32 s43, s42, 98304
    s_mov_b32 m0, s43
    s_add_u32 s43, s43, 4096
    buffer_load_dwordx4 v6, s[28:31], s40 offen lds
    s_mov_b32 m0, s43
    s_add_u32 s43, s43, 4096
    buffer_load_dwordx4 v7, s[28:31], s40 offen lds
    s_mov_b32 m0, s43
    s_add_u32 s43, s43, 4096
    buffer_load_dwordx4 v8, s[16:19], s41 offen lds
    s_mov_b32 m0, s43
    s_add_u32 s40, s40, 8192
    buffer_load_dwordx4 v9, s[16:19], s41 offen lds
    s_add_u32 s41, s41, 262144
    s_waitcnt vmcnt(16)
    s_barrier
    s_add_u32 s43, s42, 0
    s_mov_b32 m0, s43
    s_add_u32 s43, s43, 4096
    buffer_load_dwordx4 v6, s[28:31], s40 offen lds
    s_mov_b32 m0, s43
    s_add_u32 s43, s43, 4096
    buffer_load_dwordx4 v7, s[28:31], s40 offen lds
    s_mov_b32 m0, s43
    s_add_u32 s43, s43, 4096
    buffer_load_dwordx4 v8, s[16:19], s41 offen lds
    s_mov_b32 m0, s43
    s_add_u32 s40, s40, 8192
    buffer_load_dwordx4 v9, s[16:19], s41 offen lds
    s_add_u32 s41, s41, 262144
    s_waitcnt vmcnt(16)
    s_barrier
    s_add_u32 s43, s42, 16384
    s_mov_b32 m0, s43
    s_add_u32 s43, s43, 4096
    buffer_load_dwordx4 v6, s[28:31], s40 offen lds
    s_mov_b32 m0, s43
    s_add_u32 s43, s43, 4096
    buffer_load_dwordx4 v7, s[28:31], s40 offen lds
    s_mov_b32 m0, s43
    s_add_u32 s43, s43, 4096
    buffer_load_dwordx4 v8, s[16:19], s41 offen lds
    s_mov_b32 m0, s43
    s_add_u32 s40, s40, 8192
    buffer_load_dwordx4 v9, s[16:19], s41 offen lds
    s_add_u32 s41, s41, 262144
    s_waitcnt vmcnt(16)
    s_barrier
    s_add_u32 s43, s42, 32768
    s_mov_b32 m0, s43
    s_add_u32 s43, s43, 4096
    buffer_load_dwordx4 v6, s[28:31], s40 offen lds
    s_mov_b32 m0, s43
    s_add_u32 s43, s43, 4096
    buffer_load_dwordx4 v7, s[28:31], s40 offen lds
    s_mov_b32 m0, s43
    s_add_u32 s43, s43, 4096
    buffer_load_dwordx4 v8, s[16:19], s41 offen lds
    s_mov_b32 m0, s43
    s_add_u32 s40, s40, 8192
    buffer_load_dwordx4 v9, s[16:19], s41 offen lds
    s_add_u32 s41, s41, 262144
    s_waitcnt vmcnt(16)
    s_barrier
    s_add_u32 s43, s42, 49152
    s_mov_b32 m0, s43
    s_add_u32 s43, s43, 4096
    buffer_load_dwordx4 v6, s[28:31], s40 offen lds
    s_mov_b32 m0, s43
    s_add_u32 s43, s43, 4096
    buffer_load_dwordx4 v7, s[28:31], s40 offen lds
    s_mov_b32 m0, s43
    s_add_u32 s43, s43, 4096
    buffer_load_dwordx4 v8, s[16:19], s41 offen lds
    s_mov_b32 m0, s43
    s_add_u32 s40, s40, 8192
    buffer_load_dwordx4 v9, s[16:19], s41 offen lds
    s_add_u32 s41, s41, 262144
    s_waitcnt vmcnt(16)
    s_barrier
    s_add_u32 s43, s42, 65536
    s_mov_b32 m0, s43
    s_add_u32 s43, s43, 4096
    buffer_load_dwordx4 v6, s[28:31], s40 offen lds
    s_mov_b32 m0, s43
    s_add_u32 s43, s43, 4096
    buffer_load_dwordx4 v7, s[28:31], s40 offen lds
    s_mov_b32 m0, s43
    s_add_u32 s43, s43, 4096
    buffer_load_dwordx4 v8, s[16:19], s41 offen lds
    s_mov_b32 m0, s43
    s_add_u32 s40, s40, 8192
    buffer_load_dwordx4 v9, s[16:19], s41 offen lds
    s_add_u32 s41, s41, 262144
    s_waitcnt vmcnt(16)
    s_barrier
    s_add_u32 s43, s42, 81920
    s_mov_b32 m0, s43
    s_add_u32 s43, s43, 4096
    buffer_load_dwordx4 v6, s[28:31], s40 offen lds
    s_mov_b32 m0, s43
    s_add_u32 s43, s43, 4096
    buffer_load_dwordx4 v7, s[28:31], s40 offen lds
    s_mov_b32 m0, s43
    s_add_u32 s43, s43, 4096
    buffer_load_dwordx4 v8, s[16:19], s41 offen lds
    s_mov_b32 m0, s43
    s_add_u32 s40, s40, 8192
    buffer_load_dwordx4 v9, s[16:19], s41 offen lds
    s_add_u32 s41, s41, 262144
    s_sub_u32 s62, s62, 1
    s_cmp_lg_u32 s62, 0
    s_cbranch_scc1 K4_LLOOP
    s_endpgm
K4_COMPUTE:
    s_and_b32 s44, s32, 1
    s_lshr_b32 s45, s32, 1
    v_and_b32 v10, 31, v2
    s_lshl_b32 s46, s44, 5
    v_add_u32 v10, s46, v10
    v_lshrrev_b32 v11, 5, v2
    v_bfe_u32 v12, v10, 1, 3
    v_xor_b32 v12, v12, v11
    v_lshlrev_b32 v12, 4, v12
    v_lshl_add_u32 v12, v10, 7, v12
    v_xor_b32 v13, 32, v12
    v_xor_b32 v14, 64, v12
    v_xor_b32 v15, 96, v12
    v_bfe_u32 v16, v2, 2, 2
    v_lshl_add_u32 v16, v11, 3, v16
    v_lshlrev_b32 v16, 7, v16
    v_bfe_u32 v17, v2, 4, 1
    v_and_b32 v18, 3, v2
    v_lshlrev_b32 v18, 3, v18
    v_lshl_add_u32 v17, v17, 5, v18
    s_lshl_b32 s46, s45, 6
    v_add_u32 v17, s46, v17
    v_bfe_u32 v18, v2, 3, 1
    v_lshlrev_b32 v18, 6, v18
    v_xor_b32 v17, v17, v18
    v_add_u32 v16, v16, v17
    v_add_u32 v16, 8192, v16
    v_add_u32 v24, 0x10000, v16
    v_add_u32 v25, 0x10000, v12
    v_add_u32 v26, 0x10000, v13
    v_add_u32 v27, 0x10000, v14
    v_add_u32 v28, 0x10000, v15
    v_and_b32 v21, 31, v2
    v_mul_u32_u24 v20, 896, v21
    v_lshl_add_u32 v20, v11, 3, v20
    s_lshl_b32 s46, s35, 1
    s_add_u32 s46, s46, s45
    s_mul_i32 s47, s46, 28672
    s_lshl_b32 s48, s36, 7
    s_add_u32 s47, s47, s48
    s_lshl_b32 s48, s44, 6
    s_add_u32 s47, s47, s48
    s_add_u32 s48, s47, 3145728
    buffer_load_dwordx2 v[160:161], v20, s[28:31], s48 offen offset:0
    buffer_load_dwordx2 v[162:163], v20, s[28:31], s48 offen offset:16
    buffer_load_dwordx2 v[164:165], v20, s[28:31], s48 offen offset:32
    buffer_load_dwordx2 v[166:167], v20, s[28:31], s48 offen offset:48
    v_lshlrev_b32 v21, 1, v21
    s_lshl_b32 s46, s46, 6
    buffer_load_ushort v22, v21, s[20:23], s46 offen
    s_barrier
    ds_read_b64_tr_b16 v[96:97], v16 offset:0
    ds_read_b64_tr_b16 v[98:99], v16 offset:512
    ds_read_b128 v[100:103], v12 offset:0
    ds_read_b64_tr_b16 v[104:105], v16 offset:2048
    ds_read_b64_tr_b16 v[106:107], v16 offset:2560
    ds_read_b128 v[108:111], v13 offset:0
    ds_read_b64_tr_b16 v[112:113], v16 offset:4096
    ds_read_b64_tr_b16 v[114:115], v16 offset:4608
    ds_read_b128 v[116:119], v14 offset:0
    ds_read_b64_tr_b16 v[120:121], v16 offset:6144
    ds_read_b64_tr_b16 v[122:123], v16 offset:6656
    ds_read_b128 v[124:127], v15 offset:0
    v_mov_b32 v64, 0
    v_mov_b32 v65, 0
    v_mov_b32 v66, 0
    v_mov_b32 v67, 0
    v_mov_b32 v68, 0
    v_mov_b32 v69, 0
    v_mov_b32 v70, 0
    v_mov_b32 v71, 0
    v_mov_b32 v72, 0
    v_mov_b32 v73, 0
    v_mov_b32 v74, 0
    v_mov_b32 v75, 0
    v_mov_b32 v76, 0
    v_mov_b32 v77, 0
    v_mov_b32 v78, 0
    v_mov_b32 v79, 0
    s_mov_b32 s62, 2
K4_CLOOP:
    s_waitcnt lgkmcnt(0)
    s_barrier
    ds_read_b64_tr_b16 v[128:129], v16 offset:16384
    ds_read_b64_tr_b16 v[130:131], v16 offset:16896
    ds_read_b128 v[132:135], v12 offset:16384
    ds_read_b64_tr_b16 v[136:137], v16 offset:18432
    ds_read_b64_tr_b16 v[138:139], v16 offset:18944
    ds_read_b128 v[140:143], v13 offset:16384
    ds_read_b64_tr_b16 v[144:145], v16 offset:20480
    ds_read_b64_tr_b16 v[146:147], v16 offset:20992
    ds_read_b128 v[148:151], v14 offset:16384
    ds_read_b64_tr_b16 v[152:153], v16 offset:22528
    ds_read_b64_tr_b16 v[154:155], v16 offset:23040
    ds_read_b128 v[156:159], v15 offset:16384
    v_mfma_f32_32x32x16_bf16 v[64:79], v[100:103], v[96:99], v[64:79]
    v_mfma_f32_32x32x16_bf16 v[64:79], v[108:111], v[104:107], v[64:79]
    v_mfma_f32_32x32x16_bf16 v[64:79], v[116:119], v[112:115], v[64:79]
    v_mfma_f32_32x32x16_bf16 v[64:79], v[124:127], v[120:123], v[64:79]
    s_waitcnt lgkmcnt(0)
    s_barrier
    ds_read_b64_tr_b16 v[96:97], v16 offset:32768
    ds_read_b64_tr_b16 v[98:99], v16 offset:33280
    ds_read_b128 v[100:103], v12 offset:32768
    ds_read_b64_tr_b16 v[104:105], v16 offset:34816
    ds_read_b64_tr_b16 v[106:107], v16 offset:35328
    ds_read_b128 v[108:111], v13 offset:32768
    ds_read_b64_tr_b16 v[112:113], v16 offset:36864
    ds_read_b64_tr_b16 v[114:115], v16 offset:37376
    ds_read_b128 v[116:119], v14 offset:32768
    ds_read_b64_tr_b16 v[120:121], v16 offset:38912
    ds_read_b64_tr_b16 v[122:123], v16 offset:39424
    ds_read_b128 v[124:127], v15 offset:32768
    v_mfma_f32_32x32x16_bf16 v[64:79], v[132:135], v[128:131], v[64:79]
    v_mfma_f32_32x32x16_bf16 v[64:79], v[140:143], v[136:139], v[64:79]
    v_mfma_f32_32x32x16_bf16 v[64:79], v[148:151], v[144:147], v[64:79]
    v_mfma_f32_32x32x16_bf16 v[64:79], v[156:159], v[152:155], v[64:79]
    s_waitcnt lgkmcnt(0)
    s_barrier
    ds_read_b64_tr_b16 v[128:129], v16 offset:49152
    ds_read_b64_tr_b16 v[130:131], v16 offset:49664
    ds_read_b128 v[132:135], v12 offset:49152
    ds_read_b64_tr_b16 v[136:137], v16 offset:51200
    ds_read_b64_tr_b16 v[138:139], v16 offset:51712
    ds_read_b128 v[140:143], v13 offset:49152
    ds_read_b64_tr_b16 v[144:145], v16 offset:53248
    ds_read_b64_tr_b16 v[146:147], v16 offset:53760
    ds_read_b128 v[148:151], v14 offset:49152
    ds_read_b64_tr_b16 v[152:153], v16 offset:55296
    ds_read_b64_tr_b16 v[154:155], v16 offset:55808
    ds_read_b128 v[156:159], v15 offset:49152
    v_mfma_f32_32x32x16_bf16 v[64:79], v[100:103], v[96:99], v[64:79]
    v_mfma_f32_32x32x16_bf16 v[64:79], v[108:111], v[104:107], v[64:79]
    v_mfma_f32_32x32x16_bf16 v[64:79], v[116:119], v[112:115], v[64:79]
    v_mfma_f32_32x32x16_bf16 v[64:79], v[124:127], v[120:123], v[64:79]
    s_waitcnt lgkmcnt(0)
    s_barrier
    ds_read_b64_tr_b16 v[96:97], v24 offset:0
    ds_read_b64_tr_b16 v[98:99], v24 offset:512
    ds_read_b128 v[100:103], v25 offset:0
    ds_read_b64_tr_b16 v[104:105], v24 offset:2048
    ds_read_b64_tr_b16 v[106:107], v24 offset:2560
    ds_read_b128 v[108:111], v26 offset:0
    ds_read_b64_tr_b16 v[112:113], v24 offset:4096
    ds_read_b64_tr_b16 v[114:115], v24 offset:4608
    ds_read_b128 v[116:119], v27 offset:0
    ds_read_b64_tr_b16 v[120:121], v24 offset:6144
    ds_read_b64_tr_b16 v[122:123], v24 offset:6656
    ds_read_b128 v[124:127], v28 offset:0
    v_mfma_f32_32x32x16_bf16 v[64:79], v[132:135], v[128:131], v[64:79]
    v_mfma_f32_32x32x16_bf16 v[64:79], v[140:143], v[136:139], v[64:79]
    v_mfma_f32_32x32x16_bf16 v[64:79], v[148:151], v[144:147], v[64:79]
    v_mfma_f32_32x32x16_bf16 v[64:79], v[156:159], v[152:155], v[64:79]
    s_waitcnt lgkmcnt(0)
    s_barrier
    ds_read_b64_tr_b16 v[128:129], v24 offset:16384
    ds_read_b64_tr_b16 v[130:131], v24 offset:16896
    ds_read_b128 v[132:135], v25 offset:16384
    ds_read_b64_tr_b16 v[136:137], v24 offset:18432
    ds_read_b64_tr_b16 v[138:139], v24 offset:18944
    ds_read_b128 v[140:143], v26 offset:16384
    ds_read_b64_tr_b16 v[144:145], v24 offset:20480
    ds_read_b64_tr_b16 v[146:147], v24 offset:20992
    ds_read_b128 v[148:151], v27 offset:16384
    ds_read_b64_tr_b16 v[152:153], v24 offset:22528
    ds_read_b64_tr_b16 v[154:155], v24 offset:23040
    ds_read_b128 v[156:159], v28 offset:16384
    v_mfma_f32_32x32x16_bf16 v[64:79], v[100:103], v[96:99], v[64:79]
    v_mfma_f32_32x32x16_bf16 v[64:79], v[108:111], v[104:107], v[64:79]
    v_mfma_f32_32x32x16_bf16 v[64:79], v[116:119], v[112:115], v[64:79]
    v_mfma_f32_32x32x16_bf16 v[64:79], v[124:127], v[120:123], v[64:79]
    s_waitcnt lgkmcnt(0)
    s_barrier
    ds_read_b64_tr_b16 v[96:97], v24 offset:32768
    ds_read_b64_tr_b16 v[98:99], v24 offset:33280
    ds_read_b128 v[100:103], v25 offset:32768
    ds_read_b64_tr_b16 v[104:105], v24 offset:34816
    ds_read_b64_tr_b16 v[106:107], v24 offset:35328
    ds_read_b128 v[108:111], v26 offset:32768
    ds_read_b64_tr_b16 v[112:113], v24 offset:36864
    ds_read_b64_tr_b16 v[114:115], v24 offset:37376
    ds_read_b128 v[116:119], v27 offset:32768
    ds_read_b64_tr_b16 v[120:121], v24 offset:38912
    ds_read_b64_tr_b16 v[122:123], v24 offset:39424
    ds_read_b128 v[124:127], v28 offset:32768
    v_mfma_f32_32x32x16_bf16 v[64:79], v[132:135], v[128:131], v[64:79]
    v_mfma_f32_32x32x16_bf16 v[64:79], v[140:143], v[136:139], v[64:79]
    v_mfma_f32_32x32x16_bf16 v[64:79], v[148:151], v[144:147], v[64:79]
    v_mfma_f32_32x32x16_bf16 v[64:79], v[156:159], v[152:155], v[64:79]
    s_waitcnt lgkmcnt(0)
    s_barrier
    ds_read_b64_tr_b16 v[128:129], v16 offset:0
    ds_read_b64_tr_b16 v[130:131], v16 offset:512
    ds_read_b128 v[132:135], v12 offset:0
    ds_read_b64_tr_b16 v[136:137], v16 offset:2048
    ds_read_b64_tr_b16 v[138:139], v16 offset:2560
    ds_read_b128 v[140:143], v13 offset:0
    ds_read_b64_tr_b16 v[144:145], v16 offset:4096
    ds_read_b64_tr_b16 v[146:147], v16 offset:4608
    ds_read_b128 v[148:151], v14 offset:0
    ds_read_b64_tr_b16 v[152:153], v16 offset:6144
    ds_read_b64_tr_b16 v[154:155], v16 offset:6656
    ds_read_b128 v[156:159], v15 offset:0
    v_mfma_f32_32x32x16_bf16 v[64:79], v[100:103], v[96:99], v[64:79]
    v_mfma_f32_32x32x16_bf16 v[64:79], v[108:111], v[104:107], v[64:79]
    v_mfma_f32_32x32x16_bf16 v[64:79], v[116:119], v[112:115], v[64:79]
    v_mfma_f32_32x32x16_bf16 v[64:79], v[124:127], v[120:123], v[64:79]
    s_waitcnt lgkmcnt(0)
    s_barrier
    ds_read_b64_tr_b16 v[96:97], v16 offset:16384
    ds_read_b64_tr_b16 v[98:99], v16 offset:16896
    ds_read_b128 v[100:103], v12 offset:16384
    ds_read_b64_tr_b16 v[104:105], v16 offset:18432
    ds_read_b64_tr_b16 v[106:107], v16 offset:18944
    ds_read_b128 v[108:111], v13 offset:16384
    ds_read_b64_tr_b16 v[112:113], v16 offset:20480
    ds_read_b64_tr_b16 v[114:115], v16 offset:20992
    ds_read_b128 v[116:119], v14 offset:16384
    ds_read_b64_tr_b16 v[120:121], v16 offset:22528
    ds_read_b64_tr_b16 v[122:123], v16 offset:23040
    ds_read_b128 v[124:127], v15 offset:16384
    v_mfma_f32_32x32x16_bf16 v[64:79], v[132:135], v[128:131], v[64:79]
    v_mfma_f32_32x32x16_bf16 v[64:79], v[140:143], v[136:139], v[64:79]
    v_mfma_f32_32x32x16_bf16 v[64:79], v[148:151], v[144:147], v[64:79]
    v_mfma_f32_32x32x16_bf16 v[64:79], v[156:159], v[152:155], v[64:79]
    s_waitcnt lgkmcnt(0)
    s_barrier
    ds_read_b64_tr_b16 v[128:129], v16 offset:32768
    ds_read_b64_tr_b16 v[130:131], v16 offset:33280
    ds_read_b128 v[132:135], v12 offset:32768
    ds_read_b64_tr_b16 v[136:137], v16 offset:34816
    ds_read_b64_tr_b16 v[138:139], v16 offset:35328
    ds_read_b128 v[140:143], v13 offset:32768
    ds_read_b64_tr_b16 v[144:145], v16 offset:36864
    ds_read_b64_tr_b16 v[146:147], v16 offset:37376
    ds_read_b128 v[148:151], v14 offset:32768
    ds_read_b64_tr_b16 v[152:153], v16 offset:38912
    ds_read_b64_tr_b16 v[154:155], v16 offset:39424
    ds_read_b128 v[156:159], v15 offset:32768
    v_mfma_f32_32x32x16_bf16 v[64:79], v[100:103], v[96:99], v[64:79]
    v_mfma_f32_32x32x16_bf16 v[64:79], v[108:111], v[104:107], v[64:79]
    v_mfma_f32_32x32x16_bf16 v[64:79], v[116:119], v[112:115], v[64:79]
    v_mfma_f32_32x32x16_bf16 v[64:79], v[124:127], v[120:123], v[64:79]
    s_waitcnt lgkmcnt(0)
    s_barrier
    ds_read_b64_tr_b16 v[96:97], v16 offset:49152
    ds_read_b64_tr_b16 v[98:99], v16 offset:49664
    ds_read_b128 v[100:103], v12 offset:49152
    ds_read_b64_tr_b16 v[104:105], v16 offset:51200
    ds_read_b64_tr_b16 v[106:107], v16 offset:51712
    ds_read_b128 v[108:111], v13 offset:49152
    ds_read_b64_tr_b16 v[112:113], v16 offset:53248
    ds_read_b64_tr_b16 v[114:115], v16 offset:53760
    ds_read_b128 v[116:119], v14 offset:49152
    ds_read_b64_tr_b16 v[120:121], v16 offset:55296
    ds_read_b64_tr_b16 v[122:123], v16 offset:55808
    ds_read_b128 v[124:127], v15 offset:49152
    v_mfma_f32_32x32x16_bf16 v[64:79], v[132:135], v[128:131], v[64:79]
    v_mfma_f32_32x32x16_bf16 v[64:79], v[140:143], v[136:139], v[64:79]
    v_mfma_f32_32x32x16_bf16 v[64:79], v[148:151], v[144:147], v[64:79]
    v_mfma_f32_32x32x16_bf16 v[64:79], v[156:159], v[152:155], v[64:79]
    s_waitcnt lgkmcnt(0)
    s_barrier
    ds_read_b64_tr_b16 v[128:129], v24 offset:0
    ds_read_b64_tr_b16 v[130:131], v24 offset:512
    ds_read_b128 v[132:135], v25 offset:0
    ds_read_b64_tr_b16 v[136:137], v24 offset:2048
    ds_read_b64_tr_b16 v[138:139], v24 offset:2560
    ds_read_b128 v[140:143], v26 offset:0
    ds_read_b64_tr_b16 v[144:145], v24 offset:4096
    ds_read_b64_tr_b16 v[146:147], v24 offset:4608
    ds_read_b128 v[148:151], v27 offset:0
    ds_read_b64_tr_b16 v[152:153], v24 offset:6144
    ds_read_b64_tr_b16 v[154:155], v24 offset:6656
    ds_read_b128 v[156:159], v28 offset:0
    v_mfma_f32_32x32x16_bf16 v[64:79], v[100:103], v[96:99], v[64:79]
    v_mfma_f32_32x32x16_bf16 v[64:79], v[108:111], v[104:107], v[64:79]
    v_mfma_f32_32x32x16_bf16 v[64:79], v[116:119], v[112:115], v[64:79]
    v_mfma_f32_32x32x16_bf16 v[64:79], v[124:127], v[120:123], v[64:79]
    s_waitcnt lgkmcnt(0)
    s_barrier
    ds_read_b64_tr_b16 v[96:97], v24 offset:16384
    ds_read_b64_tr_b16 v[98:99], v24 offset:16896
    ds_read_b128 v[100:103], v25 offset:16384
    ds_read_b64_tr_b16 v[104:105], v24 offset:18432
    ds_read_b64_tr_b16 v[106:107], v24 offset:18944
    ds_read_b128 v[108:111], v26 offset:16384
    ds_read_b64_tr_b16 v[112:113], v24 offset:20480
    ds_read_b64_tr_b16 v[114:115], v24 offset:20992
    ds_read_b128 v[116:119], v27 offset:16384
    ds_read_b64_tr_b16 v[120:121], v24 offset:22528
    ds_read_b64_tr_b16 v[122:123], v24 offset:23040
    ds_read_b128 v[124:127], v28 offset:16384
    v_mfma_f32_32x32x16_bf16 v[64:79], v[132:135], v[128:131], v[64:79]
    v_mfma_f32_32x32x16_bf16 v[64:79], v[140:143], v[136:139], v[64:79]
    v_mfma_f32_32x32x16_bf16 v[64:79], v[148:151], v[144:147], v[64:79]
    v_mfma_f32_32x32x16_bf16 v[64:79], v[156:159], v[152:155], v[64:79]
    s_waitcnt lgkmcnt(0)
    s_barrier
    ds_read_b64_tr_b16 v[128:129], v24 offset:32768
    ds_read_b64_tr_b16 v[130:131], v24 offset:33280
    ds_read_b128 v[132:135], v25 offset:32768
    ds_read_b64_tr_b16 v[136:137], v24 offset:34816
    ds_read_b64_tr_b16 v[138:139], v24 offset:35328
    ds_read_b128 v[140:143], v26 offset:32768
    ds_read_b64_tr_b16 v[144:145], v24 offset:36864
    ds_read_b64_tr_b16 v[146:147], v24 offset:37376
    ds_read_b128 v[148:151], v27 offset:32768
    ds_read_b64_tr_b16 v[152:153], v24 offset:38912
    ds_read_b64_tr_b16 v[154:155], v24 offset:39424
    ds_read_b128 v[156:159], v28 offset:32768
    v_mfma_f32_32x32x16_bf16 v[64:79], v[100:103], v[96:99], v[64:79]
    v_mfma_f32_32x32x16_bf16 v[64:79], v[108:111], v[104:107], v[64:79]
    v_mfma_f32_32x32x16_bf16 v[64:79], v[116:119], v[112:115], v[64:79]
    v_mfma_f32_32x32x16_bf16 v[64:79], v[124:127], v[120:123], v[64:79]
    s_waitcnt lgkmcnt(0)
    s_barrier
    ds_read_b64_tr_b16 v[96:97], v16 offset:0
    ds_read_b64_tr_b16 v[98:99], v16 offset:512
    ds_read_b128 v[100:103], v12 offset:0
    ds_read_b64_tr_b16 v[104:105], v16 offset:2048
    ds_read_b64_tr_b16 v[106:107], v16 offset:2560
    ds_read_b128 v[108:111], v13 offset:0
    ds_read_b64_tr_b16 v[112:113], v16 offset:4096
    ds_read_b64_tr_b16 v[114:115], v16 offset:4608
    ds_read_b128 v[116:119], v14 offset:0
    ds_read_b64_tr_b16 v[120:121], v16 offset:6144
    ds_read_b64_tr_b16 v[122:123], v16 offset:6656
    ds_read_b128 v[124:127], v15 offset:0
    v_mfma_f32_32x32x16_bf16 v[64:79], v[132:135], v[128:131], v[64:79]
    v_mfma_f32_32x32x16_bf16 v[64:79], v[140:143], v[136:139], v[64:79]
    v_mfma_f32_32x32x16_bf16 v[64:79], v[148:151], v[144:147], v[64:79]
    v_mfma_f32_32x32x16_bf16 v[64:79], v[156:159], v[152:155], v[64:79]
    s_sub_u32 s62, s62, 1
    s_cmp_lg_u32 s62, 0
    s_cbranch_scc1 K4_CLOOP
    s_waitcnt lgkmcnt(0)
    v_and_b32 v10, 31, v2
    s_waitcnt vmcnt(0)
    v_lshlrev_b32 v22, 16, v22
    s_nop 7
    v_cvt_pk_bf16_f32 v40, v64, v65
    v_cvt_pk_bf16_f32 v41, v66, v67
    v_lshlrev_b32 v42, 16, v40
    v_and_b32 v43, 0xffff0000, v40
    v_lshlrev_b32 v44, 16, v41
    v_and_b32 v45, 0xffff0000, v41
    v_add_f32 v42, v42, v22
    v_add_f32 v43, v43, v22
    v_add_f32 v44, v44, v22
    v_add_f32 v45, v45, v22
    v_cvt_pk_bf16_f32 v40, v42, v43
    v_cvt_pk_bf16_f32 v41, v44, v45
    v_lshlrev_b32 v42, 16, v40
    v_and_b32 v43, 0xffff0000, v40
    v_lshlrev_b32 v44, 16, v41
    v_and_b32 v45, 0xffff0000, v41
    v_lshlrev_b32 v46, 16, v160
    v_and_b32 v47, 0xffff0000, v160
    v_lshlrev_b32 v48, 16, v161
    v_and_b32 v49, 0xffff0000, v161
    v_add_f32 v42, v42, v46
    v_add_f32 v43, v43, v47
    v_add_f32 v44, v44, v48
    v_add_f32 v45, v45, v49
    v_cvt_pk_bf16_f32 v54, v42, v43
    v_cvt_pk_bf16_f32 v55, v44, v45
    buffer_store_dwordx2 v[54:55], v20, s[24:27], s47 offen offset:0
    s_nop 1
    v_cvt_pk_bf16_f32 v40, v68, v69
    v_cvt_pk_bf16_f32 v41, v70, v71
    v_lshlrev_b32 v42, 16, v40
    v_and_b32 v43, 0xffff0000, v40
    v_lshlrev_b32 v44, 16, v41
    v_and_b32 v45, 0xffff0000, v41
    v_add_f32 v42, v42, v22
    v_add_f32 v43, v43, v22
    v_add_f32 v44, v44, v22
    v_add_f32 v45, v45, v22
    v_cvt_pk_bf16_f32 v40, v42, v43
    v_cvt_pk_bf16_f32 v41, v44, v45
    v_lshlrev_b32 v42, 16, v40
    v_and_b32 v43, 0xffff0000, v40
    v_lshlrev_b32 v44, 16, v41
    v_and_b32 v45, 0xffff0000, v41
    v_lshlrev_b32 v46, 16, v162
    v_and_b32 v47, 0xffff0000, v162
    v_lshlrev_b32 v48, 16, v163
    v_and_b32 v49, 0xffff0000, v163
    v_add_f32 v42, v42, v46
    v_add_f32 v43, v43, v47
    v_add_f32 v44, v44, v48
    v_add_f32 v45, v45, v49
    v_cvt_pk_bf16_f32 v54, v42, v43
    v_cvt_pk_bf16_f32 v55, v44, v45
    buffer_store_dwordx2 v[54:55], v20, s[24:27], s47 offen offset:16
    s_nop 1
    v_cvt_pk_bf16_f32 v40, v72, v73
    v_cvt_pk_bf16_f32 v41, v74, v75
    v_lshlrev_b32 v42, 16, v40
    v_and_b32 v43, 0xffff0000, v40
    v_lshlrev_b32 v44, 16, v41
    v_and_b32 v45, 0xffff0000, v41
    v_add_f32 v42, v42, v22
    v_add_f32 v43, v43, v22
    v_add_f32 v44, v44, v22
    v_add_f32 v45, v45, v22
    v_cvt_pk_bf16_f32 v40, v42, v43
    v_cvt_pk_bf16_f32 v41, v44, v45
    v_lshlrev_b32 v42, 16, v40
    v_and_b32 v43, 0xffff0000, v40
    v_lshlrev_b32 v44, 16, v41
    v_and_b32 v45, 0xffff0000, v41
    v_lshlrev_b32 v46, 16, v164
    v_and_b32 v47, 0xffff0000, v164
    v_lshlrev_b32 v48, 16, v165
    v_and_b32 v49, 0xffff0000, v165
    v_add_f32 v42, v42, v46
    v_add_f32 v43, v43, v47
    v_add_f32 v44, v44, v48
    v_add_f32 v45, v45, v49
    v_cvt_pk_bf16_f32 v54, v42, v43
    v_cvt_pk_bf16_f32 v55, v44, v45
    buffer_store_dwordx2 v[54:55], v20, s[24:27], s47 offen offset:32
    s_nop 1
    v_cvt_pk_bf16_f32 v40, v76, v77
    v_cvt_pk_bf16_f32 v41, v78, v79
    v_lshlrev_b32 v42, 16, v40
    v_and_b32 v43, 0xffff0000, v40
    v_lshlrev_b32 v44, 16, v41
    v_and_b32 v45, 0xffff0000, v41
    v_add_f32 v42, v42, v22
    v_add_f32 v43, v43, v22
    v_add_f32 v44, v44, v22
    v_add_f32 v45, v45, v22
    v_cvt_pk_bf16_f32 v40, v42, v43
    v_cvt_pk_bf16_f32 v41, v44, v45
    v_lshlrev_b32 v42, 16, v40
    v_and_b32 v43, 0xffff0000, v40
    v_lshlrev_b32 v44, 16, v41
    v_and_b32 v45, 0xffff0000, v41
    v_lshlrev_b32 v46, 16, v166
    v_and_b32 v47, 0xffff0000, v166
    v_lshlrev_b32 v48, 16, v167
    v_and_b32 v49, 0xffff0000, v167
    v_add_f32 v42, v42, v46
    v_add_f32 v43, v43, v47
    v_add_f32 v44, v44, v48
    v_add_f32 v45, v45, v49
    v_cvt_pk_bf16_f32 v54, v42, v43
    v_cvt_pk_bf16_f32 v55, v44, v45
    buffer_store_dwordx2 v[54:55], v20, s[24:27], s47 offen offset:48
    s_nop 1
K4_DONE:
    s_endpgm
.section .rodata,"a"
.p2align 6
.amdhsa_kernel k4_gemm_kernel
  .amdhsa_next_free_vgpr 168
  .amdhsa_next_free_sgpr 102
  .amdhsa_accum_offset 168
  .amdhsa_group_segment_fixed_size 0
  .amdhsa_kernarg_size 104
  .amdhsa_user_sgpr_count 2
  .amdhsa_user_sgpr_kernarg_segment_ptr 1
  .amdhsa_system_sgpr_workgroup_id_x 1
.end_amdhsa_kernel
```
